```python
import torch

def _softmax(x, axis=-1):
    return torch.softmax(x, dim=axis)
def _gelu(x):
    return torch.nn.functional.gelu(x, approximate="tanh")
def _silu(x):
    return torch.nn.functional.silu(x)
def _sigmoid(x):
    return torch.sigmoid(x)
def _layernorm(x, axis=-1, eps=1e-5):
    m = x.mean(dim=axis, keepdim=True)
    v = x.var(dim=axis, keepdim=True, unbiased=False)
    return (x - m) / torch.sqrt(v + eps)
def _scatter_add(tgt, idx, src, axis=0):
    return tgt.clone().index_add_(axis, idx, src)
def _segment_sum(src, seg, n):
    out = torch.zeros((n,) + src.shape[1:], dtype=src.dtype)
    return out.index_add_(0, seg, src)
def _pad(x, pw):
    flat = tuple(v for pair in reversed(pw) for v in pair)
    return torch.nn.functional.pad(x, flat)

kernel_name = 'concat_heads__spectral_fnet__sliding_local_dilated__prompt'

def setup_inputs():

    _w = (lambda a: (lambda t: t.to(torch.bfloat16) if t.is_floating_point() else t)(torch.as_tensor(a)))
    def _A_setup():
        B, S, D = 1, 2048, 640
        ns = torch.arange(S)[:, None] * torch.arange(S)[None, :]
        nd = torch.arange(D)[:, None] * torch.arange(D)[None, :]
        Ws_re = torch.cos(-2.0 * torch.pi * ns / S).to(float)
        Ws_im = torch.sin(-2.0 * torch.pi * ns / S).to(float)
        Wd_re = torch.cos(-2.0 * torch.pi * nd / D).to(float)
        Wd_im = torch.sin(-2.0 * torch.pi * nd / D).to(float)
        return {
            "x": _w((lambda *s: torch.randn(*s, dtype=torch.bfloat16) * 0.05)(B, S, D)),
            "dft_seq_re": _w(Ws_re),
            "dft_seq_im": _w(Ws_im),
            "dft_hid_re": _w(Wd_re),
            "dft_hid_im": _w(Wd_im),
        }
    _A_in = _A_setup()

    def _B_setup():
        B, S, D = 1, 2048, 640
        return {
            "x": _w((lambda *s: torch.randn(*s, dtype=torch.bfloat16) * 0.2)(B, S, D)),
            "wqkv": _w((lambda *s: torch.randn(*s, dtype=torch.bfloat16) * 0.8)(D, 3 * D)),
            "wo": _w((lambda *s: torch.randn(*s, dtype=torch.bfloat16) * 0.2)(D, D)),
        }
    _B_in = _B_setup()

    return {
        "A_x": _A_in["x"],
        "A_dft_seq_re": _A_in["dft_seq_re"],
        "A_dft_seq_im": _A_in["dft_seq_im"],
        "A_dft_hid_re": _A_in["dft_hid_re"],
        "A_dft_hid_im": _A_in["dft_hid_im"],
        "B_x": _B_in["x"],
        "B_wqkv": _B_in["wqkv"],
        "B_wo": _B_in["wo"],
    }

def reference(A_x, A_dft_seq_re, A_dft_seq_im, A_dft_hid_re, A_dft_hid_im, B_x, B_wqkv, B_wo):
    def _A_ref(x, dft_seq_re, dft_seq_im, dft_hid_re, dft_hid_im):
        a = torch.einsum("bsd,ed->bse", x, dft_hid_re)
        b = torch.einsum("bsd,ed->bse", x, dft_hid_im)
        y = torch.einsum("ts,bse->bte", dft_seq_re, a) - torch.einsum("ts,bse->bte", dft_seq_im, b)
        return y

    def _B_ref(x, wqkv, wo):
        B, S, D = x.shape
        H = 32; Dh = D // H
        W, dil = 8, 2
        qkv = (lambda x, *d: x.permute(*d))((x @ wqkv).reshape(B, S, 3, H, Dh), 2, 0, 3, 1, 4)
        q, k, v = qkv[0], qkv[1], qkv[2]
        scale = Dh ** -0.5
        pos = torch.arange(S)
        off = torch.arange(W) * dil
        idx = pos[:, None] - off[None, :]
        mask = idx >= 0
        idx_c = torch.where(mask, idx, 0).reshape(-1)
        kg = k[:, :, idx_c, :].reshape(B, H, S, W, Dh)
        vg = v[:, :, idx_c, :].reshape(B, H, S, W, Dh)
        logits = torch.einsum("bhsd,bhswd->bhsw", q, kg) * scale
        logits = torch.where(mask[None, None, :, :], logits, -1e9)
        attn = _softmax(logits, axis=-1)
        o = torch.einsum("bhsw,bhswd->bhsd", attn, vg)
        return (lambda x, *d: x.permute(*d))(o, 0, 2, 1, 3).reshape(B, S, D) @ wo

    a = _A_ref(A_x, A_dft_seq_re, A_dft_seq_im, A_dft_hid_re, A_dft_hid_im)
    b = _B_ref(B_x, B_wqkv, B_wo)
    return torch.concatenate([a, b], axis=-1)
```

```asm
; @launch grid=(256,1,1) block=(512,1,1) lds=163840
.amdgcn_target "amdgcn-amd-amdhsa--gfx950"
.text
.globl concat_heads__spectral_fnet__sliding_local_dilated__prompt_kernel
.p2align 8
.type concat_heads__spectral_fnet__sliding_local_dilated__prompt_kernel,@function
concat_heads__spectral_fnet__sliding_local_dilated__prompt_kernel:
L_start:
    s_load_dwordx2 s[20:21], s[0:1], 40
    s_load_dwordx2 s[24:25], s[0:1], 48
    s_cmp_ge_u32 s2, 256
    s_cbranch_scc1 L_end
    s_load_dwordx2 s[44:45], s[0:1], 0
    s_load_dwordx2 s[28:29], s[0:1], 56
    s_load_dwordx2 s[32:33], s[0:1], 64
    s_load_dwordx2 s[40:41], s[0:1], 72
    s_load_dwordx2 s[36:37], s[0:1], 80
    v_lshrrev_b32 v1, 6, v0
    v_and_b32 v0, 63, v0
    v_readfirstlane_b32 s3, v1
    s_mov_b32 s22, 2621440
    s_mov_b32 s23, 0x20000
    s_mov_b32 s26, 2457600
    s_mov_b32 s27, 0x20000
    s_and_b32 s4, s2, 7
    s_lshr_b32 s5, s2, 3
    s_cmp_ge_u32 s5, 24
    s_cbranch_scc1 L_A
    s_and_b32 s6, s4, 1
    s_lshr_b32 s7, s5, 2
    s_bfe_u32 s9, s4, 0x10001
    s_mul_i32 s9, s9, 6
    s_add_u32 s7, s7, s9
    s_and_b32 s8, s4, 4
    s_and_b32 s9, s5, 3
    s_add_u32 s8, s8, s9
    s_mul_i32 s9, s7, 88
    s_sub_u32 s9, s9, 8
    s_cmp_lt_u32 s3, 4
    s_cbranch_scc1 L_Bcomp
    s_and_b32 s10, s3, 3
    v_lshrrev_b32 v1, 3, v0
    s_lshl_b32 s12, s10, 3
    s_add_u32 s12, s12, s9
    s_lshl_b32 s12, s12, 1
    s_add_u32 s12, s12, s6
    s_mul_i32 s12, s12, 80
    s_and_b32 s11, s10, 1
    s_lshl_b32 s13, s11, 2
    v_lshrrev_b32 v3, 4, v0
    v_and_b32 v2, 7, v0
    v_xor_b32 v3, s13, v3
    v_xor_b32 v2, v2, v3
    v_mul_u32_u24 v1, 160, v1
    v_add3_u32 v1, v1, v2, s12
    v_lshlrev_b32 v10, 4, v1
    s_lshl_b32 s13, s10, 10
    v_add_u32 v11, 81920, v10
    v_add_u32 v12, 163840, v10
    s_waitcnt lgkmcnt(0)
    s_add_u32 m0, s13, 0
    s_nop 0
    buffer_load_dwordx4 v10, s[20:23], 0 offen lds
    s_add_u32 m0, s13, 4096
    s_nop 0
    buffer_load_dwordx4 v11, s[20:23], 0 offen lds
    s_add_u32 m0, s13, 8192
    s_nop 0
    buffer_load_dwordx4 v12, s[20:23], 0 offen lds
    v_lshrrev_b32 v4, 5, v0
    v_and_b32 v5, 31, v0
    s_lshl_b32 s11, s11, 2
    v_lshl_or_b32 v6, v4, 1, s11
    v_xor_b32 v5, v5, v6
    v_xor_b32 v6, 8, v5
    v_min_u32 v5, 29, v5
    v_min_u32 v6, 29, v6
    v_mul_u32_u24 v7, 26, v5
    v_mul_u32_u24 v8, 26, v6
    v_lshrrev_b32 v7, 8, v7
    v_lshrrev_b32 v8, 8, v8
    s_movk_i32 s14, 70
    v_mad_u32_u24 v7, v7, s14, v5
    v_mad_u32_u24 v8, v8, s14, v6
    v_mul_u32_u24 v4, 240, v4
    s_mul_i32 s11, s10, 480
    s_mul_i32 s12, s8, 10
    s_add_u32 s11, s11, s12
    v_add3_u32 v7, v7, v4, s11
    v_add3_u32 v8, v8, v4, s11
    v_lshlrev_b32 v16, 4, v7
    v_lshlrev_b32 v17, 4, v8
    v_add_u32 v17, 30720, v17
    v_add_u32 v18, 61440, v16
    v_add_u32 v19, 61440, v17
    v_add_u32 v20, 122880, v16
    v_add_u32 v21, 122880, v17
    v_add_u32 v22, 184320, v16
    v_add_u32 v23, 184320, v17
    s_add_u32 m0, s13, 12288
    s_nop 0
    buffer_load_dwordx4 v16, s[24:27], 0 offen lds
    s_add_u32 m0, s13, 16384
    s_nop 0
    buffer_load_dwordx4 v17, s[24:27], 0 offen lds
    s_add_u32 m0, s13, 20480
    s_nop 0
    buffer_load_dwordx4 v18, s[24:27], 0 offen lds
    s_add_u32 m0, s13, 24576
    s_nop 0
    buffer_load_dwordx4 v19, s[24:27], 0 offen lds
    s_add_u32 m0, s13, 28672
    s_nop 0
    buffer_load_dwordx4 v20, s[24:27], 0 offen lds
    s_add_u32 m0, s13, 32768
    s_nop 0
    buffer_load_dwordx4 v21, s[24:27], 0 offen lds
    s_add_u32 m0, s13, 36864
    s_nop 0
    buffer_load_dwordx4 v22, s[24:27], 0 offen lds
    s_add_u32 m0, s13, 40960
    s_nop 0
    buffer_load_dwordx4 v23, s[24:27], 0 offen lds
    s_mov_b32 s30, 819200
    s_mov_b32 s31, 0x20000
    s_mov_b32 s34, 5242880
    s_mov_b32 s35, 0x20000
    s_mov_b32 s38, 6291456
    s_mov_b32 s39, 0x20000
    s_mov_b32 s42, 256
    s_mov_b32 s43, 0x20000
    s_mul_i32 s44, s5, 52
    s_lshr_b32 s44, s44, 8
    s_mul_i32 s46, s44, 5
    s_sub_u32 s46, s5, s46
    s_add_u32 s47, s46, s44
    s_and_b32 s47, s47, 3
    s_lshl_b32 s45, s4, 2
    s_add_u32 s45, s45, s44
    s_and_b32 s44, s45, 1
    s_lshr_b32 s45, s45, 1
    s_mul_i32 s62, s47, 204800
    s_mul_i32 s63, s47, 20
    s_add_u32 s63, s63, s3
    s_lshl_b32 s63, s63, 15
    v_and_b32 v1, 31, v0
    v_lshrrev_b32 v2, 5, v0
    s_lshr_b32 s12, s3, 1
    s_lshl_b32 s12, s12, 5
    s_and_b32 s16, s3, 1
    v_add_u32 v3, s12, v1
    v_mul_u32_u24 v4, 520, v3
    v_mul_u32_u24 v5, 40, v2
    s_mul_i32 s11, s16, 80
    v_add_u32 v5, s11, v5
    v_add_u32 v224, v4, v5
    v_and_b32 v232, 3, v0
    v_bfe_u32 v7, v0, 2, 2
    v_lshl_add_u32 v7, v232, 2, v7
    v_and_b32 v8, 16, v0
    v_add3_u32 v7, v7, v8, s12
    v_mul_u32_u24 v7, 520, v7
    v_add_u32 v225, v7, v5
    v_sub_u32 v247, 0, v232
    v_sub_u32 v248, 1, v232
    v_sub_u32 v249, 2, v232
    v_ashrrev_i32 v247, 31, v247
    v_ashrrev_i32 v248, 31, v248
    v_ashrrev_i32 v249, 31, v249
    v_mov_b32 v9, 0xffff
    v_or_b32 v226, v9, v247
    v_bfi_b32 v227, v9, v248, v249
    v_mov_b32 v250, 0x3ea52b5c
    v_add_u32 v228, s9, v3
    v_add_u32 v228, 8, v228
    s_lshl_b32 s11, s8, 1
    s_add_u32 s11, s11, s16
    s_mul_i32 s11, s11, 163840
    s_lshl_b32 s14, s6, 14
    s_add_u32 s11, s11, s14
    s_add_u32 s11, s11, 65536
    v_lshlrev_b32 v6, 4, v228
    v_add_u32 v6, s11, v6
    v_lshl_add_u32 v7, v2, 31, v6
    v_add_u32 v7, 131072, v7
    v_lshl_add_u32 v6, v2, 16, v6
    s_sub_u32 s14, 1016, s9
    s_min_u32 s14, s14, 88
    v_cmp_gt_u32 vcc, s14, v3
    v_bfrev_b32 v8, 1
    s_and_b32 s15, s3, 3
    v_cndmask_b32 v229, v8, v6, vcc
    v_cndmask_b32 v231, v8, v7, vcc
    v_add_u32 v230, 32768, v229
    s_lshr_b32 s16, s3, 2
    v_lshrrev_b32 v2, 4, v0
    v_bfe_u32 v5, v0, 2, 2
    v_and_b32 v7, 1, v2
    v_lshl_or_b32 v7, v7, 2, v5
    s_lshl_b32 s12, s15, 1
    v_xor_b32 v7, s12, v7
    v_lshl_add_u32 v8, v2, 3, v5
    v_lshlrev_b32 v8, 8, v8
    v_lshl_add_u32 v8, v232, 3, v8
    v_lshl_add_u32 v233, v7, 5, v8
    v_xor_b32 v234, 32, v233
    v_add_u32 v235, 81920, v233
    v_add_u32 v236, 81920, v234
    v_add_u32 v237, 147456, v233
    v_add_u32 v238, 147456, v234
    v_add_u32 v239, 65536, v233
    v_add_u32 v240, 65536, v234
    s_lshl_b32 s12, s44, 14
    s_lshl_b32 s11, s45, 10
    s_add_u32 s12, s12, s11
    s_add_u32 s12, s12, 65536
    v_lshl_add_u32 v241, v0, 4, s12
    s_lshl_b32 s60, s3, 10
    s_add_u32 s60, s60, 81920
    v_and_b32 v1, 15, v0
    v_lshlrev_b32 v3, 10, v2
    v_lshl_add_u32 v3, v1, 4, v3
    s_lshl_b32 s14, s16, 9
    s_add_u32 s14, s14, 81920
    v_add_u32 v242, s14, v3
    v_add_u32 v243, 49152, v242
    s_lshl_b32 s14, s45, 6
    s_lshl_b32 s11, s16, 5
    s_add_u32 s11, s14, s11
    v_add_u32 v3, s11, v1
    v_lshl_add_u32 v3, v3, 1, s44
    v_mul_u32_u24 v3, 2560, v3
    v_and_b32 v4, 1, v2
    v_lshlrev_b32 v4, 5, v4
    v_and_b32 v5, 2, v2
    v_lshl_add_u32 v4, v5, 3, v4
    s_lshl_b32 s11, s46, 8
    s_lshl_b32 s15, s15, 6
    s_add_u32 s11, s11, s15
    s_add_u32 s11, s11, 1280
    v_add3_u32 v244, v3, v4, s11
    v_add_u32 v245, 81920, v244
    s_mul_i32 s15, s14, 5958
    s_lshr_b32 s15, s15, 19
    s_add_u32 s14, s14, 63
    s_mul_i32 s14, s14, 5958
    s_lshr_b32 s14, s14, 19
    v_mov_b32 v3, s15
    v_mov_b32 v4, s14
    v_cmp_gt_u32 vcc, 32, v0
    s_mul_i32 s14, s44, 12
    v_bfe_u32 v1, v0, 2, 3
    v_cndmask_b32 v3, v4, v3, vcc
    v_add_u32 v3, s14, v3
    v_lshl_add_u32 v3, v3, 3, v1
    v_lshlrev_b32 v3, 7, v3
    v_min_u32 v1, 0, v232
    v_lshl_add_u32 v3, v1, 16, v3
    v_add_u32 v246, 4096, v3
    s_mul_i32 s61, s6, 12
    s_add_u32 s61, s61, s7
    s_lshl_b32 s61, s61, 3
    s_add_u32 s61, s61, s8
    s_lshl_b32 s61, s61, 7
    s_lshl_b32 s11, s3, 15
    s_mul_i32 s11, s11, 0
    s_add_u32 s61, s61, s11
    s_add_u32 s61, s61, 4096
    v_mov_b32 v252, 252
    v_lshrrev_b32 v4, 4, v0
    v_and_b32 v5, 15, v0
    v_lshlrev_b32 v6, 1, v4
    v_xor_b32 v5, v5, v6
    v_mul_u32_u24 v26, 1280, v4
    v_lshl_add_u32 v26, v5, 4, v26
    s_lshl_b32 s11, s46, 8
    v_add_u32 v26, s11, v26
    v_xor_b32 v27, 128, v26
    s_movk_i32 s14, 128
    s_mov_b32 s15, 245760
    s_add_u32 m0, s13, 45056
    s_nop 0
    buffer_load_dwordx4 v10, s[20:23], s14 offen lds
    s_add_u32 m0, s13, 57344
    s_nop 0
    buffer_load_dwordx4 v16, s[24:27], s15 offen lds
    s_add_u32 m0, s13, 61440
    s_nop 0
    buffer_load_dwordx4 v17, s[24:27], s15 offen lds
    s_add_u32 m0, s13, 65536
    s_nop 0
    buffer_load_dwordx4 v18, s[24:27], s15 offen lds
    s_add_u32 m0, s13, 49152
    s_nop 0
    buffer_load_dwordx4 v11, s[20:23], s14 offen lds
    s_add_u32 m0, s13, 69632
    s_nop 0
    buffer_load_dwordx4 v19, s[24:27], s15 offen lds
    s_add_u32 m0, s13, 73728
    s_nop 0
    buffer_load_dwordx4 v20, s[24:27], s15 offen lds
    s_add_u32 m0, s13, 77824
    s_nop 0
    buffer_load_dwordx4 v21, s[24:27], s15 offen lds
    s_add_u32 m0, s13, 53248
    s_nop 0
    buffer_load_dwordx4 v12, s[20:23], s14 offen lds
    s_add_u32 m0, s13, 81920
    s_nop 0
    buffer_load_dwordx4 v22, s[24:27], s15 offen lds
    s_add_u32 m0, s13, 86016
    s_nop 0
    buffer_load_dwordx4 v23, s[24:27], s15 offen lds
    s_waitcnt vmcnt(11)
    s_barrier
    s_movk_i32 s14, 256
    s_mov_b32 s15, 491520
    s_add_u32 m0, s13, 90112
    s_nop 0
    buffer_load_dwordx4 v10, s[20:23], s14 offen lds
    s_add_u32 m0, s13, 102400
    s_nop 0
    buffer_load_dwordx4 v16, s[24:27], s15 offen lds
    s_add_u32 m0, s13, 106496
    s_nop 0
    buffer_load_dwordx4 v17, s[24:27], s15 offen lds
    s_add_u32 m0, s13, 110592
    s_nop 0
    buffer_load_dwordx4 v18, s[24:27], s15 offen lds
    s_add_u32 m0, s13, 94208
    s_nop 0
    buffer_load_dwordx4 v11, s[20:23], s14 offen lds
    s_add_u32 m0, s13, 114688
    s_nop 0
    buffer_load_dwordx4 v19, s[24:27], s15 offen lds
    s_add_u32 m0, s13, 118784
    s_nop 0
    buffer_load_dwordx4 v20, s[24:27], s15 offen lds
    s_add_u32 m0, s13, 122880
    s_nop 0
    buffer_load_dwordx4 v21, s[24:27], s15 offen lds
    s_add_u32 m0, s13, 98304
    s_nop 0
    buffer_load_dwordx4 v12, s[20:23], s14 offen lds
    s_add_u32 m0, s13, 126976
    s_nop 0
    buffer_load_dwordx4 v22, s[24:27], s15 offen lds
    s_add_u32 m0, s13, 131072
    s_nop 0
    buffer_load_dwordx4 v23, s[24:27], s15 offen lds
    s_waitcnt vmcnt(11)
    s_barrier
    s_movk_i32 s14, 384
    s_mov_b32 s15, 737280
    s_add_u32 m0, s13, 0
    s_nop 0
    buffer_load_dwordx4 v10, s[20:23], s14 offen lds
    s_add_u32 m0, s13, 12288
    s_nop 0
    buffer_load_dwordx4 v16, s[24:27], s15 offen lds
    s_add_u32 m0, s13, 16384
    s_nop 0
    buffer_load_dwordx4 v17, s[24:27], s15 offen lds
    s_add_u32 m0, s13, 20480
    s_nop 0
    buffer_load_dwordx4 v18, s[24:27], s15 offen lds
    s_add_u32 m0, s13, 4096
    s_nop 0
    buffer_load_dwordx4 v11, s[20:23], s14 offen lds
    s_add_u32 m0, s13, 24576
    s_nop 0
    buffer_load_dwordx4 v19, s[24:27], s15 offen lds
    s_add_u32 m0, s13, 28672
    s_nop 0
    buffer_load_dwordx4 v20, s[24:27], s15 offen lds
    s_add_u32 m0, s13, 32768
    s_nop 0
    buffer_load_dwordx4 v21, s[24:27], s15 offen lds
    s_add_u32 m0, s13, 8192
    s_nop 0
    buffer_load_dwordx4 v12, s[20:23], s14 offen lds
    s_add_u32 m0, s13, 36864
    s_nop 0
    buffer_load_dwordx4 v22, s[24:27], s15 offen lds
    s_add_u32 m0, s13, 40960
    s_nop 0
    buffer_load_dwordx4 v23, s[24:27], s15 offen lds
    s_waitcnt vmcnt(11)
    s_barrier
    s_movk_i32 s14, 512
    s_mov_b32 s15, 983040
    s_add_u32 m0, s13, 45056
    s_nop 0
    buffer_load_dwordx4 v10, s[20:23], s14 offen lds
    s_add_u32 m0, s13, 57344
    s_nop 0
    buffer_load_dwordx4 v16, s[24:27], s15 offen lds
    s_add_u32 m0, s13, 61440
    s_nop 0
    buffer_load_dwordx4 v17, s[24:27], s15 offen lds
    s_add_u32 m0, s13, 65536
    s_nop 0
    buffer_load_dwordx4 v18, s[24:27], s15 offen lds
    s_add_u32 m0, s13, 49152
    s_nop 0
    buffer_load_dwordx4 v11, s[20:23], s14 offen lds
    s_add_u32 m0, s13, 69632
    s_nop 0
    buffer_load_dwordx4 v19, s[24:27], s15 offen lds
    s_add_u32 m0, s13, 73728
    s_nop 0
    buffer_load_dwordx4 v20, s[24:27], s15 offen lds
    s_add_u32 m0, s13, 77824
    s_nop 0
    buffer_load_dwordx4 v21, s[24:27], s15 offen lds
    s_add_u32 m0, s13, 53248
    s_nop 0
    buffer_load_dwordx4 v12, s[20:23], s14 offen lds
    s_add_u32 m0, s13, 81920
    s_nop 0
    buffer_load_dwordx4 v22, s[24:27], s15 offen lds
    s_add_u32 m0, s13, 86016
    s_nop 0
    buffer_load_dwordx4 v23, s[24:27], s15 offen lds
    s_waitcnt vmcnt(11)
    s_barrier
    s_movk_i32 s14, 640
    s_mov_b32 s15, 1228800
    s_add_u32 m0, s13, 90112
    s_nop 0
    buffer_load_dwordx4 v10, s[20:23], s14 offen lds
    s_add_u32 m0, s13, 102400
    s_nop 0
    buffer_load_dwordx4 v16, s[24:27], s15 offen lds
    s_add_u32 m0, s13, 106496
    s_nop 0
    buffer_load_dwordx4 v17, s[24:27], s15 offen lds
    s_add_u32 m0, s13, 110592
    s_nop 0
    buffer_load_dwordx4 v18, s[24:27], s15 offen lds
    s_add_u32 m0, s13, 94208
    s_nop 0
    buffer_load_dwordx4 v11, s[20:23], s14 offen lds
    s_add_u32 m0, s13, 114688
    s_nop 0
    buffer_load_dwordx4 v19, s[24:27], s15 offen lds
    s_add_u32 m0, s13, 118784
    s_nop 0
    buffer_load_dwordx4 v20, s[24:27], s15 offen lds
    s_add_u32 m0, s13, 122880
    s_nop 0
    buffer_load_dwordx4 v21, s[24:27], s15 offen lds
    s_add_u32 m0, s13, 98304
    s_nop 0
    buffer_load_dwordx4 v12, s[20:23], s14 offen lds
    s_add_u32 m0, s13, 126976
    s_nop 0
    buffer_load_dwordx4 v22, s[24:27], s15 offen lds
    s_add_u32 m0, s13, 131072
    s_nop 0
    buffer_load_dwordx4 v23, s[24:27], s15 offen lds
    s_waitcnt vmcnt(11)
    s_barrier
    s_movk_i32 s14, 768
    s_mov_b32 s15, 1474560
    s_add_u32 m0, s13, 0
    s_nop 0
    buffer_load_dwordx4 v10, s[20:23], s14 offen lds
    s_add_u32 m0, s13, 12288
    s_nop 0
    buffer_load_dwordx4 v16, s[24:27], s15 offen lds
    s_add_u32 m0, s13, 16384
    s_nop 0
    buffer_load_dwordx4 v17, s[24:27], s15 offen lds
    s_add_u32 m0, s13, 20480
    s_nop 0
    buffer_load_dwordx4 v18, s[24:27], s15 offen lds
    s_add_u32 m0, s13, 4096
    s_nop 0
    buffer_load_dwordx4 v11, s[20:23], s14 offen lds
    s_add_u32 m0, s13, 24576
    s_nop 0
    buffer_load_dwordx4 v19, s[24:27], s15 offen lds
    s_add_u32 m0, s13, 28672
    s_nop 0
    buffer_load_dwordx4 v20, s[24:27], s15 offen lds
    s_add_u32 m0, s13, 32768
    s_nop 0
    buffer_load_dwordx4 v21, s[24:27], s15 offen lds
    s_add_u32 m0, s13, 8192
    s_nop 0
    buffer_load_dwordx4 v12, s[20:23], s14 offen lds
    s_add_u32 m0, s13, 36864
    s_nop 0
    buffer_load_dwordx4 v22, s[24:27], s15 offen lds
    s_add_u32 m0, s13, 40960
    s_nop 0
    buffer_load_dwordx4 v23, s[24:27], s15 offen lds
    s_waitcnt vmcnt(11)
    s_barrier
    s_movk_i32 s14, 896
    s_mov_b32 s15, 1720320
    s_add_u32 m0, s13, 45056
    s_nop 0
    buffer_load_dwordx4 v10, s[20:23], s14 offen lds
    s_add_u32 m0, s13, 57344
    s_nop 0
    buffer_load_dwordx4 v16, s[24:27], s15 offen lds
    s_add_u32 m0, s13, 61440
    s_nop 0
    buffer_load_dwordx4 v17, s[24:27], s15 offen lds
    s_add_u32 m0, s13, 65536
    s_nop 0
    buffer_load_dwordx4 v18, s[24:27], s15 offen lds
    s_add_u32 m0, s13, 49152
    s_nop 0
    buffer_load_dwordx4 v11, s[20:23], s14 offen lds
    s_add_u32 m0, s13, 69632
    s_nop 0
    buffer_load_dwordx4 v19, s[24:27], s15 offen lds
    s_add_u32 m0, s13, 73728
    s_nop 0
    buffer_load_dwordx4 v20, s[24:27], s15 offen lds
    s_add_u32 m0, s13, 77824
    s_nop 0
    buffer_load_dwordx4 v21, s[24:27], s15 offen lds
    s_add_u32 m0, s13, 53248
    s_nop 0
    buffer_load_dwordx4 v12, s[20:23], s14 offen lds
    s_add_u32 m0, s13, 81920
    s_nop 0
    buffer_load_dwordx4 v22, s[24:27], s15 offen lds
    s_add_u32 m0, s13, 86016
    s_nop 0
    buffer_load_dwordx4 v23, s[24:27], s15 offen lds
    s_waitcnt vmcnt(11)
    s_barrier
    s_movk_i32 s14, 1024
    s_mov_b32 s15, 1966080
    s_add_u32 m0, s13, 90112
    s_nop 0
    buffer_load_dwordx4 v10, s[20:23], s14 offen lds
    s_add_u32 m0, s13, 102400
    s_nop 0
    buffer_load_dwordx4 v16, s[24:27], s15 offen lds
    s_add_u32 m0, s13, 106496
    s_nop 0
    buffer_load_dwordx4 v17, s[24:27], s15 offen lds
    s_add_u32 m0, s13, 110592
    s_nop 0
    buffer_load_dwordx4 v18, s[24:27], s15 offen lds
    s_add_u32 m0, s13, 94208
    s_nop 0
    buffer_load_dwordx4 v11, s[20:23], s14 offen lds
    s_add_u32 m0, s13, 114688
    s_nop 0
    buffer_load_dwordx4 v19, s[24:27], s15 offen lds
    s_add_u32 m0, s13, 118784
    s_nop 0
    buffer_load_dwordx4 v20, s[24:27], s15 offen lds
    s_add_u32 m0, s13, 122880
    s_nop 0
    buffer_load_dwordx4 v21, s[24:27], s15 offen lds
    s_add_u32 m0, s13, 98304
    s_nop 0
    buffer_load_dwordx4 v12, s[20:23], s14 offen lds
    s_add_u32 m0, s13, 126976
    s_nop 0
    buffer_load_dwordx4 v22, s[24:27], s15 offen lds
    s_add_u32 m0, s13, 131072
    s_nop 0
    buffer_load_dwordx4 v23, s[24:27], s15 offen lds
    s_waitcnt vmcnt(11)
    s_barrier
    s_movk_i32 s14, 1152
    s_mov_b32 s15, 2211840
    s_add_u32 m0, s13, 0
    s_nop 0
    buffer_load_dwordx4 v10, s[20:23], s14 offen lds
    s_add_u32 m0, s13, 12288
    s_nop 0
    buffer_load_dwordx4 v16, s[24:27], s15 offen lds
    s_add_u32 m0, s13, 16384
    s_nop 0
    buffer_load_dwordx4 v17, s[24:27], s15 offen lds
    s_add_u32 m0, s13, 20480
    s_nop 0
    buffer_load_dwordx4 v18, s[24:27], s15 offen lds
    s_add_u32 m0, s13, 4096
    s_nop 0
    buffer_load_dwordx4 v11, s[20:23], s14 offen lds
    s_add_u32 m0, s13, 24576
    s_nop 0
    buffer_load_dwordx4 v19, s[24:27], s15 offen lds
    s_add_u32 m0, s13, 28672
    s_nop 0
    buffer_load_dwordx4 v20, s[24:27], s15 offen lds
    s_add_u32 m0, s13, 32768
    s_nop 0
    buffer_load_dwordx4 v21, s[24:27], s15 offen lds
    s_add_u32 m0, s13, 8192
    s_nop 0
    buffer_load_dwordx4 v12, s[20:23], s14 offen lds
    s_add_u32 m0, s13, 36864
    s_nop 0
    buffer_load_dwordx4 v22, s[24:27], s15 offen lds
    s_add_u32 m0, s13, 40960
    s_nop 0
    buffer_load_dwordx4 v23, s[24:27], s15 offen lds
    s_waitcnt vmcnt(11)
    s_barrier
    s_cmp_ge_u32 s5, 20
    s_cbranch_scc1 L_wo_1
    s_cmp_eq_u32 s3, 5
    s_cbranch_scc1 L_wo_3
    s_cmp_eq_u32 s3, 6
    s_cbranch_scc1 L_wo_4
    s_cmp_eq_u32 s3, 7
    s_cbranch_scc1 L_wo_5
L_wo_2:
    s_add_u32 s14, s62, 0
    s_mov_b32 m0, 81920
    s_sub_u32 s15, s14, 819200
    s_min_u32 s14, s14, s15
    buffer_load_dwordx4 v26, s[28:31], s14 offen lds
    s_add_u32 s14, s62, 5120
    s_mov_b32 m0, 82944
    s_sub_u32 s15, s14, 819200
    s_min_u32 s14, s14, s15
    buffer_load_dwordx4 v26, s[28:31], s14 offen lds
    s_add_u32 s14, s62, 10240
    s_mov_b32 m0, 83968
    s_sub_u32 s15, s14, 819200
    s_min_u32 s14, s14, s15
    buffer_load_dwordx4 v27, s[28:31], s14 offen lds
    s_add_u32 s14, s62, 15360
    s_mov_b32 m0, 84992
    s_sub_u32 s15, s14, 819200
    s_min_u32 s14, s14, s15
    buffer_load_dwordx4 v27, s[28:31], s14 offen lds
    s_add_u32 s14, s62, 25600
    s_mov_b32 m0, 86016
    s_sub_u32 s15, s14, 819200
    s_min_u32 s14, s14, s15
    buffer_load_dwordx4 v26, s[28:31], s14 offen lds
    s_add_u32 s14, s62, 30720
    s_mov_b32 m0, 87040
    s_sub_u32 s15, s14, 819200
    s_min_u32 s14, s14, s15
    buffer_load_dwordx4 v26, s[28:31], s14 offen lds
    s_branch L_wo_1
L_wo_3:
    s_add_u32 s14, s62, 35840
    s_mov_b32 m0, 88064
    s_sub_u32 s15, s14, 819200
    s_min_u32 s14, s14, s15
    buffer_load_dwordx4 v27, s[28:31], s14 offen lds
    s_add_u32 s14, s62, 40960
    s_mov_b32 m0, 89088
    s_sub_u32 s15, s14, 819200
    s_min_u32 s14, s14, s15
    buffer_load_dwordx4 v27, s[28:31], s14 offen lds
    s_add_u32 s14, s62, 404480
    s_mov_b32 m0, 162816
    s_sub_u32 s15, s14, 819200
    s_min_u32 s14, s14, s15
    buffer_load_dwordx4 v27, s[28:31], s14 offen lds
    s_add_u32 s14, s62, 378880
    s_mov_b32 m0, 161792
    s_sub_u32 s15, s14, 819200
    s_min_u32 s14, s14, s15
    buffer_load_dwordx4 v27, s[28:31], s14 offen lds
    s_add_u32 s14, s62, 399360
    s_mov_b32 m0, 160768
    s_sub_u32 s15, s14, 819200
    s_min_u32 s14, s14, s15
    buffer_load_dwordx4 v26, s[28:31], s14 offen lds
    s_add_u32 s14, s62, 394240
    s_mov_b32 m0, 159744
    s_sub_u32 s15, s14, 819200
    s_min_u32 s14, s14, s15
    buffer_load_dwordx4 v26, s[28:31], s14 offen lds
    s_branch L_wo_1
L_wo_4:
    s_add_u32 s14, s62, 389120
    s_mov_b32 m0, 158720
    s_sub_u32 s15, s14, 819200
    s_min_u32 s14, s14, s15
    buffer_load_dwordx4 v27, s[28:31], s14 offen lds
    s_add_u32 s14, s62, 384000
    s_mov_b32 m0, 157696
    s_sub_u32 s15, s14, 819200
    s_min_u32 s14, s14, s15
    buffer_load_dwordx4 v27, s[28:31], s14 offen lds
    s_add_u32 s14, s62, 373760
    s_mov_b32 m0, 156672
    s_sub_u32 s15, s14, 819200
    s_min_u32 s14, s14, s15
    buffer_load_dwordx4 v26, s[28:31], s14 offen lds
    s_add_u32 s14, s62, 368640
    s_mov_b32 m0, 155648
    s_sub_u32 s15, s14, 819200
    s_min_u32 s14, s14, s15
    buffer_load_dwordx4 v26, s[28:31], s14 offen lds
    s_add_u32 s14, s62, 363520
    s_mov_b32 m0, 154624
    s_sub_u32 s15, s14, 819200
    s_min_u32 s14, s14, s15
    buffer_load_dwordx4 v27, s[28:31], s14 offen lds
    s_add_u32 s14, s62, 358400
    s_mov_b32 m0, 153600
    s_sub_u32 s15, s14, 819200
    s_min_u32 s14, s14, s15
    buffer_load_dwordx4 v27, s[28:31], s14 offen lds
    s_branch L_wo_1
L_wo_5:
    s_add_u32 s14, s62, 353280
    s_mov_b32 m0, 152576
    s_sub_u32 s15, s14, 819200
    s_min_u32 s14, s14, s15
    buffer_load_dwordx4 v26, s[28:31], s14 offen lds
    s_add_u32 s14, s62, 327680
    s_mov_b32 m0, 151552
    s_sub_u32 s15, s14, 819200
    s_min_u32 s14, s14, s15
    buffer_load_dwordx4 v26, s[28:31], s14 offen lds
    s_add_u32 s14, s62, 348160
    s_mov_b32 m0, 150528
    s_sub_u32 s15, s14, 819200
    s_min_u32 s14, s14, s15
    buffer_load_dwordx4 v27, s[28:31], s14 offen lds
    s_add_u32 s14, s62, 343040
    s_mov_b32 m0, 149504
    s_sub_u32 s15, s14, 819200
    s_min_u32 s14, s14, s15
    buffer_load_dwordx4 v27, s[28:31], s14 offen lds
    s_add_u32 s14, s62, 337920
    s_mov_b32 m0, 148480
    s_sub_u32 s15, s14, 819200
    s_min_u32 s14, s14, s15
    buffer_load_dwordx4 v26, s[28:31], s14 offen lds
    s_add_u32 s14, s62, 332800
    s_mov_b32 m0, 147456
    s_sub_u32 s15, s14, 819200
    s_min_u32 s14, s14, s15
    buffer_load_dwordx4 v26, s[28:31], s14 offen lds
L_wo_1:
    s_cmp_ge_u32 s5, 20
    s_cbranch_scc1 L_w9a
    s_waitcnt vmcnt(6)
    s_branch L_w9b
L_w9a:
    s_waitcnt vmcnt(0)
L_w9b:
    s_barrier
    s_cmp_ge_u32 s5, 20
    s_cbranch_scc1 L_wo_6
    s_cmp_eq_u32 s3, 5
    s_cbranch_scc1 L_wo_8
    s_cmp_eq_u32 s3, 6
    s_cbranch_scc1 L_wo_9
    s_cmp_eq_u32 s3, 7
    s_cbranch_scc1 L_wo_10
L_wo_7:
    s_add_u32 s14, s62, 322560
    s_mov_b32 m0, 146432
    s_sub_u32 s15, s14, 819200
    s_min_u32 s14, s14, s15
    buffer_load_dwordx4 v27, s[28:31], s14 offen lds
    s_add_u32 s14, s62, 317440
    s_mov_b32 m0, 145408
    s_sub_u32 s15, s14, 819200
    s_min_u32 s14, s14, s15
    buffer_load_dwordx4 v27, s[28:31], s14 offen lds
    s_add_u32 s14, s62, 312320
    s_mov_b32 m0, 144384
    s_sub_u32 s15, s14, 819200
    s_min_u32 s14, s14, s15
    buffer_load_dwordx4 v26, s[28:31], s14 offen lds
    s_branch L_wo_6
L_wo_8:
    s_add_u32 s14, s62, 307200
    s_mov_b32 m0, 143360
    s_sub_u32 s15, s14, 819200
    s_min_u32 s14, s14, s15
    buffer_load_dwordx4 v26, s[28:31], s14 offen lds
    s_add_u32 s14, s62, 302080
    s_mov_b32 m0, 142336
    s_sub_u32 s15, s14, 819200
    s_min_u32 s14, s14, s15
    buffer_load_dwordx4 v27, s[28:31], s14 offen lds
    s_add_u32 s14, s62, 276480
    s_mov_b32 m0, 141312
    s_sub_u32 s15, s14, 819200
    s_min_u32 s14, s14, s15
    buffer_load_dwordx4 v27, s[28:31], s14 offen lds
    s_branch L_wo_6
L_wo_9:
    s_add_u32 s14, s62, 296960
    s_mov_b32 m0, 140288
    s_sub_u32 s15, s14, 819200
    s_min_u32 s14, s14, s15
    buffer_load_dwordx4 v26, s[28:31], s14 offen lds
    s_add_u32 s14, s62, 291840
    s_mov_b32 m0, 139264
    s_sub_u32 s15, s14, 819200
    s_min_u32 s14, s14, s15
    buffer_load_dwordx4 v26, s[28:31], s14 offen lds
    s_add_u32 s14, s62, 286720
    s_mov_b32 m0, 138240
    s_sub_u32 s15, s14, 819200
    s_min_u32 s14, s14, s15
    buffer_load_dwordx4 v27, s[28:31], s14 offen lds
    s_branch L_wo_6
L_wo_10:
    s_add_u32 s14, s62, 281600
    s_mov_b32 m0, 137216
    s_sub_u32 s15, s14, 819200
    s_min_u32 s14, s14, s15
    buffer_load_dwordx4 v27, s[28:31], s14 offen lds
    s_add_u32 s14, s62, 271360
    s_mov_b32 m0, 136192
    s_sub_u32 s15, s14, 819200
    s_min_u32 s14, s14, s15
    buffer_load_dwordx4 v26, s[28:31], s14 offen lds
    s_add_u32 s14, s62, 266240
    s_mov_b32 m0, 135168
    s_sub_u32 s15, s14, 819200
    s_min_u32 s14, s14, s15
    buffer_load_dwordx4 v26, s[28:31], s14 offen lds
L_wo_6:
    s_barrier
    s_cmp_ge_u32 s5, 20
    s_cbranch_scc1 L_wo_11
    s_cmp_eq_u32 s3, 5
    s_cbranch_scc1 L_wo_13
    s_cmp_eq_u32 s3, 6
    s_cbranch_scc1 L_wo_14
    s_cmp_eq_u32 s3, 7
    s_cbranch_scc1 L_wo_15
L_wo_12:
    s_add_u32 s14, s62, 261120
    s_mov_b32 m0, 134144
    s_sub_u32 s15, s14, 819200
    s_min_u32 s14, s14, s15
    buffer_load_dwordx4 v27, s[28:31], s14 offen lds
    s_add_u32 s14, s62, 256000
    s_mov_b32 m0, 133120
    s_sub_u32 s15, s14, 819200
    s_min_u32 s14, s14, s15
    buffer_load_dwordx4 v27, s[28:31], s14 offen lds
    s_branch L_wo_11
L_wo_13:
    s_add_u32 s14, s62, 250880
    s_mov_b32 m0, 132096
    s_sub_u32 s15, s14, 819200
    s_min_u32 s14, s14, s15
    buffer_load_dwordx4 v26, s[28:31], s14 offen lds
    s_add_u32 s14, s62, 225280
    s_mov_b32 m0, 131072
    s_sub_u32 s15, s14, 819200
    s_min_u32 s14, s14, s15
    buffer_load_dwordx4 v26, s[28:31], s14 offen lds
    s_branch L_wo_11
L_wo_14:
    s_add_u32 s14, s62, 245760
    s_mov_b32 m0, 130048
    s_sub_u32 s15, s14, 819200
    s_min_u32 s14, s14, s15
    buffer_load_dwordx4 v27, s[28:31], s14 offen lds
    s_add_u32 s14, s62, 240640
    s_mov_b32 m0, 129024
    s_sub_u32 s15, s14, 819200
    s_min_u32 s14, s14, s15
    buffer_load_dwordx4 v27, s[28:31], s14 offen lds
    s_branch L_wo_11
L_wo_15:
    s_add_u32 s14, s62, 235520
    s_mov_b32 m0, 128000
    s_sub_u32 s15, s14, 819200
    s_min_u32 s14, s14, s15
    buffer_load_dwordx4 v26, s[28:31], s14 offen lds
    s_add_u32 s14, s62, 230400
    s_mov_b32 m0, 126976
    s_sub_u32 s15, s14, 819200
    s_min_u32 s14, s14, s15
    buffer_load_dwordx4 v26, s[28:31], s14 offen lds
L_wo_11:
    s_barrier
    s_cmp_lt_u32 s3, 6
    s_cbranch_scc1 L_attn
    s_cmp_ge_u32 s5, 20
    s_cbranch_scc1 L_wo_16
    s_cmp_eq_u32 s3, 7
    s_cbranch_scc1 L_wo_18
L_wo_17:
    s_add_u32 s14, s62, 220160
    s_mov_b32 m0, 125952
    s_sub_u32 s15, s14, 819200
    s_min_u32 s14, s14, s15
    buffer_load_dwordx4 v27, s[28:31], s14 offen lds
    s_add_u32 s14, s62, 209920
    s_mov_b32 m0, 123904
    s_sub_u32 s15, s14, 819200
    s_min_u32 s14, s14, s15
    buffer_load_dwordx4 v26, s[28:31], s14 offen lds
    s_add_u32 s14, s62, 199680
    s_mov_b32 m0, 121856
    s_sub_u32 s15, s14, 819200
    s_min_u32 s14, s14, s15
    buffer_load_dwordx4 v27, s[28:31], s14 offen lds
    s_add_u32 s14, s62, 194560
    s_mov_b32 m0, 119808
    s_sub_u32 s15, s14, 819200
    s_min_u32 s14, s14, s15
    buffer_load_dwordx4 v26, s[28:31], s14 offen lds
    s_add_u32 s14, s62, 184320
    s_mov_b32 m0, 117760
    s_sub_u32 s15, s14, 819200
    s_min_u32 s14, s14, s15
    buffer_load_dwordx4 v27, s[28:31], s14 offen lds
    s_add_u32 s14, s62, 168960
    s_mov_b32 m0, 115712
    s_sub_u32 s15, s14, 819200
    s_min_u32 s14, s14, s15
    buffer_load_dwordx4 v26, s[28:31], s14 offen lds
    s_add_u32 s14, s62, 158720
    s_mov_b32 m0, 113664
    s_sub_u32 s15, s14, 819200
    s_min_u32 s14, s14, s15
    buffer_load_dwordx4 v27, s[28:31], s14 offen lds
    s_add_u32 s14, s62, 148480
    s_mov_b32 m0, 111616
    s_sub_u32 s15, s14, 819200
    s_min_u32 s14, s14, s15
    buffer_load_dwordx4 v26, s[28:31], s14 offen lds
    s_add_u32 s14, s62, 143360
    s_mov_b32 m0, 109568
    s_sub_u32 s15, s14, 819200
    s_min_u32 s14, s14, s15
    buffer_load_dwordx4 v27, s[28:31], s14 offen lds
    s_add_u32 s14, s62, 133120
    s_mov_b32 m0, 107520
    s_sub_u32 s15, s14, 819200
    s_min_u32 s14, s14, s15
    buffer_load_dwordx4 v26, s[28:31], s14 offen lds
    s_add_u32 s14, s62, 117760
    s_mov_b32 m0, 105472
    s_sub_u32 s15, s14, 819200
    s_min_u32 s14, s14, s15
    buffer_load_dwordx4 v27, s[28:31], s14 offen lds
    s_add_u32 s14, s62, 107520
    s_mov_b32 m0, 103424
    s_sub_u32 s15, s14, 819200
    s_min_u32 s14, s14, s15
    buffer_load_dwordx4 v26, s[28:31], s14 offen lds
    s_add_u32 s14, s62, 97280
    s_mov_b32 m0, 101376
    s_sub_u32 s15, s14, 819200
    s_min_u32 s14, s14, s15
    buffer_load_dwordx4 v27, s[28:31], s14 offen lds
    s_add_u32 s14, s62, 92160
    s_mov_b32 m0, 99328
    s_sub_u32 s15, s14, 819200
    s_min_u32 s14, s14, s15
    buffer_load_dwordx4 v26, s[28:31], s14 offen lds
    s_add_u32 s14, s62, 81920
    s_mov_b32 m0, 97280
    s_sub_u32 s15, s14, 819200
    s_min_u32 s14, s14, s15
    buffer_load_dwordx4 v27, s[28:31], s14 offen lds
    s_add_u32 s14, s62, 66560
    s_mov_b32 m0, 95232
    s_sub_u32 s15, s14, 819200
    s_min_u32 s14, s14, s15
    buffer_load_dwordx4 v26, s[28:31], s14 offen lds
    s_add_u32 s14, s62, 56320
    s_mov_b32 m0, 93184
    s_sub_u32 s15, s14, 819200
    s_min_u32 s14, s14, s15
    buffer_load_dwordx4 v27, s[28:31], s14 offen lds
    s_add_u32 s14, s62, 46080
    s_mov_b32 m0, 91136
    s_sub_u32 s15, s14, 819200
    s_min_u32 s14, s14, s15
    buffer_load_dwordx4 v26, s[28:31], s14 offen lds
    s_add_u32 s14, s62, 409600
    s_mov_b32 m0, 73728
    s_sub_u32 s15, s14, 819200
    s_min_u32 s14, s14, s15
    buffer_load_dwordx4 v26, s[28:31], s14 offen lds
    s_add_u32 s14, s62, 419840
    s_mov_b32 m0, 75776
    s_sub_u32 s15, s14, 819200
    s_min_u32 s14, s14, s15
    buffer_load_dwordx4 v27, s[28:31], s14 offen lds
    s_branch L_wo_16
L_wo_18:
    s_add_u32 s14, s62, 215040
    s_mov_b32 m0, 124928
    s_sub_u32 s15, s14, 819200
    s_min_u32 s14, s14, s15
    buffer_load_dwordx4 v27, s[28:31], s14 offen lds
    s_add_u32 s14, s62, 204800
    s_mov_b32 m0, 122880
    s_sub_u32 s15, s14, 819200
    s_min_u32 s14, s14, s15
    buffer_load_dwordx4 v26, s[28:31], s14 offen lds
    s_add_u32 s14, s62, 174080
    s_mov_b32 m0, 120832
    s_sub_u32 s15, s14, 819200
    s_min_u32 s14, s14, s15
    buffer_load_dwordx4 v27, s[28:31], s14 offen lds
    s_add_u32 s14, s62, 189440
    s_mov_b32 m0, 118784
    s_sub_u32 s15, s14, 819200
    s_min_u32 s14, s14, s15
    buffer_load_dwordx4 v26, s[28:31], s14 offen lds
    s_add_u32 s14, s62, 179200
    s_mov_b32 m0, 116736
    s_sub_u32 s15, s14, 819200
    s_min_u32 s14, s14, s15
    buffer_load_dwordx4 v27, s[28:31], s14 offen lds
    s_add_u32 s14, s62, 163840
    s_mov_b32 m0, 114688
    s_sub_u32 s15, s14, 819200
    s_min_u32 s14, s14, s15
    buffer_load_dwordx4 v26, s[28:31], s14 offen lds
    s_add_u32 s14, s62, 153600
    s_mov_b32 m0, 112640
    s_sub_u32 s15, s14, 819200
    s_min_u32 s14, s14, s15
    buffer_load_dwordx4 v27, s[28:31], s14 offen lds
    s_add_u32 s14, s62, 122880
    s_mov_b32 m0, 110592
    s_sub_u32 s15, s14, 819200
    s_min_u32 s14, s14, s15
    buffer_load_dwordx4 v26, s[28:31], s14 offen lds
    s_add_u32 s14, s62, 138240
    s_mov_b32 m0, 108544
    s_sub_u32 s15, s14, 819200
    s_min_u32 s14, s14, s15
    buffer_load_dwordx4 v27, s[28:31], s14 offen lds
    s_add_u32 s14, s62, 128000
    s_mov_b32 m0, 106496
    s_sub_u32 s15, s14, 819200
    s_min_u32 s14, s14, s15
    buffer_load_dwordx4 v26, s[28:31], s14 offen lds
    s_add_u32 s14, s62, 112640
    s_mov_b32 m0, 104448
    s_sub_u32 s15, s14, 819200
    s_min_u32 s14, s14, s15
    buffer_load_dwordx4 v27, s[28:31], s14 offen lds
    s_add_u32 s14, s62, 102400
    s_mov_b32 m0, 102400
    s_sub_u32 s15, s14, 819200
    s_min_u32 s14, s14, s15
    buffer_load_dwordx4 v26, s[28:31], s14 offen lds
    s_add_u32 s14, s62, 71680
    s_mov_b32 m0, 100352
    s_sub_u32 s15, s14, 819200
    s_min_u32 s14, s14, s15
    buffer_load_dwordx4 v27, s[28:31], s14 offen lds
    s_add_u32 s14, s62, 87040
    s_mov_b32 m0, 98304
    s_sub_u32 s15, s14, 819200
    s_min_u32 s14, s14, s15
    buffer_load_dwordx4 v26, s[28:31], s14 offen lds
    s_add_u32 s14, s62, 76800
    s_mov_b32 m0, 96256
    s_sub_u32 s15, s14, 819200
    s_min_u32 s14, s14, s15
    buffer_load_dwordx4 v27, s[28:31], s14 offen lds
    s_add_u32 s14, s62, 61440
    s_mov_b32 m0, 94208
    s_sub_u32 s15, s14, 819200
    s_min_u32 s14, s14, s15
    buffer_load_dwordx4 v26, s[28:31], s14 offen lds
    s_add_u32 s14, s62, 51200
    s_mov_b32 m0, 92160
    s_sub_u32 s15, s14, 819200
    s_min_u32 s14, s14, s15
    buffer_load_dwordx4 v27, s[28:31], s14 offen lds
    s_add_u32 s14, s62, 20480
    s_mov_b32 m0, 90112
    s_sub_u32 s15, s14, 819200
    s_min_u32 s14, s14, s15
    buffer_load_dwordx4 v26, s[28:31], s14 offen lds
    s_add_u32 s14, s62, 414720
    s_mov_b32 m0, 74752
    s_sub_u32 s15, s14, 819200
    s_min_u32 s14, s14, s15
    buffer_load_dwordx4 v26, s[28:31], s14 offen lds
    s_add_u32 s14, s62, 424960
    s_mov_b32 m0, 76800
    s_sub_u32 s15, s14, 819200
    s_min_u32 s14, s14, s15
    buffer_load_dwordx4 v27, s[28:31], s14 offen lds
L_wo_16:
    s_barrier
    s_cmp_ge_u32 s5, 20
    s_cbranch_scc1 L_wo_19
    s_cmp_eq_u32 s3, 7
    s_cbranch_scc1 L_wo_21
L_wo_20:
    s_add_u32 s14, s62, 435200
    s_mov_b32 m0, 77824
    s_sub_u32 s15, s14, 819200
    s_min_u32 s14, s14, s15
    buffer_load_dwordx4 v26, s[28:31], s14 offen lds
    s_add_u32 s14, s62, 445440
    s_mov_b32 m0, 79872
    s_sub_u32 s15, s14, 819200
    s_min_u32 s14, s14, s15
    buffer_load_dwordx4 v27, s[28:31], s14 offen lds
    s_add_u32 s14, s62, 430080
    s_mov_b32 m0, 65536
    s_sub_u32 s15, s14, 819200
    s_min_u32 s14, s14, s15
    buffer_load_dwordx4 v26, s[28:31], s14 offen lds
    s_add_u32 s14, s62, 460800
    s_mov_b32 m0, 67584
    s_sub_u32 s15, s14, 819200
    s_min_u32 s14, s14, s15
    buffer_load_dwordx4 v27, s[28:31], s14 offen lds
    s_add_u32 s14, s62, 471040
    s_mov_b32 m0, 69632
    s_sub_u32 s15, s14, 819200
    s_min_u32 s14, s14, s15
    buffer_load_dwordx4 v26, s[28:31], s14 offen lds
    s_add_u32 s14, s62, 486400
    s_mov_b32 m0, 71680
    s_sub_u32 s15, s14, 819200
    s_min_u32 s14, s14, s15
    buffer_load_dwordx4 v27, s[28:31], s14 offen lds
    s_add_u32 s14, s62, 496640
    s_mov_b32 m0, 57344
    s_sub_u32 s15, s14, 819200
    s_min_u32 s14, s14, s15
    buffer_load_dwordx4 v26, s[28:31], s14 offen lds
    s_add_u32 s14, s62, 481280
    s_mov_b32 m0, 59392
    s_sub_u32 s15, s14, 819200
    s_min_u32 s14, s14, s15
    buffer_load_dwordx4 v27, s[28:31], s14 offen lds
    s_add_u32 s14, s62, 512000
    s_mov_b32 m0, 61440
    s_sub_u32 s15, s14, 819200
    s_min_u32 s14, s14, s15
    buffer_load_dwordx4 v26, s[28:31], s14 offen lds
    s_branch L_wo_19
L_wo_21:
    s_add_u32 s14, s62, 440320
    s_mov_b32 m0, 78848
    s_sub_u32 s15, s14, 819200
    s_min_u32 s14, s14, s15
    buffer_load_dwordx4 v26, s[28:31], s14 offen lds
    s_add_u32 s14, s62, 450560
    s_mov_b32 m0, 80896
    s_sub_u32 s15, s14, 819200
    s_min_u32 s14, s14, s15
    buffer_load_dwordx4 v27, s[28:31], s14 offen lds
    s_add_u32 s14, s62, 455680
    s_mov_b32 m0, 66560
    s_sub_u32 s15, s14, 819200
    s_min_u32 s14, s14, s15
    buffer_load_dwordx4 v26, s[28:31], s14 offen lds
    s_add_u32 s14, s62, 465920
    s_mov_b32 m0, 68608
    s_sub_u32 s15, s14, 819200
    s_min_u32 s14, s14, s15
    buffer_load_dwordx4 v27, s[28:31], s14 offen lds
    s_add_u32 s14, s62, 476160
    s_mov_b32 m0, 70656
    s_sub_u32 s15, s14, 819200
    s_min_u32 s14, s14, s15
    buffer_load_dwordx4 v26, s[28:31], s14 offen lds
    s_add_u32 s14, s62, 491520
    s_mov_b32 m0, 72704
    s_sub_u32 s15, s14, 819200
    s_min_u32 s14, s14, s15
    buffer_load_dwordx4 v27, s[28:31], s14 offen lds
    s_add_u32 s14, s62, 501760
    s_mov_b32 m0, 58368
    s_sub_u32 s15, s14, 819200
    s_min_u32 s14, s14, s15
    buffer_load_dwordx4 v26, s[28:31], s14 offen lds
    s_add_u32 s14, s62, 506880
    s_mov_b32 m0, 60416
    s_sub_u32 s15, s14, 819200
    s_min_u32 s14, s14, s15
    buffer_load_dwordx4 v27, s[28:31], s14 offen lds
    s_add_u32 s14, s62, 517120
    s_mov_b32 m0, 62464
    s_sub_u32 s15, s14, 819200
    s_min_u32 s14, s14, s15
    buffer_load_dwordx4 v26, s[28:31], s14 offen lds
L_wo_19:
    s_waitcnt vmcnt(9)
    s_barrier
    s_cmp_ge_u32 s5, 20
    s_cbranch_scc1 L_b13
    s_cmp_ge_u32 s5, 20
    s_cbranch_scc1 L_wo_22
    s_cmp_eq_u32 s3, 7
    s_cbranch_scc1 L_wo_24
L_wo_23:
    s_add_u32 s14, s62, 522240
    s_mov_b32 m0, 63488
    s_sub_u32 s15, s14, 819200
    s_min_u32 s14, s14, s15
    buffer_load_dwordx4 v27, s[28:31], s14 offen lds
    s_add_u32 s14, s62, 558080
    s_mov_b32 m0, 54272
    s_sub_u32 s15, s14, 819200
    s_min_u32 s14, s14, s15
    buffer_load_dwordx4 v26, s[28:31], s14 offen lds
    s_add_u32 s14, s62, 568320
    s_mov_b32 m0, 56320
    s_sub_u32 s15, s14, 819200
    s_min_u32 s14, s14, s15
    buffer_load_dwordx4 v27, s[28:31], s14 offen lds
    s_add_u32 s14, s62, 542720
    s_mov_b32 m0, 50176
    s_sub_u32 s15, s14, 819200
    s_min_u32 s14, s14, s15
    buffer_load_dwordx4 v26, s[28:31], s14 offen lds
    s_add_u32 s14, s62, 552960
    s_mov_b32 m0, 52224
    s_sub_u32 s15, s14, 819200
    s_min_u32 s14, s14, s15
    buffer_load_dwordx4 v27, s[28:31], s14 offen lds
    s_add_u32 s14, s62, 573440
    s_mov_b32 m0, 40960
    s_sub_u32 s15, s14, 819200
    s_min_u32 s14, s14, s15
    buffer_load_dwordx4 v26, s[28:31], s14 offen lds
    s_add_u32 s14, s62, 588800
    s_mov_b32 m0, 43008
    s_sub_u32 s15, s14, 819200
    s_min_u32 s14, s14, s15
    buffer_load_dwordx4 v27, s[28:31], s14 offen lds
    s_add_u32 s14, s62, 599040
    s_mov_b32 m0, 45056
    s_sub_u32 s15, s14, 819200
    s_min_u32 s14, s14, s15
    buffer_load_dwordx4 v26, s[28:31], s14 offen lds
    s_add_u32 s14, s62, 583680
    s_mov_b32 m0, 47104
    s_sub_u32 s15, s14, 819200
    s_min_u32 s14, s14, s15
    buffer_load_dwordx4 v27, s[28:31], s14 offen lds
    s_add_u32 s14, s62, 614400
    s_mov_b32 m0, 32768
    s_sub_u32 s15, s14, 819200
    s_min_u32 s14, s14, s15
    buffer_load_dwordx4 v26, s[28:31], s14 offen lds
    s_add_u32 s14, s62, 624640
    s_mov_b32 m0, 34816
    s_sub_u32 s15, s14, 819200
    s_min_u32 s14, s14, s15
    buffer_load_dwordx4 v27, s[28:31], s14 offen lds
    s_add_u32 s14, s62, 640000
    s_mov_b32 m0, 36864
    s_sub_u32 s15, s14, 819200
    s_min_u32 s14, s14, s15
    buffer_load_dwordx4 v26, s[28:31], s14 offen lds
    s_add_u32 s14, s62, 650240
    s_mov_b32 m0, 38912
    s_sub_u32 s15, s14, 819200
    s_min_u32 s14, s14, s15
    buffer_load_dwordx4 v27, s[28:31], s14 offen lds
    s_add_u32 s14, s62, 634880
    s_mov_b32 m0, 24576
    s_sub_u32 s15, s14, 819200
    s_min_u32 s14, s14, s15
    buffer_load_dwordx4 v26, s[28:31], s14 offen lds
    s_add_u32 s14, s62, 665600
    s_mov_b32 m0, 26624
    s_sub_u32 s15, s14, 819200
    s_min_u32 s14, s14, s15
    buffer_load_dwordx4 v27, s[28:31], s14 offen lds
    s_add_u32 s14, s62, 675840
    s_mov_b32 m0, 28672
    s_sub_u32 s15, s14, 819200
    s_min_u32 s14, s14, s15
    buffer_load_dwordx4 v26, s[28:31], s14 offen lds
    s_branch L_wo_22
L_wo_24:
    s_add_u32 s14, s62, 527360
    s_mov_b32 m0, 64512
    s_sub_u32 s15, s14, 819200
    s_min_u32 s14, s14, s15
    buffer_load_dwordx4 v27, s[28:31], s14 offen lds
    s_add_u32 s14, s62, 563200
    s_mov_b32 m0, 55296
    s_sub_u32 s15, s14, 819200
    s_min_u32 s14, s14, s15
    buffer_load_dwordx4 v27, s[28:31], s14 offen lds
    s_add_u32 s14, s62, 537600
    s_mov_b32 m0, 49152
    s_sub_u32 s15, s14, 819200
    s_min_u32 s14, s14, s15
    buffer_load_dwordx4 v26, s[28:31], s14 offen lds
    s_add_u32 s14, s62, 547840
    s_mov_b32 m0, 51200
    s_sub_u32 s15, s14, 819200
    s_min_u32 s14, s14, s15
    buffer_load_dwordx4 v27, s[28:31], s14 offen lds
    s_add_u32 s14, s62, 532480
    s_mov_b32 m0, 53248
    s_sub_u32 s15, s14, 819200
    s_min_u32 s14, s14, s15
    buffer_load_dwordx4 v26, s[28:31], s14 offen lds
    s_add_u32 s14, s62, 578560
    s_mov_b32 m0, 41984
    s_sub_u32 s15, s14, 819200
    s_min_u32 s14, s14, s15
    buffer_load_dwordx4 v26, s[28:31], s14 offen lds
    s_add_u32 s14, s62, 593920
    s_mov_b32 m0, 44032
    s_sub_u32 s15, s14, 819200
    s_min_u32 s14, s14, s15
    buffer_load_dwordx4 v27, s[28:31], s14 offen lds
    s_add_u32 s14, s62, 604160
    s_mov_b32 m0, 46080
    s_sub_u32 s15, s14, 819200
    s_min_u32 s14, s14, s15
    buffer_load_dwordx4 v26, s[28:31], s14 offen lds
    s_add_u32 s14, s62, 609280
    s_mov_b32 m0, 48128
    s_sub_u32 s15, s14, 819200
    s_min_u32 s14, s14, s15
    buffer_load_dwordx4 v27, s[28:31], s14 offen lds
    s_add_u32 s14, s62, 619520
    s_mov_b32 m0, 33792
    s_sub_u32 s15, s14, 819200
    s_min_u32 s14, s14, s15
    buffer_load_dwordx4 v26, s[28:31], s14 offen lds
    s_add_u32 s14, s62, 629760
    s_mov_b32 m0, 35840
    s_sub_u32 s15, s14, 819200
    s_min_u32 s14, s14, s15
    buffer_load_dwordx4 v27, s[28:31], s14 offen lds
    s_add_u32 s14, s62, 645120
    s_mov_b32 m0, 37888
    s_sub_u32 s15, s14, 819200
    s_min_u32 s14, s14, s15
    buffer_load_dwordx4 v26, s[28:31], s14 offen lds
    s_add_u32 s14, s62, 655360
    s_mov_b32 m0, 39936
    s_sub_u32 s15, s14, 819200
    s_min_u32 s14, s14, s15
    buffer_load_dwordx4 v27, s[28:31], s14 offen lds
    s_add_u32 s14, s62, 660480
    s_mov_b32 m0, 25600
    s_sub_u32 s15, s14, 819200
    s_min_u32 s14, s14, s15
    buffer_load_dwordx4 v26, s[28:31], s14 offen lds
    s_add_u32 s14, s62, 670720
    s_mov_b32 m0, 27648
    s_sub_u32 s15, s14, 819200
    s_min_u32 s14, s14, s15
    buffer_load_dwordx4 v27, s[28:31], s14 offen lds
    s_add_u32 s14, s62, 680960
    s_mov_b32 m0, 29696
    s_sub_u32 s15, s14, 819200
    s_min_u32 s14, s14, s15
    buffer_load_dwordx4 v26, s[28:31], s14 offen lds
L_wo_22:
    s_barrier
    s_cmp_ge_u32 s5, 20
    s_cbranch_scc1 L_wo_25
    s_cmp_eq_u32 s3, 7
    s_cbranch_scc1 L_wo_27
L_wo_26:
    s_add_u32 s14, s62, 691200
    s_mov_b32 m0, 30720
    s_sub_u32 s15, s14, 819200
    s_min_u32 s14, s14, s15
    buffer_load_dwordx4 v27, s[28:31], s14 offen lds
    s_add_u32 s14, s62, 701440
    s_mov_b32 m0, 16384
    s_sub_u32 s15, s14, 819200
    s_min_u32 s14, s14, s15
    buffer_load_dwordx4 v26, s[28:31], s14 offen lds
    s_add_u32 s14, s62, 686080
    s_mov_b32 m0, 18432
    s_sub_u32 s15, s14, 819200
    s_min_u32 s14, s14, s15
    buffer_load_dwordx4 v27, s[28:31], s14 offen lds
    s_add_u32 s14, s62, 716800
    s_mov_b32 m0, 20480
    s_sub_u32 s15, s14, 819200
    s_min_u32 s14, s14, s15
    buffer_load_dwordx4 v26, s[28:31], s14 offen lds
    s_add_u32 s14, s62, 727040
    s_mov_b32 m0, 22528
    s_sub_u32 s15, s14, 819200
    s_min_u32 s14, s14, s15
    buffer_load_dwordx4 v27, s[28:31], s14 offen lds
    s_add_u32 s14, s62, 742400
    s_mov_b32 m0, 8192
    s_sub_u32 s15, s14, 819200
    s_min_u32 s14, s14, s15
    buffer_load_dwordx4 v26, s[28:31], s14 offen lds
    s_add_u32 s14, s62, 752640
    s_mov_b32 m0, 10240
    s_sub_u32 s15, s14, 819200
    s_min_u32 s14, s14, s15
    buffer_load_dwordx4 v27, s[28:31], s14 offen lds
    s_add_u32 s14, s62, 737280
    s_mov_b32 m0, 12288
    s_sub_u32 s15, s14, 819200
    s_min_u32 s14, s14, s15
    buffer_load_dwordx4 v26, s[28:31], s14 offen lds
    s_add_u32 s14, s62, 768000
    s_mov_b32 m0, 14336
    s_sub_u32 s15, s14, 819200
    s_min_u32 s14, s14, s15
    buffer_load_dwordx4 v27, s[28:31], s14 offen lds
    s_add_u32 s14, s62, 778240
    s_mov_b32 m0, 0
    s_sub_u32 s15, s14, 819200
    s_min_u32 s14, s14, s15
    buffer_load_dwordx4 v26, s[28:31], s14 offen lds
    s_add_u32 s14, s62, 793600
    s_mov_b32 m0, 2048
    s_sub_u32 s15, s14, 819200
    s_min_u32 s14, s14, s15
    buffer_load_dwordx4 v27, s[28:31], s14 offen lds
    s_add_u32 s14, s62, 803840
    s_mov_b32 m0, 4096
    s_sub_u32 s15, s14, 819200
    s_min_u32 s14, s14, s15
    buffer_load_dwordx4 v26, s[28:31], s14 offen lds
    s_add_u32 s14, s62, 788480
    s_mov_b32 m0, 6144
    s_sub_u32 s15, s14, 819200
    s_min_u32 s14, s14, s15
    buffer_load_dwordx4 v27, s[28:31], s14 offen lds
    s_branch L_wo_25
L_wo_27:
    s_add_u32 s14, s62, 696320
    s_mov_b32 m0, 31744
    s_sub_u32 s15, s14, 819200
    s_min_u32 s14, s14, s15
    buffer_load_dwordx4 v27, s[28:31], s14 offen lds
    s_add_u32 s14, s62, 706560
    s_mov_b32 m0, 17408
    s_sub_u32 s15, s14, 819200
    s_min_u32 s14, s14, s15
    buffer_load_dwordx4 v26, s[28:31], s14 offen lds
    s_add_u32 s14, s62, 711680
    s_mov_b32 m0, 19456
    s_sub_u32 s15, s14, 819200
    s_min_u32 s14, s14, s15
    buffer_load_dwordx4 v27, s[28:31], s14 offen lds
    s_add_u32 s14, s62, 721920
    s_mov_b32 m0, 21504
    s_sub_u32 s15, s14, 819200
    s_min_u32 s14, s14, s15
    buffer_load_dwordx4 v26, s[28:31], s14 offen lds
    s_add_u32 s14, s62, 732160
    s_mov_b32 m0, 23552
    s_sub_u32 s15, s14, 819200
    s_min_u32 s14, s14, s15
    buffer_load_dwordx4 v27, s[28:31], s14 offen lds
    s_add_u32 s14, s62, 747520
    s_mov_b32 m0, 9216
    s_sub_u32 s15, s14, 819200
    s_min_u32 s14, s14, s15
    buffer_load_dwordx4 v26, s[28:31], s14 offen lds
    s_add_u32 s14, s62, 757760
    s_mov_b32 m0, 11264
    s_sub_u32 s15, s14, 819200
    s_min_u32 s14, s14, s15
    buffer_load_dwordx4 v27, s[28:31], s14 offen lds
    s_add_u32 s14, s62, 762880
    s_mov_b32 m0, 13312
    s_sub_u32 s15, s14, 819200
    s_min_u32 s14, s14, s15
    buffer_load_dwordx4 v26, s[28:31], s14 offen lds
    s_add_u32 s14, s62, 773120
    s_mov_b32 m0, 15360
    s_sub_u32 s15, s14, 819200
    s_min_u32 s14, s14, s15
    buffer_load_dwordx4 v27, s[28:31], s14 offen lds
    s_add_u32 s14, s62, 783360
    s_mov_b32 m0, 1024
    s_sub_u32 s15, s14, 819200
    s_min_u32 s14, s14, s15
    buffer_load_dwordx4 v26, s[28:31], s14 offen lds
    s_add_u32 s14, s62, 798720
    s_mov_b32 m0, 3072
    s_sub_u32 s15, s14, 819200
    s_min_u32 s14, s14, s15
    buffer_load_dwordx4 v27, s[28:31], s14 offen lds
    s_add_u32 s14, s62, 808960
    s_mov_b32 m0, 5120
    s_sub_u32 s15, s14, 819200
    s_min_u32 s14, s14, s15
    buffer_load_dwordx4 v26, s[28:31], s14 offen lds
    s_add_u32 s14, s62, 814080
    s_mov_b32 m0, 7168
    s_sub_u32 s15, s14, 819200
    s_min_u32 s14, s14, s15
    buffer_load_dwordx4 v27, s[28:31], s14 offen lds
L_wo_25:
    ds_read_b64_tr_b16 v[64:65], v235 offset:0
    ds_read_b64_tr_b16 v[66:67], v235 offset:1024
    ds_read_b64_tr_b16 v[68:69], v236 offset:0
    ds_read_b64_tr_b16 v[70:71], v236 offset:1024
    ds_read_b64_tr_b16 v[72:73], v235 offset:8192
    ds_read_b64_tr_b16 v[74:75], v235 offset:9216
    ds_read_b64_tr_b16 v[76:77], v236 offset:8192
    ds_read_b64_tr_b16 v[78:79], v236 offset:9216
    ds_read_b64_tr_b16 v[80:81], v235 offset:16384
    ds_read_b64_tr_b16 v[82:83], v235 offset:17408
    ds_read_b64_tr_b16 v[84:85], v236 offset:16384
    ds_read_b64_tr_b16 v[86:87], v236 offset:17408
    ds_read_b64_tr_b16 v[88:89], v235 offset:24576
    ds_read_b64_tr_b16 v[90:91], v235 offset:25600
    ds_read_b64_tr_b16 v[92:93], v236 offset:24576
    ds_read_b64_tr_b16 v[94:95], v236 offset:25600
    ds_read_b64_tr_b16 v[96:97], v235 offset:32768
    ds_read_b64_tr_b16 v[98:99], v235 offset:33792
    ds_read_b64_tr_b16 v[100:101], v236 offset:32768
    ds_read_b64_tr_b16 v[102:103], v236 offset:33792
    ds_read_b64_tr_b16 v[104:105], v235 offset:40960
    ds_read_b64_tr_b16 v[106:107], v235 offset:41984
    ds_read_b64_tr_b16 v[108:109], v236 offset:40960
    ds_read_b64_tr_b16 v[110:111], v236 offset:41984
    ds_read_b64_tr_b16 v[112:113], v235 offset:49152
    ds_read_b64_tr_b16 v[114:115], v235 offset:50176
    ds_read_b64_tr_b16 v[116:117], v236 offset:49152
    ds_read_b64_tr_b16 v[118:119], v236 offset:50176
    ds_read_b64_tr_b16 v[120:121], v235 offset:57344
    ds_read_b64_tr_b16 v[122:123], v235 offset:58368
    ds_read_b64_tr_b16 v[124:125], v236 offset:57344
    ds_read_b64_tr_b16 v[126:127], v236 offset:58368
    ds_read_b64_tr_b16 v[128:129], v237 offset:0
    ds_read_b64_tr_b16 v[130:131], v237 offset:1024
    ds_read_b64_tr_b16 v[132:133], v238 offset:0
    ds_read_b64_tr_b16 v[134:135], v238 offset:1024
    ds_read_b64_tr_b16 v[136:137], v237 offset:8192
    ds_read_b64_tr_b16 v[138:139], v237 offset:9216
    ds_read_b64_tr_b16 v[140:141], v238 offset:8192
    ds_read_b64_tr_b16 v[142:143], v238 offset:9216
    s_waitcnt vmcnt(0)
    s_branch L_r2
L_Bcomp:
    s_and_b32 s10, s3, 1
    s_cmp_lg_u32 s10, 0
    s_cbranch_scc1 L_ts_28
    s_mul_i32 s12, s5, 22
    s_bfe_u32 s13, s4, 0x10001
    s_mul_i32 s13, s13, 528
    s_add_u32 s12, s12, s13
    s_sub_u32 s12, s12, 8
    v_min_u32 v1, 21, v0
    v_add_u32 v1, s12, v1
    s_and_b32 s12, s4, 1
    v_lshl_add_u32 v1, v1, 1, s12
    v_mul_i32_i24 v29, 1280, v1
    s_movk_i32 s51, 128
    s_waitcnt lgkmcnt(0)
    s_mov_b64 s[52:53], s[20:21]
    s_mov_b32 s54, 2621440
    s_branch L_ts_29
L_ts_28:
    s_mul_i32 s12, s5, 40
    v_min_u32 v1, 39, v0
    v_add_u32 v1, s12, v1
    v_mul_u32_u24 v2, 13108, v1
    v_lshrrev_b32 v2, 16, v2
    v_mul_u32_u24 v2, 640, v2
    v_lshl_add_u32 v2, v1, 7, v2
    s_lshr_b32 s12, s4, 2
    s_mul_i32 s12, s12, 640
    v_add_u32 v29, s12, v2
    s_mov_b32 s51, 245760
    s_waitcnt lgkmcnt(0)
    s_mov_b64 s[52:53], s[24:25]
    s_mov_b32 s54, 2457600
L_ts_29:
    s_mov_b32 s55, 0x20000
    s_lshr_b32 s10, s3, 1
    s_mul_i32 s12, s10, s51
    s_lshl_b32 s13, s51, 1
    s_mov_b32 s50, s12
    s_mov_b32 s49, s13
    s_mov_b32 s30, 819200
    s_mov_b32 s31, 0x20000
    s_mov_b32 s34, 5242880
    s_mov_b32 s35, 0x20000
    s_mov_b32 s38, 6291456
    s_mov_b32 s39, 0x20000
    s_mov_b32 s42, 256
    s_mov_b32 s43, 0x20000
    s_mul_i32 s44, s5, 52
    s_lshr_b32 s44, s44, 8
    s_mul_i32 s46, s44, 5
    s_sub_u32 s46, s5, s46
    s_add_u32 s47, s46, s44
    s_and_b32 s47, s47, 3
    s_lshl_b32 s45, s4, 2
    s_add_u32 s45, s45, s44
    s_and_b32 s44, s45, 1
    s_lshr_b32 s45, s45, 1
    s_mul_i32 s62, s47, 204800
    s_mul_i32 s63, s47, 20
    s_add_u32 s63, s63, s3
    s_lshl_b32 s63, s63, 15
    v_and_b32 v1, 31, v0
    v_lshrrev_b32 v2, 5, v0
    s_lshr_b32 s12, s3, 1
    s_lshl_b32 s12, s12, 5
    s_and_b32 s16, s3, 1
    v_add_u32 v3, s12, v1
    v_mul_u32_u24 v4, 520, v3
    v_mul_u32_u24 v5, 40, v2
    s_mul_i32 s11, s16, 80
    v_add_u32 v5, s11, v5
    v_add_u32 v224, v4, v5
    v_and_b32 v232, 3, v0
    v_bfe_u32 v7, v0, 2, 2
    v_lshl_add_u32 v7, v232, 2, v7
    v_and_b32 v8, 16, v0
    v_add3_u32 v7, v7, v8, s12
    v_mul_u32_u24 v7, 520, v7
    v_add_u32 v225, v7, v5
    v_sub_u32 v247, 0, v232
    v_sub_u32 v248, 1, v232
    v_sub_u32 v249, 2, v232
    v_ashrrev_i32 v247, 31, v247
    v_ashrrev_i32 v248, 31, v248
    v_ashrrev_i32 v249, 31, v249
    v_mov_b32 v9, 0xffff
    v_or_b32 v226, v9, v247
    v_bfi_b32 v227, v9, v248, v249
    v_mov_b32 v250, 0x3ea52b5c
    v_add_u32 v228, s9, v3
    v_add_u32 v228, 8, v228
    s_lshl_b32 s11, s8, 1
    s_add_u32 s11, s11, s16
    s_mul_i32 s11, s11, 163840
    s_lshl_b32 s14, s6, 14
    s_add_u32 s11, s11, s14
    s_add_u32 s11, s11, 65536
    v_lshlrev_b32 v6, 4, v228
    v_add_u32 v6, s11, v6
    v_lshl_add_u32 v7, v2, 31, v6
    v_add_u32 v7, 131072, v7
    v_lshl_add_u32 v6, v2, 16, v6
    s_sub_u32 s14, 1016, s9
    s_min_u32 s14, s14, 88
    v_cmp_gt_u32 vcc, s14, v3
    v_bfrev_b32 v8, 1
    s_and_b32 s15, s3, 3
    v_cndmask_b32 v229, v8, v6, vcc
    v_cndmask_b32 v231, v8, v7, vcc
    v_add_u32 v230, 32768, v229
    s_lshr_b32 s16, s3, 2
    v_lshrrev_b32 v2, 4, v0
    v_bfe_u32 v5, v0, 2, 2
    v_and_b32 v7, 1, v2
    v_lshl_or_b32 v7, v7, 2, v5
    s_lshl_b32 s12, s15, 1
    v_xor_b32 v7, s12, v7
    v_lshl_add_u32 v8, v2, 3, v5
    v_lshlrev_b32 v8, 8, v8
    v_lshl_add_u32 v8, v232, 3, v8
    v_lshl_add_u32 v233, v7, 5, v8
    v_xor_b32 v234, 32, v233
    v_add_u32 v235, 81920, v233
    v_add_u32 v236, 81920, v234
    v_add_u32 v237, 147456, v233
    v_add_u32 v238, 147456, v234
    v_add_u32 v239, 65536, v233
    v_add_u32 v240, 65536, v234
    s_lshl_b32 s12, s44, 14
    s_lshl_b32 s11, s45, 10
    s_add_u32 s12, s12, s11
    s_add_u32 s12, s12, 65536
    v_lshl_add_u32 v241, v0, 4, s12
    s_lshl_b32 s60, s3, 10
    s_add_u32 s60, s60, 81920
    v_and_b32 v1, 15, v0
    v_lshlrev_b32 v3, 10, v2
    v_lshl_add_u32 v3, v1, 4, v3
    s_lshl_b32 s14, s16, 9
    s_add_u32 s14, s14, 81920
    v_add_u32 v242, s14, v3
    v_add_u32 v243, 49152, v242
    s_lshl_b32 s14, s45, 6
    s_lshl_b32 s11, s16, 5
    s_add_u32 s11, s14, s11
    v_add_u32 v3, s11, v1
    v_lshl_add_u32 v3, v3, 1, s44
    v_mul_u32_u24 v3, 2560, v3
    v_and_b32 v4, 1, v2
    v_lshlrev_b32 v4, 5, v4
    v_and_b32 v5, 2, v2
    v_lshl_add_u32 v4, v5, 3, v4
    s_lshl_b32 s11, s46, 8
    s_lshl_b32 s15, s15, 6
    s_add_u32 s11, s11, s15
    s_add_u32 s11, s11, 1280
    v_add3_u32 v244, v3, v4, s11
    v_add_u32 v245, 81920, v244
    s_mul_i32 s15, s14, 5958
    s_lshr_b32 s15, s15, 19
    s_add_u32 s14, s14, 63
    s_mul_i32 s14, s14, 5958
    s_lshr_b32 s14, s14, 19
    v_mov_b32 v3, s15
    v_mov_b32 v4, s14
    v_cmp_gt_u32 vcc, 32, v0
    s_mul_i32 s14, s44, 12
    v_bfe_u32 v1, v0, 2, 3
    v_cndmask_b32 v3, v4, v3, vcc
    v_add_u32 v3, s14, v3
    v_lshl_add_u32 v3, v3, 3, v1
    v_lshlrev_b32 v3, 7, v3
    v_min_u32 v1, 0, v232
    v_lshl_add_u32 v3, v1, 16, v3
    v_add_u32 v246, 4096, v3
    s_mul_i32 s61, s6, 12
    s_add_u32 s61, s61, s7
    s_lshl_b32 s61, s61, 3
    s_add_u32 s61, s61, s8
    s_lshl_b32 s61, s61, 7
    s_lshl_b32 s11, s3, 15
    s_mul_i32 s11, s11, 0
    s_add_u32 s61, s61, s11
    s_add_u32 s61, s61, 4096
    v_mov_b32 v252, 252
    s_cmp_lg_u32 s3, 3
    s_cbranch_scc1 L_nw3
    s_getpc_b64 s[16:17]
L_pc:
    s_sub_u32 s16, s16, L_pc - L_start
    s_subb_u32 s17, s17, 0
    s_and_b32 s18, s5, 7
    s_lshl_b32 s18, s18, 13
    v_lshl_add_u32 v15, v0, 7, s18
    v_min_u32 v15, L_end - L_start, v15
    global_load_dword v255, v15, s[16:17]
    v_mul_u32_u24 v1, 0x289000, v0
    v_add_u32 v1, 0xf000, v1
    v_mul_u32_u24 v2, 2099200, v0
    v_add_u32 v2, 1280, v2
    buffer_load_dword v255, v1, s[36:39], 0 offen
    buffer_load_dword v255, v2, s[32:35], 0 offen
    buffer_load_dword v255, v0, s[28:31], 0 offen
    s_cmp_lg_u32 s2, 0
    s_cbranch_scc1 L_nw3
    v_mov_b32 v10, 0
    buffer_load_dword v11, v10, s[36:39], 0 offen sc1
    s_waitcnt vmcnt(0)
    v_add_u32 v11, 1, v11
    v_or_b32 v11, 0x80000000, v11
    s_mov_b64 exec, 1
    buffer_store_dword v11, v252, s[40:43], 0 offen sc1
    buffer_store_dword v11, v10, s[36:39], 0 offen sc1
    s_mov_b64 exec, -1
L_nw3:
    v_and_b32 v1, 15, v0
    v_lshrrev_b32 v2, 4, v0
    v_lshrrev_b32 v3, 1, v1
    v_xor_b32 v3, v3, v2
    v_lshlrev_b32 v4, 7, v1
    v_lshl_add_u32 v16, v3, 4, v4
    v_xor_b32 v17, 64, v16
    v_add_u32 v18, 90112, v16
    v_add_u32 v19, 90112, v17
    v_bfe_u32 v5, v0, 2, 2
    v_and_b32 v6, 3, v0
    v_and_b32 v7, 1, v2
    v_lshl_or_b32 v7, v7, 2, v5
    s_lshl_b32 s12, s3, 2
    v_xor_b32 v7, s12, v7
    v_lshl_add_u32 v8, v2, 3, v5
    v_lshlrev_b32 v8, 9, v8
    v_lshl_add_u32 v8, v6, 3, v8
    v_add_u32 v8, 12288, v8
    v_xor_b32 v9, 0, v7
    v_lshl_add_u32 v20, v9, 5, v8
    v_add_u32 v24, 90112, v20
    v_xor_b32 v9, 1, v7
    v_lshl_add_u32 v21, v9, 5, v8
    v_add_u32 v25, 90112, v21
    v_xor_b32 v9, 2, v7
    v_lshl_add_u32 v22, v9, 5, v8
    v_add_u32 v26, 90112, v22
    v_xor_b32 v9, 3, v7
    v_lshl_add_u32 v23, v9, 5, v8
    v_add_u32 v27, 90112, v23
    s_lshl_b32 s12, s3, 7
    v_mul_u32_u24 v28, 520, v1
    v_lshl_add_u32 v28, v2, 3, v28
    v_add_u32 v28, s12, v28
    s_barrier
    ds_read_b64_tr_b16 v[56:57], v20 offset:0
    ds_read_b64_tr_b16 v[58:59], v20 offset:2048
    ds_read_b128 v[32:35], v16 offset:0
    ds_read_b128 v[36:39], v16 offset:2048
    ds_read_b128 v[40:43], v16 offset:4096
    ds_read_b128 v[44:47], v16 offset:6144
    ds_read_b128 v[48:51], v16 offset:8192
    ds_read_b128 v[52:55], v16 offset:10240
    ds_read_b64_tr_b16 v[60:61], v21 offset:0
    ds_read_b64_tr_b16 v[62:63], v21 offset:2048
    ds_read_b64_tr_b16 v[64:65], v22 offset:0
    ds_read_b64_tr_b16 v[66:67], v22 offset:2048
    ds_read_b64_tr_b16 v[68:69], v23 offset:0
    ds_read_b64_tr_b16 v[70:71], v23 offset:2048
    s_waitcnt lgkmcnt(0)
    v_mfma_f32_16x16x32_bf16 v[128:131], v[56:59], v[32:35], 0
    ds_read_b64_tr_b16 v[96:97], v20 offset:16384
    v_mfma_f32_16x16x32_bf16 v[132:135], v[56:59], v[36:39], 0
    ds_read_b64_tr_b16 v[98:99], v20 offset:18432
    v_mfma_f32_16x16x32_bf16 v[136:139], v[56:59], v[40:43], 0
    ds_read_b128 v[72:75], v17 offset:0
    v_mfma_f32_16x16x32_bf16 v[140:143], v[56:59], v[44:47], 0
    ds_read_b128 v[76:79], v17 offset:2048
    v_mfma_f32_16x16x32_bf16 v[144:147], v[56:59], v[48:51], 0
    ds_read_b128 v[80:83], v17 offset:4096
    v_mfma_f32_16x16x32_bf16 v[148:151], v[56:59], v[52:55], 0
    ds_read_b128 v[84:87], v17 offset:6144
    v_mfma_f32_16x16x32_bf16 v[152:155], v[60:63], v[32:35], 0
    ds_read_b128 v[88:91], v17 offset:8192
    v_mfma_f32_16x16x32_bf16 v[156:159], v[60:63], v[36:39], 0
    ds_read_b128 v[92:95], v17 offset:10240
    v_mfma_f32_16x16x32_bf16 v[160:163], v[60:63], v[40:43], 0
    ds_read_b64_tr_b16 v[100:101], v21 offset:16384
    v_mfma_f32_16x16x32_bf16 v[164:167], v[60:63], v[44:47], 0
    ds_read_b64_tr_b16 v[102:103], v21 offset:18432
    v_mfma_f32_16x16x32_bf16 v[168:171], v[60:63], v[48:51], 0
    ds_read_b64_tr_b16 v[104:105], v22 offset:16384
    v_mfma_f32_16x16x32_bf16 v[172:175], v[60:63], v[52:55], 0
    ds_read_b64_tr_b16 v[106:107], v22 offset:18432
    v_mfma_f32_16x16x32_bf16 v[176:179], v[64:67], v[32:35], 0
    ds_read_b64_tr_b16 v[108:109], v23 offset:16384
    v_mfma_f32_16x16x32_bf16 v[180:183], v[64:67], v[36:39], 0
    ds_read_b64_tr_b16 v[110:111], v23 offset:18432
    v_mfma_f32_16x16x32_bf16 v[184:187], v[64:67], v[40:43], 0
    v_mfma_f32_16x16x32_bf16 v[188:191], v[64:67], v[44:47], 0
    v_mfma_f32_16x16x32_bf16 v[192:195], v[64:67], v[48:51], 0
    v_mfma_f32_16x16x32_bf16 v[196:199], v[64:67], v[52:55], 0
    s_cmp_ge_u32 s3, 3
    s_cbranch_scc1 L_sk_30
    v_mfma_f32_16x16x32_bf16 v[200:203], v[68:71], v[32:35], 0
    v_mfma_f32_16x16x32_bf16 v[204:207], v[68:71], v[36:39], 0
    v_mfma_f32_16x16x32_bf16 v[208:211], v[68:71], v[40:43], 0
    v_mfma_f32_16x16x32_bf16 v[212:215], v[68:71], v[44:47], 0
    v_mfma_f32_16x16x32_bf16 v[216:219], v[68:71], v[48:51], 0
    v_mfma_f32_16x16x32_bf16 v[220:223], v[68:71], v[52:55], 0
L_sk_30:
    s_waitcnt lgkmcnt(0)
    s_barrier
    v_mfma_f32_16x16x32_bf16 v[128:131], v[96:99], v[72:75], v[128:131]
    ds_read_b64_tr_b16 v[56:57], v20 offset:45056
    v_mfma_f32_16x16x32_bf16 v[132:135], v[96:99], v[76:79], v[132:135]
    ds_read_b64_tr_b16 v[58:59], v20 offset:47104
    v_mfma_f32_16x16x32_bf16 v[136:139], v[96:99], v[80:83], v[136:139]
    ds_read_b128 v[32:35], v16 offset:45056
    v_mfma_f32_16x16x32_bf16 v[140:143], v[96:99], v[84:87], v[140:143]
    ds_read_b128 v[36:39], v16 offset:47104
    v_mfma_f32_16x16x32_bf16 v[144:147], v[96:99], v[88:91], v[144:147]
    ds_read_b128 v[40:43], v16 offset:49152
    v_mfma_f32_16x16x32_bf16 v[148:151], v[96:99], v[92:95], v[148:151]
    ds_read_b128 v[44:47], v16 offset:51200
    v_mfma_f32_16x16x32_bf16 v[152:155], v[100:103], v[72:75], v[152:155]
    ds_read_b128 v[48:51], v16 offset:53248
    v_mfma_f32_16x16x32_bf16 v[156:159], v[100:103], v[76:79], v[156:159]
    ds_read_b128 v[52:55], v16 offset:55296
    v_mfma_f32_16x16x32_bf16 v[160:163], v[100:103], v[80:83], v[160:163]
    ds_read_b64_tr_b16 v[60:61], v21 offset:45056
    v_mfma_f32_16x16x32_bf16 v[164:167], v[100:103], v[84:87], v[164:167]
    ds_read_b64_tr_b16 v[62:63], v21 offset:47104
    v_mfma_f32_16x16x32_bf16 v[168:171], v[100:103], v[88:91], v[168:171]
    ds_read_b64_tr_b16 v[64:65], v22 offset:45056
    v_mfma_f32_16x16x32_bf16 v[172:175], v[100:103], v[92:95], v[172:175]
    ds_read_b64_tr_b16 v[66:67], v22 offset:47104
    v_mfma_f32_16x16x32_bf16 v[176:179], v[104:107], v[72:75], v[176:179]
    ds_read_b64_tr_b16 v[68:69], v23 offset:45056
    v_mfma_f32_16x16x32_bf16 v[180:183], v[104:107], v[76:79], v[180:183]
    ds_read_b64_tr_b16 v[70:71], v23 offset:47104
    v_mfma_f32_16x16x32_bf16 v[184:187], v[104:107], v[80:83], v[184:187]
    v_mfma_f32_16x16x32_bf16 v[188:191], v[104:107], v[84:87], v[188:191]
    v_mfma_f32_16x16x32_bf16 v[192:195], v[104:107], v[88:91], v[192:195]
    v_mfma_f32_16x16x32_bf16 v[196:199], v[104:107], v[92:95], v[196:199]
    s_cmp_ge_u32 s3, 3
    s_cbranch_scc1 L_sk_31
    v_mfma_f32_16x16x32_bf16 v[200:203], v[108:111], v[72:75], v[200:203]
    v_mfma_f32_16x16x32_bf16 v[204:207], v[108:111], v[76:79], v[204:207]
    v_mfma_f32_16x16x32_bf16 v[208:211], v[108:111], v[80:83], v[208:211]
    v_mfma_f32_16x16x32_bf16 v[212:215], v[108:111], v[84:87], v[212:215]
    v_mfma_f32_16x16x32_bf16 v[216:219], v[108:111], v[88:91], v[216:219]
    v_mfma_f32_16x16x32_bf16 v[220:223], v[108:111], v[92:95], v[220:223]
L_sk_31:
    s_waitcnt lgkmcnt(0)
    v_mfma_f32_16x16x32_bf16 v[128:131], v[56:59], v[32:35], v[128:131]
    ds_read_b64_tr_b16 v[96:97], v20 offset:61440
    v_mfma_f32_16x16x32_bf16 v[132:135], v[56:59], v[36:39], v[132:135]
    ds_read_b64_tr_b16 v[98:99], v20 offset:63488
    v_mfma_f32_16x16x32_bf16 v[136:139], v[56:59], v[40:43], v[136:139]
    ds_read_b128 v[72:75], v17 offset:45056
    v_mfma_f32_16x16x32_bf16 v[140:143], v[56:59], v[44:47], v[140:143]
    ds_read_b128 v[76:79], v17 offset:47104
    v_mfma_f32_16x16x32_bf16 v[144:147], v[56:59], v[48:51], v[144:147]
    ds_read_b128 v[80:83], v17 offset:49152
    v_mfma_f32_16x16x32_bf16 v[148:151], v[56:59], v[52:55], v[148:151]
    ds_read_b128 v[84:87], v17 offset:51200
    v_mfma_f32_16x16x32_bf16 v[152:155], v[60:63], v[32:35], v[152:155]
    ds_read_b128 v[88:91], v17 offset:53248
    v_mfma_f32_16x16x32_bf16 v[156:159], v[60:63], v[36:39], v[156:159]
    ds_read_b128 v[92:95], v17 offset:55296
    v_mfma_f32_16x16x32_bf16 v[160:163], v[60:63], v[40:43], v[160:163]
    ds_read_b64_tr_b16 v[100:101], v21 offset:61440
    v_mfma_f32_16x16x32_bf16 v[164:167], v[60:63], v[44:47], v[164:167]
    ds_read_b64_tr_b16 v[102:103], v21 offset:63488
    v_mfma_f32_16x16x32_bf16 v[168:171], v[60:63], v[48:51], v[168:171]
    ds_read_b64_tr_b16 v[104:105], v22 offset:61440
    v_mfma_f32_16x16x32_bf16 v[172:175], v[60:63], v[52:55], v[172:175]
    ds_read_b64_tr_b16 v[106:107], v22 offset:63488
    v_mfma_f32_16x16x32_bf16 v[176:179], v[64:67], v[32:35], v[176:179]
    ds_read_b64_tr_b16 v[108:109], v23 offset:61440
    v_mfma_f32_16x16x32_bf16 v[180:183], v[64:67], v[36:39], v[180:183]
    ds_read_b64_tr_b16 v[110:111], v23 offset:63488
    v_mfma_f32_16x16x32_bf16 v[184:187], v[64:67], v[40:43], v[184:187]
    v_mfma_f32_16x16x32_bf16 v[188:191], v[64:67], v[44:47], v[188:191]
    v_mfma_f32_16x16x32_bf16 v[192:195], v[64:67], v[48:51], v[192:195]
    v_mfma_f32_16x16x32_bf16 v[196:199], v[64:67], v[52:55], v[196:199]
    s_cmp_ge_u32 s3, 3
    s_cbranch_scc1 L_sk_32
    v_mfma_f32_16x16x32_bf16 v[200:203], v[68:71], v[32:35], v[200:203]
    v_mfma_f32_16x16x32_bf16 v[204:207], v[68:71], v[36:39], v[204:207]
    v_mfma_f32_16x16x32_bf16 v[208:211], v[68:71], v[40:43], v[208:211]
    v_mfma_f32_16x16x32_bf16 v[212:215], v[68:71], v[44:47], v[212:215]
    v_mfma_f32_16x16x32_bf16 v[216:219], v[68:71], v[48:51], v[216:219]
    v_mfma_f32_16x16x32_bf16 v[220:223], v[68:71], v[52:55], v[220:223]
L_sk_32:
    s_waitcnt lgkmcnt(0)
    s_barrier
    v_mfma_f32_16x16x32_bf16 v[128:131], v[96:99], v[72:75], v[128:131]
    ds_read_b64_tr_b16 v[56:57], v24 offset:0
    v_mfma_f32_16x16x32_bf16 v[132:135], v[96:99], v[76:79], v[132:135]
    ds_read_b64_tr_b16 v[58:59], v24 offset:2048
    v_mfma_f32_16x16x32_bf16 v[136:139], v[96:99], v[80:83], v[136:139]
    ds_read_b128 v[32:35], v18 offset:0
    v_mfma_f32_16x16x32_bf16 v[140:143], v[96:99], v[84:87], v[140:143]
    ds_read_b128 v[36:39], v18 offset:2048
    v_mfma_f32_16x16x32_bf16 v[144:147], v[96:99], v[88:91], v[144:147]
    ds_read_b128 v[40:43], v18 offset:4096
    v_mfma_f32_16x16x32_bf16 v[148:151], v[96:99], v[92:95], v[148:151]
    ds_read_b128 v[44:47], v18 offset:6144
    v_mfma_f32_16x16x32_bf16 v[152:155], v[100:103], v[72:75], v[152:155]
    ds_read_b128 v[48:51], v18 offset:8192
    v_mfma_f32_16x16x32_bf16 v[156:159], v[100:103], v[76:79], v[156:159]
    ds_read_b128 v[52:55], v18 offset:10240
    v_mfma_f32_16x16x32_bf16 v[160:163], v[100:103], v[80:83], v[160:163]
    ds_read_b64_tr_b16 v[60:61], v25 offset:0
    v_mfma_f32_16x16x32_bf16 v[164:167], v[100:103], v[84:87], v[164:167]
    ds_read_b64_tr_b16 v[62:63], v25 offset:2048
    v_mfma_f32_16x16x32_bf16 v[168:171], v[100:103], v[88:91], v[168:171]
    ds_read_b64_tr_b16 v[64:65], v26 offset:0
    v_mfma_f32_16x16x32_bf16 v[172:175], v[100:103], v[92:95], v[172:175]
    ds_read_b64_tr_b16 v[66:67], v26 offset:2048
    v_mfma_f32_16x16x32_bf16 v[176:179], v[104:107], v[72:75], v[176:179]
    ds_read_b64_tr_b16 v[68:69], v27 offset:0
    v_mfma_f32_16x16x32_bf16 v[180:183], v[104:107], v[76:79], v[180:183]
    ds_read_b64_tr_b16 v[70:71], v27 offset:2048
    v_mfma_f32_16x16x32_bf16 v[184:187], v[104:107], v[80:83], v[184:187]
    v_mfma_f32_16x16x32_bf16 v[188:191], v[104:107], v[84:87], v[188:191]
    v_mfma_f32_16x16x32_bf16 v[192:195], v[104:107], v[88:91], v[192:195]
    v_mfma_f32_16x16x32_bf16 v[196:199], v[104:107], v[92:95], v[196:199]
    s_cmp_ge_u32 s3, 3
    s_cbranch_scc1 L_sk_33
    v_mfma_f32_16x16x32_bf16 v[200:203], v[108:111], v[72:75], v[200:203]
    v_mfma_f32_16x16x32_bf16 v[204:207], v[108:111], v[76:79], v[204:207]
    v_mfma_f32_16x16x32_bf16 v[208:211], v[108:111], v[80:83], v[208:211]
    v_mfma_f32_16x16x32_bf16 v[212:215], v[108:111], v[84:87], v[212:215]
    v_mfma_f32_16x16x32_bf16 v[216:219], v[108:111], v[88:91], v[216:219]
    v_mfma_f32_16x16x32_bf16 v[220:223], v[108:111], v[92:95], v[220:223]
L_sk_33:
    s_waitcnt lgkmcnt(0)
    v_mfma_f32_16x16x32_bf16 v[128:131], v[56:59], v[32:35], v[128:131]
    ds_read_b64_tr_b16 v[96:97], v24 offset:16384
    v_mfma_f32_16x16x32_bf16 v[132:135], v[56:59], v[36:39], v[132:135]
    ds_read_b64_tr_b16 v[98:99], v24 offset:18432
    v_mfma_f32_16x16x32_bf16 v[136:139], v[56:59], v[40:43], v[136:139]
    ds_read_b128 v[72:75], v19 offset:0
    v_mfma_f32_16x16x32_bf16 v[140:143], v[56:59], v[44:47], v[140:143]
    ds_read_b128 v[76:79], v19 offset:2048
    v_mfma_f32_16x16x32_bf16 v[144:147], v[56:59], v[48:51], v[144:147]
    ds_read_b128 v[80:83], v19 offset:4096
    v_mfma_f32_16x16x32_bf16 v[148:151], v[56:59], v[52:55], v[148:151]
    ds_read_b128 v[84:87], v19 offset:6144
    v_mfma_f32_16x16x32_bf16 v[152:155], v[60:63], v[32:35], v[152:155]
    ds_read_b128 v[88:91], v19 offset:8192
    v_mfma_f32_16x16x32_bf16 v[156:159], v[60:63], v[36:39], v[156:159]
    ds_read_b128 v[92:95], v19 offset:10240
    v_mfma_f32_16x16x32_bf16 v[160:163], v[60:63], v[40:43], v[160:163]
    ds_read_b64_tr_b16 v[100:101], v25 offset:16384
    v_mfma_f32_16x16x32_bf16 v[164:167], v[60:63], v[44:47], v[164:167]
    ds_read_b64_tr_b16 v[102:103], v25 offset:18432
    v_mfma_f32_16x16x32_bf16 v[168:171], v[60:63], v[48:51], v[168:171]
    ds_read_b64_tr_b16 v[104:105], v26 offset:16384
    v_mfma_f32_16x16x32_bf16 v[172:175], v[60:63], v[52:55], v[172:175]
    ds_read_b64_tr_b16 v[106:107], v26 offset:18432
    v_mfma_f32_16x16x32_bf16 v[176:179], v[64:67], v[32:35], v[176:179]
    ds_read_b64_tr_b16 v[108:109], v27 offset:16384
    v_mfma_f32_16x16x32_bf16 v[180:183], v[64:67], v[36:39], v[180:183]
    ds_read_b64_tr_b16 v[110:111], v27 offset:18432
    v_mfma_f32_16x16x32_bf16 v[184:187], v[64:67], v[40:43], v[184:187]
    v_mfma_f32_16x16x32_bf16 v[188:191], v[64:67], v[44:47], v[188:191]
    v_mfma_f32_16x16x32_bf16 v[192:195], v[64:67], v[48:51], v[192:195]
    v_mfma_f32_16x16x32_bf16 v[196:199], v[64:67], v[52:55], v[196:199]
    s_cmp_ge_u32 s3, 3
    s_cbranch_scc1 L_sk_34
    v_mfma_f32_16x16x32_bf16 v[200:203], v[68:71], v[32:35], v[200:203]
    v_mfma_f32_16x16x32_bf16 v[204:207], v[68:71], v[36:39], v[204:207]
    v_mfma_f32_16x16x32_bf16 v[208:211], v[68:71], v[40:43], v[208:211]
    v_mfma_f32_16x16x32_bf16 v[212:215], v[68:71], v[44:47], v[212:215]
    v_mfma_f32_16x16x32_bf16 v[216:219], v[68:71], v[48:51], v[216:219]
    v_mfma_f32_16x16x32_bf16 v[220:223], v[68:71], v[52:55], v[220:223]
L_sk_34:
    s_waitcnt lgkmcnt(0)
    s_barrier
    v_mfma_f32_16x16x32_bf16 v[128:131], v[96:99], v[72:75], v[128:131]
    ds_read_b64_tr_b16 v[56:57], v20 offset:0
    v_mfma_f32_16x16x32_bf16 v[132:135], v[96:99], v[76:79], v[132:135]
    ds_read_b64_tr_b16 v[58:59], v20 offset:2048
    v_mfma_f32_16x16x32_bf16 v[136:139], v[96:99], v[80:83], v[136:139]
    ds_read_b128 v[32:35], v16 offset:0
    v_mfma_f32_16x16x32_bf16 v[140:143], v[96:99], v[84:87], v[140:143]
    ds_read_b128 v[36:39], v16 offset:2048
    v_mfma_f32_16x16x32_bf16 v[144:147], v[96:99], v[88:91], v[144:147]
    ds_read_b128 v[40:43], v16 offset:4096
    v_mfma_f32_16x16x32_bf16 v[148:151], v[96:99], v[92:95], v[148:151]
    ds_read_b128 v[44:47], v16 offset:6144
    v_mfma_f32_16x16x32_bf16 v[152:155], v[100:103], v[72:75], v[152:155]
    ds_read_b128 v[48:51], v16 offset:8192
    v_mfma_f32_16x16x32_bf16 v[156:159], v[100:103], v[76:79], v[156:159]
    ds_read_b128 v[52:55], v16 offset:10240
    v_mfma_f32_16x16x32_bf16 v[160:163], v[100:103], v[80:83], v[160:163]
    ds_read_b64_tr_b16 v[60:61], v21 offset:0
    v_mfma_f32_16x16x32_bf16 v[164:167], v[100:103], v[84:87], v[164:167]
    ds_read_b64_tr_b16 v[62:63], v21 offset:2048
    v_mfma_f32_16x16x32_bf16 v[168:171], v[100:103], v[88:91], v[168:171]
    ds_read_b64_tr_b16 v[64:65], v22 offset:0
    v_mfma_f32_16x16x32_bf16 v[172:175], v[100:103], v[92:95], v[172:175]
    ds_read_b64_tr_b16 v[66:67], v22 offset:2048
    v_mfma_f32_16x16x32_bf16 v[176:179], v[104:107], v[72:75], v[176:179]
    ds_read_b64_tr_b16 v[68:69], v23 offset:0
    v_mfma_f32_16x16x32_bf16 v[180:183], v[104:107], v[76:79], v[180:183]
    ds_read_b64_tr_b16 v[70:71], v23 offset:2048
    v_mfma_f32_16x16x32_bf16 v[184:187], v[104:107], v[80:83], v[184:187]
    v_mfma_f32_16x16x32_bf16 v[188:191], v[104:107], v[84:87], v[188:191]
    v_mfma_f32_16x16x32_bf16 v[192:195], v[104:107], v[88:91], v[192:195]
    v_mfma_f32_16x16x32_bf16 v[196:199], v[104:107], v[92:95], v[196:199]
    s_cmp_ge_u32 s3, 3
    s_cbranch_scc1 L_sk_35
    v_mfma_f32_16x16x32_bf16 v[200:203], v[108:111], v[72:75], v[200:203]
    v_mfma_f32_16x16x32_bf16 v[204:207], v[108:111], v[76:79], v[204:207]
    v_mfma_f32_16x16x32_bf16 v[208:211], v[108:111], v[80:83], v[208:211]
    v_mfma_f32_16x16x32_bf16 v[212:215], v[108:111], v[84:87], v[212:215]
    v_mfma_f32_16x16x32_bf16 v[216:219], v[108:111], v[88:91], v[216:219]
    v_mfma_f32_16x16x32_bf16 v[220:223], v[108:111], v[92:95], v[220:223]
L_sk_35:
    s_waitcnt lgkmcnt(0)
    v_mfma_f32_16x16x32_bf16 v[128:131], v[56:59], v[32:35], v[128:131]
    ds_read_b64_tr_b16 v[96:97], v20 offset:16384
    v_mfma_f32_16x16x32_bf16 v[132:135], v[56:59], v[36:39], v[132:135]
    ds_read_b64_tr_b16 v[98:99], v20 offset:18432
    v_mfma_f32_16x16x32_bf16 v[136:139], v[56:59], v[40:43], v[136:139]
    ds_read_b128 v[72:75], v17 offset:0
    v_mfma_f32_16x16x32_bf16 v[140:143], v[56:59], v[44:47], v[140:143]
    ds_read_b128 v[76:79], v17 offset:2048
    v_mfma_f32_16x16x32_bf16 v[144:147], v[56:59], v[48:51], v[144:147]
    ds_read_b128 v[80:83], v17 offset:4096
    v_mfma_f32_16x16x32_bf16 v[148:151], v[56:59], v[52:55], v[148:151]
    ds_read_b128 v[84:87], v17 offset:6144
    v_mfma_f32_16x16x32_bf16 v[152:155], v[60:63], v[32:35], v[152:155]
    ds_read_b128 v[88:91], v17 offset:8192
    v_mfma_f32_16x16x32_bf16 v[156:159], v[60:63], v[36:39], v[156:159]
    ds_read_b128 v[92:95], v17 offset:10240
    v_mfma_f32_16x16x32_bf16 v[160:163], v[60:63], v[40:43], v[160:163]
    ds_read_b64_tr_b16 v[100:101], v21 offset:16384
    v_mfma_f32_16x16x32_bf16 v[164:167], v[60:63], v[44:47], v[164:167]
    ds_read_b64_tr_b16 v[102:103], v21 offset:18432
    v_mfma_f32_16x16x32_bf16 v[168:171], v[60:63], v[48:51], v[168:171]
    ds_read_b64_tr_b16 v[104:105], v22 offset:16384
    v_mfma_f32_16x16x32_bf16 v[172:175], v[60:63], v[52:55], v[172:175]
    ds_read_b64_tr_b16 v[106:107], v22 offset:18432
    v_mfma_f32_16x16x32_bf16 v[176:179], v[64:67], v[32:35], v[176:179]
    ds_read_b64_tr_b16 v[108:109], v23 offset:16384
    v_mfma_f32_16x16x32_bf16 v[180:183], v[64:67], v[36:39], v[180:183]
    ds_read_b64_tr_b16 v[110:111], v23 offset:18432
    v_mfma_f32_16x16x32_bf16 v[184:187], v[64:67], v[40:43], v[184:187]
    v_mfma_f32_16x16x32_bf16 v[188:191], v[64:67], v[44:47], v[188:191]
    v_mfma_f32_16x16x32_bf16 v[192:195], v[64:67], v[48:51], v[192:195]
    v_mfma_f32_16x16x32_bf16 v[196:199], v[64:67], v[52:55], v[196:199]
    s_cmp_ge_u32 s3, 3
    s_cbranch_scc1 L_sk_36
    v_mfma_f32_16x16x32_bf16 v[200:203], v[68:71], v[32:35], v[200:203]
    v_mfma_f32_16x16x32_bf16 v[204:207], v[68:71], v[36:39], v[204:207]
    v_mfma_f32_16x16x32_bf16 v[208:211], v[68:71], v[40:43], v[208:211]
    v_mfma_f32_16x16x32_bf16 v[212:215], v[68:71], v[44:47], v[212:215]
    v_mfma_f32_16x16x32_bf16 v[216:219], v[68:71], v[48:51], v[216:219]
    v_mfma_f32_16x16x32_bf16 v[220:223], v[68:71], v[52:55], v[220:223]
L_sk_36:
    s_waitcnt lgkmcnt(0)
    s_barrier
    v_mfma_f32_16x16x32_bf16 v[128:131], v[96:99], v[72:75], v[128:131]
    ds_read_b64_tr_b16 v[56:57], v20 offset:45056
    v_mfma_f32_16x16x32_bf16 v[132:135], v[96:99], v[76:79], v[132:135]
    ds_read_b64_tr_b16 v[58:59], v20 offset:47104
    v_mfma_f32_16x16x32_bf16 v[136:139], v[96:99], v[80:83], v[136:139]
    ds_read_b128 v[32:35], v16 offset:45056
    v_mfma_f32_16x16x32_bf16 v[140:143], v[96:99], v[84:87], v[140:143]
    ds_read_b128 v[36:39], v16 offset:47104
    v_mfma_f32_16x16x32_bf16 v[144:147], v[96:99], v[88:91], v[144:147]
    ds_read_b128 v[40:43], v16 offset:49152
    v_mfma_f32_16x16x32_bf16 v[148:151], v[96:99], v[92:95], v[148:151]
    ds_read_b128 v[44:47], v16 offset:51200
    v_mfma_f32_16x16x32_bf16 v[152:155], v[100:103], v[72:75], v[152:155]
    ds_read_b128 v[48:51], v16 offset:53248
    v_mfma_f32_16x16x32_bf16 v[156:159], v[100:103], v[76:79], v[156:159]
    ds_read_b128 v[52:55], v16 offset:55296
    v_mfma_f32_16x16x32_bf16 v[160:163], v[100:103], v[80:83], v[160:163]
    ds_read_b64_tr_b16 v[60:61], v21 offset:45056
    v_mfma_f32_16x16x32_bf16 v[164:167], v[100:103], v[84:87], v[164:167]
    ds_read_b64_tr_b16 v[62:63], v21 offset:47104
    v_mfma_f32_16x16x32_bf16 v[168:171], v[100:103], v[88:91], v[168:171]
    ds_read_b64_tr_b16 v[64:65], v22 offset:45056
    v_mfma_f32_16x16x32_bf16 v[172:175], v[100:103], v[92:95], v[172:175]
    ds_read_b64_tr_b16 v[66:67], v22 offset:47104
    v_mfma_f32_16x16x32_bf16 v[176:179], v[104:107], v[72:75], v[176:179]
    ds_read_b64_tr_b16 v[68:69], v23 offset:45056
    v_mfma_f32_16x16x32_bf16 v[180:183], v[104:107], v[76:79], v[180:183]
    ds_read_b64_tr_b16 v[70:71], v23 offset:47104
    v_mfma_f32_16x16x32_bf16 v[184:187], v[104:107], v[80:83], v[184:187]
    v_mfma_f32_16x16x32_bf16 v[188:191], v[104:107], v[84:87], v[188:191]
    v_mfma_f32_16x16x32_bf16 v[192:195], v[104:107], v[88:91], v[192:195]
    v_mfma_f32_16x16x32_bf16 v[196:199], v[104:107], v[92:95], v[196:199]
    s_cmp_ge_u32 s3, 3
    s_cbranch_scc1 L_sk_37
    v_mfma_f32_16x16x32_bf16 v[200:203], v[108:111], v[72:75], v[200:203]
    v_mfma_f32_16x16x32_bf16 v[204:207], v[108:111], v[76:79], v[204:207]
    v_mfma_f32_16x16x32_bf16 v[208:211], v[108:111], v[80:83], v[208:211]
    v_mfma_f32_16x16x32_bf16 v[212:215], v[108:111], v[84:87], v[212:215]
    v_mfma_f32_16x16x32_bf16 v[216:219], v[108:111], v[88:91], v[216:219]
    v_mfma_f32_16x16x32_bf16 v[220:223], v[108:111], v[92:95], v[220:223]
L_sk_37:
    s_waitcnt lgkmcnt(0)
    v_mfma_f32_16x16x32_bf16 v[128:131], v[56:59], v[32:35], v[128:131]
    ds_read_b64_tr_b16 v[96:97], v20 offset:61440
    v_mfma_f32_16x16x32_bf16 v[132:135], v[56:59], v[36:39], v[132:135]
    ds_read_b64_tr_b16 v[98:99], v20 offset:63488
    v_mfma_f32_16x16x32_bf16 v[136:139], v[56:59], v[40:43], v[136:139]
    ds_read_b128 v[72:75], v17 offset:45056
    v_mfma_f32_16x16x32_bf16 v[140:143], v[56:59], v[44:47], v[140:143]
    ds_read_b128 v[76:79], v17 offset:47104
    v_mfma_f32_16x16x32_bf16 v[144:147], v[56:59], v[48:51], v[144:147]
    ds_read_b128 v[80:83], v17 offset:49152
    v_mfma_f32_16x16x32_bf16 v[148:151], v[56:59], v[52:55], v[148:151]
    ds_read_b128 v[84:87], v17 offset:51200
    v_mfma_f32_16x16x32_bf16 v[152:155], v[60:63], v[32:35], v[152:155]
    ds_read_b128 v[88:91], v17 offset:53248
    v_mfma_f32_16x16x32_bf16 v[156:159], v[60:63], v[36:39], v[156:159]
    ds_read_b128 v[92:95], v17 offset:55296
    v_mfma_f32_16x16x32_bf16 v[160:163], v[60:63], v[40:43], v[160:163]
    ds_read_b64_tr_b16 v[100:101], v21 offset:61440
    v_mfma_f32_16x16x32_bf16 v[164:167], v[60:63], v[44:47], v[164:167]
    ds_read_b64_tr_b16 v[102:103], v21 offset:63488
    v_mfma_f32_16x16x32_bf16 v[168:171], v[60:63], v[48:51], v[168:171]
    ds_read_b64_tr_b16 v[104:105], v22 offset:61440
    v_mfma_f32_16x16x32_bf16 v[172:175], v[60:63], v[52:55], v[172:175]
    ds_read_b64_tr_b16 v[106:107], v22 offset:63488
    v_mfma_f32_16x16x32_bf16 v[176:179], v[64:67], v[32:35], v[176:179]
    ds_read_b64_tr_b16 v[108:109], v23 offset:61440
    v_mfma_f32_16x16x32_bf16 v[180:183], v[64:67], v[36:39], v[180:183]
    ds_read_b64_tr_b16 v[110:111], v23 offset:63488
    v_mfma_f32_16x16x32_bf16 v[184:187], v[64:67], v[40:43], v[184:187]
    v_mfma_f32_16x16x32_bf16 v[188:191], v[64:67], v[44:47], v[188:191]
    v_mfma_f32_16x16x32_bf16 v[192:195], v[64:67], v[48:51], v[192:195]
    v_mfma_f32_16x16x32_bf16 v[196:199], v[64:67], v[52:55], v[196:199]
    s_cmp_ge_u32 s3, 3
    s_cbranch_scc1 L_sk_38
    v_mfma_f32_16x16x32_bf16 v[200:203], v[68:71], v[32:35], v[200:203]
    v_mfma_f32_16x16x32_bf16 v[204:207], v[68:71], v[36:39], v[204:207]
    v_mfma_f32_16x16x32_bf16 v[208:211], v[68:71], v[40:43], v[208:211]
    v_mfma_f32_16x16x32_bf16 v[212:215], v[68:71], v[44:47], v[212:215]
    v_mfma_f32_16x16x32_bf16 v[216:219], v[68:71], v[48:51], v[216:219]
    v_mfma_f32_16x16x32_bf16 v[220:223], v[68:71], v[52:55], v[220:223]
L_sk_38:
    s_waitcnt lgkmcnt(0)
    s_barrier
    v_mfma_f32_16x16x32_bf16 v[128:131], v[96:99], v[72:75], v[128:131]
    ds_read_b64_tr_b16 v[56:57], v24 offset:0
    v_mfma_f32_16x16x32_bf16 v[132:135], v[96:99], v[76:79], v[132:135]
    ds_read_b64_tr_b16 v[58:59], v24 offset:2048
    v_mfma_f32_16x16x32_bf16 v[136:139], v[96:99], v[80:83], v[136:139]
    ds_read_b128 v[32:35], v18 offset:0
    v_mfma_f32_16x16x32_bf16 v[140:143], v[96:99], v[84:87], v[140:143]
    ds_read_b128 v[36:39], v18 offset:2048
    v_mfma_f32_16x16x32_bf16 v[144:147], v[96:99], v[88:91], v[144:147]
    ds_read_b128 v[40:43], v18 offset:4096
    v_mfma_f32_16x16x32_bf16 v[148:151], v[96:99], v[92:95], v[148:151]
    ds_read_b128 v[44:47], v18 offset:6144
    v_mfma_f32_16x16x32_bf16 v[152:155], v[100:103], v[72:75], v[152:155]
    ds_read_b128 v[48:51], v18 offset:8192
    v_mfma_f32_16x16x32_bf16 v[156:159], v[100:103], v[76:79], v[156:159]
    ds_read_b128 v[52:55], v18 offset:10240
    v_mfma_f32_16x16x32_bf16 v[160:163], v[100:103], v[80:83], v[160:163]
    ds_read_b64_tr_b16 v[60:61], v25 offset:0
    v_mfma_f32_16x16x32_bf16 v[164:167], v[100:103], v[84:87], v[164:167]
    ds_read_b64_tr_b16 v[62:63], v25 offset:2048
    v_mfma_f32_16x16x32_bf16 v[168:171], v[100:103], v[88:91], v[168:171]
    ds_read_b64_tr_b16 v[64:65], v26 offset:0
    v_mfma_f32_16x16x32_bf16 v[172:175], v[100:103], v[92:95], v[172:175]
    ds_read_b64_tr_b16 v[66:67], v26 offset:2048
    v_mfma_f32_16x16x32_bf16 v[176:179], v[104:107], v[72:75], v[176:179]
    ds_read_b64_tr_b16 v[68:69], v27 offset:0
    v_mfma_f32_16x16x32_bf16 v[180:183], v[104:107], v[76:79], v[180:183]
    ds_read_b64_tr_b16 v[70:71], v27 offset:2048
    v_mfma_f32_16x16x32_bf16 v[184:187], v[104:107], v[80:83], v[184:187]
    v_mfma_f32_16x16x32_bf16 v[188:191], v[104:107], v[84:87], v[188:191]
    v_mfma_f32_16x16x32_bf16 v[192:195], v[104:107], v[88:91], v[192:195]
    v_mfma_f32_16x16x32_bf16 v[196:199], v[104:107], v[92:95], v[196:199]
    s_cmp_ge_u32 s3, 3
    s_cbranch_scc1 L_sk_39
    v_mfma_f32_16x16x32_bf16 v[200:203], v[108:111], v[72:75], v[200:203]
    v_mfma_f32_16x16x32_bf16 v[204:207], v[108:111], v[76:79], v[204:207]
    v_mfma_f32_16x16x32_bf16 v[208:211], v[108:111], v[80:83], v[208:211]
    v_mfma_f32_16x16x32_bf16 v[212:215], v[108:111], v[84:87], v[212:215]
    v_mfma_f32_16x16x32_bf16 v[216:219], v[108:111], v[88:91], v[216:219]
    v_mfma_f32_16x16x32_bf16 v[220:223], v[108:111], v[92:95], v[220:223]
L_sk_39:
    s_waitcnt lgkmcnt(0)
    v_mfma_f32_16x16x32_bf16 v[128:131], v[56:59], v[32:35], v[128:131]
    ds_read_b64_tr_b16 v[96:97], v24 offset:16384
    v_mfma_f32_16x16x32_bf16 v[132:135], v[56:59], v[36:39], v[132:135]
    ds_read_b64_tr_b16 v[98:99], v24 offset:18432
    v_mfma_f32_16x16x32_bf16 v[136:139], v[56:59], v[40:43], v[136:139]
    ds_read_b128 v[72:75], v19 offset:0
    v_mfma_f32_16x16x32_bf16 v[140:143], v[56:59], v[44:47], v[140:143]
    ds_read_b128 v[76:79], v19 offset:2048
    v_mfma_f32_16x16x32_bf16 v[144:147], v[56:59], v[48:51], v[144:147]
    ds_read_b128 v[80:83], v19 offset:4096
    v_mfma_f32_16x16x32_bf16 v[148:151], v[56:59], v[52:55], v[148:151]
    ds_read_b128 v[84:87], v19 offset:6144
    v_mfma_f32_16x16x32_bf16 v[152:155], v[60:63], v[32:35], v[152:155]
    ds_read_b128 v[88:91], v19 offset:8192
    v_mfma_f32_16x16x32_bf16 v[156:159], v[60:63], v[36:39], v[156:159]
    ds_read_b128 v[92:95], v19 offset:10240
    v_mfma_f32_16x16x32_bf16 v[160:163], v[60:63], v[40:43], v[160:163]
    ds_read_b64_tr_b16 v[100:101], v25 offset:16384
    v_mfma_f32_16x16x32_bf16 v[164:167], v[60:63], v[44:47], v[164:167]
    ds_read_b64_tr_b16 v[102:103], v25 offset:18432
    v_mfma_f32_16x16x32_bf16 v[168:171], v[60:63], v[48:51], v[168:171]
    ds_read_b64_tr_b16 v[104:105], v26 offset:16384
    v_mfma_f32_16x16x32_bf16 v[172:175], v[60:63], v[52:55], v[172:175]
    ds_read_b64_tr_b16 v[106:107], v26 offset:18432
    v_mfma_f32_16x16x32_bf16 v[176:179], v[64:67], v[32:35], v[176:179]
    ds_read_b64_tr_b16 v[108:109], v27 offset:16384
    v_mfma_f32_16x16x32_bf16 v[180:183], v[64:67], v[36:39], v[180:183]
    ds_read_b64_tr_b16 v[110:111], v27 offset:18432
    v_mfma_f32_16x16x32_bf16 v[184:187], v[64:67], v[40:43], v[184:187]
    v_mfma_f32_16x16x32_bf16 v[188:191], v[64:67], v[44:47], v[188:191]
    v_mfma_f32_16x16x32_bf16 v[192:195], v[64:67], v[48:51], v[192:195]
    v_mfma_f32_16x16x32_bf16 v[196:199], v[64:67], v[52:55], v[196:199]
    s_cmp_ge_u32 s3, 3
    s_cbranch_scc1 L_sk_40
    v_mfma_f32_16x16x32_bf16 v[200:203], v[68:71], v[32:35], v[200:203]
    v_mfma_f32_16x16x32_bf16 v[204:207], v[68:71], v[36:39], v[204:207]
    v_mfma_f32_16x16x32_bf16 v[208:211], v[68:71], v[40:43], v[208:211]
    v_mfma_f32_16x16x32_bf16 v[212:215], v[68:71], v[44:47], v[212:215]
    v_mfma_f32_16x16x32_bf16 v[216:219], v[68:71], v[48:51], v[216:219]
    v_mfma_f32_16x16x32_bf16 v[220:223], v[68:71], v[52:55], v[220:223]
L_sk_40:
    s_waitcnt lgkmcnt(0)
    s_barrier
    v_mfma_f32_16x16x32_bf16 v[128:131], v[96:99], v[72:75], v[128:131]
    ds_read_b64_tr_b16 v[56:57], v20 offset:0
    v_mfma_f32_16x16x32_bf16 v[132:135], v[96:99], v[76:79], v[132:135]
    ds_read_b64_tr_b16 v[58:59], v20 offset:2048
    v_mfma_f32_16x16x32_bf16 v[136:139], v[96:99], v[80:83], v[136:139]
    ds_read_b128 v[32:35], v16 offset:0
    v_mfma_f32_16x16x32_bf16 v[140:143], v[96:99], v[84:87], v[140:143]
    ds_read_b128 v[36:39], v16 offset:2048
    v_mfma_f32_16x16x32_bf16 v[144:147], v[96:99], v[88:91], v[144:147]
    ds_read_b128 v[40:43], v16 offset:4096
    v_mfma_f32_16x16x32_bf16 v[148:151], v[96:99], v[92:95], v[148:151]
    ds_read_b128 v[44:47], v16 offset:6144
    v_mfma_f32_16x16x32_bf16 v[152:155], v[100:103], v[72:75], v[152:155]
    ds_read_b128 v[48:51], v16 offset:8192
    v_mfma_f32_16x16x32_bf16 v[156:159], v[100:103], v[76:79], v[156:159]
    ds_read_b128 v[52:55], v16 offset:10240
    v_mfma_f32_16x16x32_bf16 v[160:163], v[100:103], v[80:83], v[160:163]
    ds_read_b64_tr_b16 v[60:61], v21 offset:0
    v_mfma_f32_16x16x32_bf16 v[164:167], v[100:103], v[84:87], v[164:167]
    ds_read_b64_tr_b16 v[62:63], v21 offset:2048
    v_mfma_f32_16x16x32_bf16 v[168:171], v[100:103], v[88:91], v[168:171]
    ds_read_b64_tr_b16 v[64:65], v22 offset:0
    v_mfma_f32_16x16x32_bf16 v[172:175], v[100:103], v[92:95], v[172:175]
    ds_read_b64_tr_b16 v[66:67], v22 offset:2048
    v_mfma_f32_16x16x32_bf16 v[176:179], v[104:107], v[72:75], v[176:179]
    ds_read_b64_tr_b16 v[68:69], v23 offset:0
    v_mfma_f32_16x16x32_bf16 v[180:183], v[104:107], v[76:79], v[180:183]
    ds_read_b64_tr_b16 v[70:71], v23 offset:2048
    v_mfma_f32_16x16x32_bf16 v[184:187], v[104:107], v[80:83], v[184:187]
    v_mfma_f32_16x16x32_bf16 v[188:191], v[104:107], v[84:87], v[188:191]
    v_mfma_f32_16x16x32_bf16 v[192:195], v[104:107], v[88:91], v[192:195]
    v_mfma_f32_16x16x32_bf16 v[196:199], v[104:107], v[92:95], v[196:199]
    s_cmp_ge_u32 s3, 3
    s_cbranch_scc1 L_sk_41
    v_mfma_f32_16x16x32_bf16 v[200:203], v[108:111], v[72:75], v[200:203]
    v_mfma_f32_16x16x32_bf16 v[204:207], v[108:111], v[76:79], v[204:207]
    v_mfma_f32_16x16x32_bf16 v[208:211], v[108:111], v[80:83], v[208:211]
    v_mfma_f32_16x16x32_bf16 v[212:215], v[108:111], v[84:87], v[212:215]
    v_mfma_f32_16x16x32_bf16 v[216:219], v[108:111], v[88:91], v[216:219]
    v_mfma_f32_16x16x32_bf16 v[220:223], v[108:111], v[92:95], v[220:223]
L_sk_41:
    s_waitcnt lgkmcnt(0)
    v_mfma_f32_16x16x32_bf16 v[128:131], v[56:59], v[32:35], v[128:131]
    ds_read_b64_tr_b16 v[96:97], v20 offset:16384
    v_mfma_f32_16x16x32_bf16 v[132:135], v[56:59], v[36:39], v[132:135]
    ds_read_b64_tr_b16 v[98:99], v20 offset:18432
    v_mfma_f32_16x16x32_bf16 v[136:139], v[56:59], v[40:43], v[136:139]
    ds_read_b128 v[72:75], v17 offset:0
    v_mfma_f32_16x16x32_bf16 v[140:143], v[56:59], v[44:47], v[140:143]
    ds_read_b128 v[76:79], v17 offset:2048
    v_mfma_f32_16x16x32_bf16 v[144:147], v[56:59], v[48:51], v[144:147]
    ds_read_b128 v[80:83], v17 offset:4096
    v_mfma_f32_16x16x32_bf16 v[148:151], v[56:59], v[52:55], v[148:151]
    ds_read_b128 v[84:87], v17 offset:6144
    v_mfma_f32_16x16x32_bf16 v[152:155], v[60:63], v[32:35], v[152:155]
    ds_read_b128 v[88:91], v17 offset:8192
    v_mfma_f32_16x16x32_bf16 v[156:159], v[60:63], v[36:39], v[156:159]
    ds_read_b128 v[92:95], v17 offset:10240
    v_mfma_f32_16x16x32_bf16 v[160:163], v[60:63], v[40:43], v[160:163]
    ds_read_b64_tr_b16 v[100:101], v21 offset:16384
    v_mfma_f32_16x16x32_bf16 v[164:167], v[60:63], v[44:47], v[164:167]
    ds_read_b64_tr_b16 v[102:103], v21 offset:18432
    v_mfma_f32_16x16x32_bf16 v[168:171], v[60:63], v[48:51], v[168:171]
    ds_read_b64_tr_b16 v[104:105], v22 offset:16384
    v_mfma_f32_16x16x32_bf16 v[172:175], v[60:63], v[52:55], v[172:175]
    ds_read_b64_tr_b16 v[106:107], v22 offset:18432
    v_mfma_f32_16x16x32_bf16 v[176:179], v[64:67], v[32:35], v[176:179]
    ds_read_b64_tr_b16 v[108:109], v23 offset:16384
    v_mfma_f32_16x16x32_bf16 v[180:183], v[64:67], v[36:39], v[180:183]
    ds_read_b64_tr_b16 v[110:111], v23 offset:18432
    v_mfma_f32_16x16x32_bf16 v[184:187], v[64:67], v[40:43], v[184:187]
    v_mfma_f32_16x16x32_bf16 v[188:191], v[64:67], v[44:47], v[188:191]
    v_mfma_f32_16x16x32_bf16 v[192:195], v[64:67], v[48:51], v[192:195]
    v_mfma_f32_16x16x32_bf16 v[196:199], v[64:67], v[52:55], v[196:199]
    s_cmp_ge_u32 s3, 3
    s_cbranch_scc1 L_sk_42
    v_mfma_f32_16x16x32_bf16 v[200:203], v[68:71], v[32:35], v[200:203]
    v_mfma_f32_16x16x32_bf16 v[204:207], v[68:71], v[36:39], v[204:207]
    v_mfma_f32_16x16x32_bf16 v[208:211], v[68:71], v[40:43], v[208:211]
    v_mfma_f32_16x16x32_bf16 v[212:215], v[68:71], v[44:47], v[212:215]
    v_mfma_f32_16x16x32_bf16 v[216:219], v[68:71], v[48:51], v[216:219]
    v_mfma_f32_16x16x32_bf16 v[220:223], v[68:71], v[52:55], v[220:223]
L_sk_42:
    s_waitcnt lgkmcnt(0)
    s_barrier
    v_mfma_f32_16x16x32_bf16 v[128:131], v[96:99], v[72:75], v[128:131]
    ds_read_b64_tr_b16 v[56:57], v20 offset:45056
    v_mfma_f32_16x16x32_bf16 v[132:135], v[96:99], v[76:79], v[132:135]
    ds_read_b64_tr_b16 v[58:59], v20 offset:47104
    v_mfma_f32_16x16x32_bf16 v[136:139], v[96:99], v[80:83], v[136:139]
    ds_read_b128 v[32:35], v16 offset:45056
    v_mfma_f32_16x16x32_bf16 v[140:143], v[96:99], v[84:87], v[140:143]
    ds_read_b128 v[36:39], v16 offset:47104
    v_mfma_f32_16x16x32_bf16 v[144:147], v[96:99], v[88:91], v[144:147]
    ds_read_b128 v[40:43], v16 offset:49152
    v_mfma_f32_16x16x32_bf16 v[148:151], v[96:99], v[92:95], v[148:151]
    ds_read_b128 v[44:47], v16 offset:51200
    v_mfma_f32_16x16x32_bf16 v[152:155], v[100:103], v[72:75], v[152:155]
    ds_read_b128 v[48:51], v16 offset:53248
    v_mfma_f32_16x16x32_bf16 v[156:159], v[100:103], v[76:79], v[156:159]
    ds_read_b128 v[52:55], v16 offset:55296
    v_mfma_f32_16x16x32_bf16 v[160:163], v[100:103], v[80:83], v[160:163]
    ds_read_b64_tr_b16 v[60:61], v21 offset:45056
    v_mfma_f32_16x16x32_bf16 v[164:167], v[100:103], v[84:87], v[164:167]
    ds_read_b64_tr_b16 v[62:63], v21 offset:47104
    v_mfma_f32_16x16x32_bf16 v[168:171], v[100:103], v[88:91], v[168:171]
    ds_read_b64_tr_b16 v[64:65], v22 offset:45056
    v_mfma_f32_16x16x32_bf16 v[172:175], v[100:103], v[92:95], v[172:175]
    ds_read_b64_tr_b16 v[66:67], v22 offset:47104
    v_mfma_f32_16x16x32_bf16 v[176:179], v[104:107], v[72:75], v[176:179]
    ds_read_b64_tr_b16 v[68:69], v23 offset:45056
    v_mfma_f32_16x16x32_bf16 v[180:183], v[104:107], v[76:79], v[180:183]
    ds_read_b64_tr_b16 v[70:71], v23 offset:47104
    v_mfma_f32_16x16x32_bf16 v[184:187], v[104:107], v[80:83], v[184:187]
    v_mfma_f32_16x16x32_bf16 v[188:191], v[104:107], v[84:87], v[188:191]
    v_mfma_f32_16x16x32_bf16 v[192:195], v[104:107], v[88:91], v[192:195]
    v_mfma_f32_16x16x32_bf16 v[196:199], v[104:107], v[92:95], v[196:199]
    s_cmp_ge_u32 s3, 3
    s_cbranch_scc1 L_sk_43
    v_mfma_f32_16x16x32_bf16 v[200:203], v[108:111], v[72:75], v[200:203]
    v_mfma_f32_16x16x32_bf16 v[204:207], v[108:111], v[76:79], v[204:207]
    v_mfma_f32_16x16x32_bf16 v[208:211], v[108:111], v[80:83], v[208:211]
    v_mfma_f32_16x16x32_bf16 v[212:215], v[108:111], v[84:87], v[212:215]
    v_mfma_f32_16x16x32_bf16 v[216:219], v[108:111], v[88:91], v[216:219]
    v_mfma_f32_16x16x32_bf16 v[220:223], v[108:111], v[92:95], v[220:223]
L_sk_43:
    s_waitcnt lgkmcnt(0)
    v_mfma_f32_16x16x32_bf16 v[128:131], v[56:59], v[32:35], v[128:131]
    ds_read_b64_tr_b16 v[96:97], v20 offset:61440
    v_mfma_f32_16x16x32_bf16 v[132:135], v[56:59], v[36:39], v[132:135]
    ds_read_b64_tr_b16 v[98:99], v20 offset:63488
    v_mfma_f32_16x16x32_bf16 v[136:139], v[56:59], v[40:43], v[136:139]
    ds_read_b128 v[72:75], v17 offset:45056
    v_mfma_f32_16x16x32_bf16 v[140:143], v[56:59], v[44:47], v[140:143]
    ds_read_b128 v[76:79], v17 offset:47104
    v_mfma_f32_16x16x32_bf16 v[144:147], v[56:59], v[48:51], v[144:147]
    ds_read_b128 v[80:83], v17 offset:49152
    v_mfma_f32_16x16x32_bf16 v[148:151], v[56:59], v[52:55], v[148:151]
    ds_read_b128 v[84:87], v17 offset:51200
    v_mfma_f32_16x16x32_bf16 v[152:155], v[60:63], v[32:35], v[152:155]
    ds_read_b128 v[88:91], v17 offset:53248
    v_mfma_f32_16x16x32_bf16 v[156:159], v[60:63], v[36:39], v[156:159]
    ds_read_b128 v[92:95], v17 offset:55296
    v_mfma_f32_16x16x32_bf16 v[160:163], v[60:63], v[40:43], v[160:163]
    ds_read_b64_tr_b16 v[100:101], v21 offset:61440
    v_mfma_f32_16x16x32_bf16 v[164:167], v[60:63], v[44:47], v[164:167]
    ds_read_b64_tr_b16 v[102:103], v21 offset:63488
    v_mfma_f32_16x16x32_bf16 v[168:171], v[60:63], v[48:51], v[168:171]
    ds_read_b64_tr_b16 v[104:105], v22 offset:61440
    v_mfma_f32_16x16x32_bf16 v[172:175], v[60:63], v[52:55], v[172:175]
    ds_read_b64_tr_b16 v[106:107], v22 offset:63488
    v_mfma_f32_16x16x32_bf16 v[176:179], v[64:67], v[32:35], v[176:179]
    ds_read_b64_tr_b16 v[108:109], v23 offset:61440
    v_mfma_f32_16x16x32_bf16 v[180:183], v[64:67], v[36:39], v[180:183]
    ds_read_b64_tr_b16 v[110:111], v23 offset:63488
    v_mfma_f32_16x16x32_bf16 v[184:187], v[64:67], v[40:43], v[184:187]
    v_mfma_f32_16x16x32_bf16 v[188:191], v[64:67], v[44:47], v[188:191]
    v_mfma_f32_16x16x32_bf16 v[192:195], v[64:67], v[48:51], v[192:195]
    v_mfma_f32_16x16x32_bf16 v[196:199], v[64:67], v[52:55], v[196:199]
    s_cmp_ge_u32 s3, 3
    s_cbranch_scc1 L_sk_44
    v_mfma_f32_16x16x32_bf16 v[200:203], v[68:71], v[32:35], v[200:203]
    v_mfma_f32_16x16x32_bf16 v[204:207], v[68:71], v[36:39], v[204:207]
    v_mfma_f32_16x16x32_bf16 v[208:211], v[68:71], v[40:43], v[208:211]
    v_mfma_f32_16x16x32_bf16 v[212:215], v[68:71], v[44:47], v[212:215]
    v_mfma_f32_16x16x32_bf16 v[216:219], v[68:71], v[48:51], v[216:219]
    v_mfma_f32_16x16x32_bf16 v[220:223], v[68:71], v[52:55], v[220:223]
L_sk_44:
    s_waitcnt lgkmcnt(0)
    s_barrier
    v_mfma_f32_16x16x32_bf16 v[128:131], v[96:99], v[72:75], v[128:131]
    ds_read_b64_tr_b16 v[56:57], v24 offset:0
    v_mfma_f32_16x16x32_bf16 v[132:135], v[96:99], v[76:79], v[132:135]
    ds_read_b64_tr_b16 v[58:59], v24 offset:2048
    v_mfma_f32_16x16x32_bf16 v[136:139], v[96:99], v[80:83], v[136:139]
    ds_read_b128 v[32:35], v18 offset:0
    v_mfma_f32_16x16x32_bf16 v[140:143], v[96:99], v[84:87], v[140:143]
    ds_read_b128 v[36:39], v18 offset:2048
    v_mfma_f32_16x16x32_bf16 v[144:147], v[96:99], v[88:91], v[144:147]
    ds_read_b128 v[40:43], v18 offset:4096
    v_mfma_f32_16x16x32_bf16 v[148:151], v[96:99], v[92:95], v[148:151]
    ds_read_b128 v[44:47], v18 offset:6144
    v_mfma_f32_16x16x32_bf16 v[152:155], v[100:103], v[72:75], v[152:155]
    ds_read_b128 v[48:51], v18 offset:8192
    v_mfma_f32_16x16x32_bf16 v[156:159], v[100:103], v[76:79], v[156:159]
    ds_read_b128 v[52:55], v18 offset:10240
    v_mfma_f32_16x16x32_bf16 v[160:163], v[100:103], v[80:83], v[160:163]
    ds_read_b64_tr_b16 v[60:61], v25 offset:0
    v_mfma_f32_16x16x32_bf16 v[164:167], v[100:103], v[84:87], v[164:167]
    ds_read_b64_tr_b16 v[62:63], v25 offset:2048
    v_mfma_f32_16x16x32_bf16 v[168:171], v[100:103], v[88:91], v[168:171]
    ds_read_b64_tr_b16 v[64:65], v26 offset:0
    v_mfma_f32_16x16x32_bf16 v[172:175], v[100:103], v[92:95], v[172:175]
    ds_read_b64_tr_b16 v[66:67], v26 offset:2048
    v_mfma_f32_16x16x32_bf16 v[176:179], v[104:107], v[72:75], v[176:179]
    ds_read_b64_tr_b16 v[68:69], v27 offset:0
    v_mfma_f32_16x16x32_bf16 v[180:183], v[104:107], v[76:79], v[180:183]
    ds_read_b64_tr_b16 v[70:71], v27 offset:2048
    v_mfma_f32_16x16x32_bf16 v[184:187], v[104:107], v[80:83], v[184:187]
    v_mfma_f32_16x16x32_bf16 v[188:191], v[104:107], v[84:87], v[188:191]
    v_mfma_f32_16x16x32_bf16 v[192:195], v[104:107], v[88:91], v[192:195]
    v_mfma_f32_16x16x32_bf16 v[196:199], v[104:107], v[92:95], v[196:199]
    s_cmp_ge_u32 s3, 3
    s_cbranch_scc1 L_sk_45
    v_mfma_f32_16x16x32_bf16 v[200:203], v[108:111], v[72:75], v[200:203]
    v_mfma_f32_16x16x32_bf16 v[204:207], v[108:111], v[76:79], v[204:207]
    v_mfma_f32_16x16x32_bf16 v[208:211], v[108:111], v[80:83], v[208:211]
    v_mfma_f32_16x16x32_bf16 v[212:215], v[108:111], v[84:87], v[212:215]
    v_mfma_f32_16x16x32_bf16 v[216:219], v[108:111], v[88:91], v[216:219]
    v_mfma_f32_16x16x32_bf16 v[220:223], v[108:111], v[92:95], v[220:223]
L_sk_45:
    s_waitcnt lgkmcnt(0)
    v_mfma_f32_16x16x32_bf16 v[128:131], v[56:59], v[32:35], v[128:131]
    ds_read_b64_tr_b16 v[96:97], v24 offset:16384
    v_mfma_f32_16x16x32_bf16 v[132:135], v[56:59], v[36:39], v[132:135]
    ds_read_b64_tr_b16 v[98:99], v24 offset:18432
    v_mfma_f32_16x16x32_bf16 v[136:139], v[56:59], v[40:43], v[136:139]
    ds_read_b128 v[72:75], v19 offset:0
    v_mfma_f32_16x16x32_bf16 v[140:143], v[56:59], v[44:47], v[140:143]
    ds_read_b128 v[76:79], v19 offset:2048
    v_mfma_f32_16x16x32_bf16 v[144:147], v[56:59], v[48:51], v[144:147]
    ds_read_b128 v[80:83], v19 offset:4096
    v_mfma_f32_16x16x32_bf16 v[148:151], v[56:59], v[52:55], v[148:151]
    ds_read_b128 v[84:87], v19 offset:6144
    v_mfma_f32_16x16x32_bf16 v[152:155], v[60:63], v[32:35], v[152:155]
    ds_read_b128 v[88:91], v19 offset:8192
    v_mfma_f32_16x16x32_bf16 v[156:159], v[60:63], v[36:39], v[156:159]
    ds_read_b128 v[92:95], v19 offset:10240
    v_mfma_f32_16x16x32_bf16 v[160:163], v[60:63], v[40:43], v[160:163]
    ds_read_b64_tr_b16 v[100:101], v25 offset:16384
    v_mfma_f32_16x16x32_bf16 v[164:167], v[60:63], v[44:47], v[164:167]
    ds_read_b64_tr_b16 v[102:103], v25 offset:18432
    v_mfma_f32_16x16x32_bf16 v[168:171], v[60:63], v[48:51], v[168:171]
    ds_read_b64_tr_b16 v[104:105], v26 offset:16384
    v_mfma_f32_16x16x32_bf16 v[172:175], v[60:63], v[52:55], v[172:175]
    ds_read_b64_tr_b16 v[106:107], v26 offset:18432
    v_mfma_f32_16x16x32_bf16 v[176:179], v[64:67], v[32:35], v[176:179]
    ds_read_b64_tr_b16 v[108:109], v27 offset:16384
    v_mfma_f32_16x16x32_bf16 v[180:183], v[64:67], v[36:39], v[180:183]
    ds_read_b64_tr_b16 v[110:111], v27 offset:18432
    v_mfma_f32_16x16x32_bf16 v[184:187], v[64:67], v[40:43], v[184:187]
    v_mfma_f32_16x16x32_bf16 v[188:191], v[64:67], v[44:47], v[188:191]
    v_mfma_f32_16x16x32_bf16 v[192:195], v[64:67], v[48:51], v[192:195]
    v_mfma_f32_16x16x32_bf16 v[196:199], v[64:67], v[52:55], v[196:199]
    s_cmp_ge_u32 s3, 3
    s_cbranch_scc1 L_sk_46
    v_mfma_f32_16x16x32_bf16 v[200:203], v[68:71], v[32:35], v[200:203]
    v_mfma_f32_16x16x32_bf16 v[204:207], v[68:71], v[36:39], v[204:207]
    v_mfma_f32_16x16x32_bf16 v[208:211], v[68:71], v[40:43], v[208:211]
    v_mfma_f32_16x16x32_bf16 v[212:215], v[68:71], v[44:47], v[212:215]
    v_mfma_f32_16x16x32_bf16 v[216:219], v[68:71], v[48:51], v[216:219]
    v_mfma_f32_16x16x32_bf16 v[220:223], v[68:71], v[52:55], v[220:223]
L_sk_46:
    s_waitcnt lgkmcnt(0)
    s_barrier
    v_mfma_f32_16x16x32_bf16 v[128:131], v[96:99], v[72:75], v[128:131]
    ds_read_b64_tr_b16 v[56:57], v20 offset:0
    v_mfma_f32_16x16x32_bf16 v[132:135], v[96:99], v[76:79], v[132:135]
    ds_read_b64_tr_b16 v[58:59], v20 offset:2048
    v_mfma_f32_16x16x32_bf16 v[136:139], v[96:99], v[80:83], v[136:139]
    ds_read_b128 v[32:35], v16 offset:0
    v_mfma_f32_16x16x32_bf16 v[140:143], v[96:99], v[84:87], v[140:143]
    ds_read_b128 v[36:39], v16 offset:2048
    v_mfma_f32_16x16x32_bf16 v[144:147], v[96:99], v[88:91], v[144:147]
    ds_read_b128 v[40:43], v16 offset:4096
    v_mfma_f32_16x16x32_bf16 v[148:151], v[96:99], v[92:95], v[148:151]
    ds_read_b128 v[44:47], v16 offset:6144
    v_mfma_f32_16x16x32_bf16 v[152:155], v[100:103], v[72:75], v[152:155]
    ds_read_b128 v[48:51], v16 offset:8192
    v_mfma_f32_16x16x32_bf16 v[156:159], v[100:103], v[76:79], v[156:159]
    ds_read_b128 v[52:55], v16 offset:10240
    v_mfma_f32_16x16x32_bf16 v[160:163], v[100:103], v[80:83], v[160:163]
    ds_read_b64_tr_b16 v[60:61], v21 offset:0
    v_mfma_f32_16x16x32_bf16 v[164:167], v[100:103], v[84:87], v[164:167]
    ds_read_b64_tr_b16 v[62:63], v21 offset:2048
    v_mfma_f32_16x16x32_bf16 v[168:171], v[100:103], v[88:91], v[168:171]
    ds_read_b64_tr_b16 v[64:65], v22 offset:0
    v_mfma_f32_16x16x32_bf16 v[172:175], v[100:103], v[92:95], v[172:175]
    ds_read_b64_tr_b16 v[66:67], v22 offset:2048
    v_mfma_f32_16x16x32_bf16 v[176:179], v[104:107], v[72:75], v[176:179]
    ds_read_b64_tr_b16 v[68:69], v23 offset:0
    v_mfma_f32_16x16x32_bf16 v[180:183], v[104:107], v[76:79], v[180:183]
    ds_read_b64_tr_b16 v[70:71], v23 offset:2048
    v_mfma_f32_16x16x32_bf16 v[184:187], v[104:107], v[80:83], v[184:187]
    v_mfma_f32_16x16x32_bf16 v[188:191], v[104:107], v[84:87], v[188:191]
    v_mfma_f32_16x16x32_bf16 v[192:195], v[104:107], v[88:91], v[192:195]
    v_mfma_f32_16x16x32_bf16 v[196:199], v[104:107], v[92:95], v[196:199]
    s_cmp_ge_u32 s3, 3
    s_cbranch_scc1 L_sk_47
    v_mfma_f32_16x16x32_bf16 v[200:203], v[108:111], v[72:75], v[200:203]
    v_mfma_f32_16x16x32_bf16 v[204:207], v[108:111], v[76:79], v[204:207]
    v_mfma_f32_16x16x32_bf16 v[208:211], v[108:111], v[80:83], v[208:211]
    v_mfma_f32_16x16x32_bf16 v[212:215], v[108:111], v[84:87], v[212:215]
    v_mfma_f32_16x16x32_bf16 v[216:219], v[108:111], v[88:91], v[216:219]
    v_mfma_f32_16x16x32_bf16 v[220:223], v[108:111], v[92:95], v[220:223]
L_sk_47:
    s_waitcnt lgkmcnt(0)
    v_mfma_f32_16x16x32_bf16 v[128:131], v[56:59], v[32:35], v[128:131]
    ds_read_b64_tr_b16 v[96:97], v20 offset:16384
    v_mfma_f32_16x16x32_bf16 v[132:135], v[56:59], v[36:39], v[132:135]
    ds_read_b64_tr_b16 v[98:99], v20 offset:18432
    v_mfma_f32_16x16x32_bf16 v[136:139], v[56:59], v[40:43], v[136:139]
    ds_read_b128 v[72:75], v17 offset:0
    v_mfma_f32_16x16x32_bf16 v[140:143], v[56:59], v[44:47], v[140:143]
    ds_read_b128 v[76:79], v17 offset:2048
    v_mfma_f32_16x16x32_bf16 v[144:147], v[56:59], v[48:51], v[144:147]
    ds_read_b128 v[80:83], v17 offset:4096
    v_mfma_f32_16x16x32_bf16 v[148:151], v[56:59], v[52:55], v[148:151]
    ds_read_b128 v[84:87], v17 offset:6144
    v_mfma_f32_16x16x32_bf16 v[152:155], v[60:63], v[32:35], v[152:155]
    ds_read_b128 v[88:91], v17 offset:8192
    v_mfma_f32_16x16x32_bf16 v[156:159], v[60:63], v[36:39], v[156:159]
    ds_read_b128 v[92:95], v17 offset:10240
    v_mfma_f32_16x16x32_bf16 v[160:163], v[60:63], v[40:43], v[160:163]
    ds_read_b64_tr_b16 v[100:101], v21 offset:16384
    v_mfma_f32_16x16x32_bf16 v[164:167], v[60:63], v[44:47], v[164:167]
    ds_read_b64_tr_b16 v[102:103], v21 offset:18432
    v_mfma_f32_16x16x32_bf16 v[168:171], v[60:63], v[48:51], v[168:171]
    ds_read_b64_tr_b16 v[104:105], v22 offset:16384
    v_mfma_f32_16x16x32_bf16 v[172:175], v[60:63], v[52:55], v[172:175]
    ds_read_b64_tr_b16 v[106:107], v22 offset:18432
    v_mfma_f32_16x16x32_bf16 v[176:179], v[64:67], v[32:35], v[176:179]
    ds_read_b64_tr_b16 v[108:109], v23 offset:16384
    v_mfma_f32_16x16x32_bf16 v[180:183], v[64:67], v[36:39], v[180:183]
    ds_read_b64_tr_b16 v[110:111], v23 offset:18432
    v_mfma_f32_16x16x32_bf16 v[184:187], v[64:67], v[40:43], v[184:187]
    v_mfma_f32_16x16x32_bf16 v[188:191], v[64:67], v[44:47], v[188:191]
    v_mfma_f32_16x16x32_bf16 v[192:195], v[64:67], v[48:51], v[192:195]
    v_mfma_f32_16x16x32_bf16 v[196:199], v[64:67], v[52:55], v[196:199]
    s_cmp_ge_u32 s3, 3
    s_cbranch_scc1 L_sk9
    v_mfma_f32_16x16x32_bf16 v[200:203], v[68:71], v[32:35], v[200:203]
    v_mfma_f32_16x16x32_bf16 v[204:207], v[68:71], v[36:39], v[204:207]
    v_mfma_f32_16x16x32_bf16 v[208:211], v[68:71], v[40:43], v[208:211]
    v_mfma_f32_16x16x32_bf16 v[212:215], v[68:71], v[44:47], v[212:215]
    v_mfma_f32_16x16x32_bf16 v[216:219], v[68:71], v[48:51], v[216:219]
    v_mfma_f32_16x16x32_bf16 v[220:223], v[68:71], v[52:55], v[220:223]
L_sk9:
    s_waitcnt lgkmcnt(0)
    s_barrier
    v_mfma_f32_16x16x32_bf16 v[128:131], v[96:99], v[72:75], v[128:131]
    v_mfma_f32_16x16x32_bf16 v[152:155], v[100:103], v[72:75], v[152:155]
    v_add_u32 v8, 0, v28
    v_add_u32 v9, 8320, v28
    v_mfma_f32_16x16x32_bf16 v[132:135], v[96:99], v[76:79], v[132:135]
    v_add_u32 v10, 16640, v28
    v_add_u32 v11, 24960, v28
    v_mfma_f32_16x16x32_bf16 v[156:159], v[100:103], v[76:79], v[156:159]
    v_add_u32 v12, 33280, v28
    v_add_u32 v13, 41600, v28
    v_mfma_f32_16x16x32_bf16 v[136:139], v[96:99], v[80:83], v[136:139]
    v_cvt_pk_bf16_f32 v112, v128, v129
    v_cvt_pk_bf16_f32 v113, v130, v131
    v_cvt_pk_bf16_f32 v114, v152, v153
    v_cvt_pk_bf16_f32 v115, v154, v155
    ds_write2_b64 v8, v[112:113], v[114:115] offset0:0 offset1:4
    v_mfma_f32_16x16x32_bf16 v[160:163], v[100:103], v[80:83], v[160:163]
    v_mfma_f32_16x16x32_bf16 v[140:143], v[96:99], v[84:87], v[140:143]
    v_cvt_pk_bf16_f32 v116, v132, v133
    v_cvt_pk_bf16_f32 v117, v134, v135
    v_cvt_pk_bf16_f32 v118, v156, v157
    v_cvt_pk_bf16_f32 v119, v158, v159
    ds_write2_b64 v9, v[116:117], v[118:119] offset0:0 offset1:4
    v_mfma_f32_16x16x32_bf16 v[164:167], v[100:103], v[84:87], v[164:167]
    v_mfma_f32_16x16x32_bf16 v[144:147], v[96:99], v[88:91], v[144:147]
    v_cvt_pk_bf16_f32 v120, v136, v137
    v_cvt_pk_bf16_f32 v121, v138, v139
    v_cvt_pk_bf16_f32 v122, v160, v161
    v_cvt_pk_bf16_f32 v123, v162, v163
    ds_write2_b64 v10, v[120:121], v[122:123] offset0:0 offset1:4
    v_mfma_f32_16x16x32_bf16 v[168:171], v[100:103], v[88:91], v[168:171]
    v_mfma_f32_16x16x32_bf16 v[148:151], v[96:99], v[92:95], v[148:151]
    v_cvt_pk_bf16_f32 v124, v140, v141
    v_cvt_pk_bf16_f32 v125, v142, v143
    v_cvt_pk_bf16_f32 v126, v164, v165
    v_cvt_pk_bf16_f32 v127, v166, v167
    ds_write2_b64 v11, v[124:125], v[126:127] offset0:0 offset1:4
    v_mfma_f32_16x16x32_bf16 v[172:175], v[100:103], v[92:95], v[172:175]
    s_cmp_ge_u32 s3, 3
    s_cbranch_scc1 L_sk10
    v_mfma_f32_16x16x32_bf16 v[176:179], v[104:107], v[72:75], v[176:179]
    v_cvt_pk_bf16_f32 v112, v144, v145
    v_cvt_pk_bf16_f32 v113, v146, v147
    v_cvt_pk_bf16_f32 v114, v168, v169
    v_cvt_pk_bf16_f32 v115, v170, v171
    ds_write2_b64 v12, v[112:113], v[114:115] offset0:0 offset1:4
    v_mfma_f32_16x16x32_bf16 v[200:203], v[108:111], v[72:75], v[200:203]
    v_mfma_f32_16x16x32_bf16 v[180:183], v[104:107], v[76:79], v[180:183]
    v_cvt_pk_bf16_f32 v116, v148, v149
    v_cvt_pk_bf16_f32 v117, v150, v151
    v_cvt_pk_bf16_f32 v118, v172, v173
    v_cvt_pk_bf16_f32 v119, v174, v175
    ds_write2_b64 v13, v[116:117], v[118:119] offset0:0 offset1:4
    v_mfma_f32_16x16x32_bf16 v[204:207], v[108:111], v[76:79], v[204:207]
    v_mfma_f32_16x16x32_bf16 v[184:187], v[104:107], v[80:83], v[184:187]
    v_cvt_pk_bf16_f32 v120, v176, v177
    v_cvt_pk_bf16_f32 v121, v178, v179
    v_cvt_pk_bf16_f32 v122, v200, v201
    v_cvt_pk_bf16_f32 v123, v202, v203
    ds_write2_b64 v8, v[120:121], v[122:123] offset0:8 offset1:12
    v_mfma_f32_16x16x32_bf16 v[208:211], v[108:111], v[80:83], v[208:211]
    v_mfma_f32_16x16x32_bf16 v[188:191], v[104:107], v[84:87], v[188:191]
    v_cvt_pk_bf16_f32 v124, v180, v181
    v_cvt_pk_bf16_f32 v125, v182, v183
    v_cvt_pk_bf16_f32 v126, v204, v205
    v_cvt_pk_bf16_f32 v127, v206, v207
    ds_write2_b64 v9, v[124:125], v[126:127] offset0:8 offset1:12
    v_mfma_f32_16x16x32_bf16 v[212:215], v[108:111], v[84:87], v[212:215]
    v_mfma_f32_16x16x32_bf16 v[192:195], v[104:107], v[88:91], v[192:195]
    v_cvt_pk_bf16_f32 v112, v184, v185
    v_cvt_pk_bf16_f32 v113, v186, v187
    v_cvt_pk_bf16_f32 v114, v208, v209
    v_cvt_pk_bf16_f32 v115, v210, v211
    ds_write2_b64 v10, v[112:113], v[114:115] offset0:8 offset1:12
    v_mfma_f32_16x16x32_bf16 v[216:219], v[108:111], v[88:91], v[216:219]
    v_mfma_f32_16x16x32_bf16 v[196:199], v[104:107], v[92:95], v[196:199]
    v_cvt_pk_bf16_f32 v116, v188, v189
    v_cvt_pk_bf16_f32 v117, v190, v191
    v_cvt_pk_bf16_f32 v118, v212, v213
    v_cvt_pk_bf16_f32 v119, v214, v215
    ds_write2_b64 v11, v[116:117], v[118:119] offset0:8 offset1:12
    v_mfma_f32_16x16x32_bf16 v[220:223], v[108:111], v[92:95], v[220:223]
    s_nop 0
    v_cvt_pk_bf16_f32 v120, v192, v193
    v_cvt_pk_bf16_f32 v121, v194, v195
    v_cvt_pk_bf16_f32 v122, v216, v217
    v_cvt_pk_bf16_f32 v123, v218, v219
    ds_write2_b64 v12, v[120:121], v[122:123] offset0:8 offset1:12
    s_nop 1
    v_cvt_pk_bf16_f32 v124, v196, v197
    v_cvt_pk_bf16_f32 v125, v198, v199
    v_cvt_pk_bf16_f32 v126, v220, v221
    v_cvt_pk_bf16_f32 v127, v222, v223
    ds_write2_b64 v13, v[124:125], v[126:127] offset0:8 offset1:12
    s_branch L_sk11
L_sk10:
    v_mfma_f32_16x16x32_bf16 v[176:179], v[104:107], v[72:75], v[176:179]
    v_cvt_pk_bf16_f32 v112, v144, v145
    v_cvt_pk_bf16_f32 v113, v146, v147
    v_cvt_pk_bf16_f32 v114, v168, v169
    v_cvt_pk_bf16_f32 v115, v170, v171
    ds_write2_b64 v12, v[112:113], v[114:115] offset0:0 offset1:4
    v_mfma_f32_16x16x32_bf16 v[180:183], v[104:107], v[76:79], v[180:183]
    v_cvt_pk_bf16_f32 v116, v148, v149
    v_cvt_pk_bf16_f32 v117, v150, v151
    v_cvt_pk_bf16_f32 v118, v172, v173
    v_cvt_pk_bf16_f32 v119, v174, v175
    ds_write2_b64 v13, v[116:117], v[118:119] offset0:0 offset1:4
    v_mfma_f32_16x16x32_bf16 v[184:187], v[104:107], v[80:83], v[184:187]
    v_cvt_pk_bf16_f32 v120, v176, v177
    v_cvt_pk_bf16_f32 v121, v178, v179
    ds_write_b64 v8, v[120:121] offset:64
    v_mfma_f32_16x16x32_bf16 v[188:191], v[104:107], v[84:87], v[188:191]
    v_cvt_pk_bf16_f32 v124, v180, v181
    v_cvt_pk_bf16_f32 v125, v182, v183
    ds_write_b64 v9, v[124:125] offset:64
    v_mfma_f32_16x16x32_bf16 v[192:195], v[104:107], v[88:91], v[192:195]
    v_cvt_pk_bf16_f32 v112, v184, v185
    v_cvt_pk_bf16_f32 v113, v186, v187
    ds_write_b64 v10, v[112:113] offset:64
    v_mfma_f32_16x16x32_bf16 v[196:199], v[104:107], v[92:95], v[196:199]
    v_cvt_pk_bf16_f32 v116, v188, v189
    v_cvt_pk_bf16_f32 v117, v190, v191
    ds_write_b64 v11, v[116:117] offset:64
    s_nop 0
    v_cvt_pk_bf16_f32 v120, v192, v193
    v_cvt_pk_bf16_f32 v121, v194, v195
    ds_write_b64 v12, v[120:121] offset:64
    s_nop 0
    v_cvt_pk_bf16_f32 v124, v196, v197
    v_cvt_pk_bf16_f32 v125, v198, v199
    ds_write_b64 v13, v[124:125] offset:64
L_sk11:
    s_waitcnt lgkmcnt(0)
    s_barrier
L_attn:
    ds_read_b64 v[32:33], v224 offset:4160
    ds_read_b64 v[42:43], v224 offset:160
    ds_read_b64 v[52:53], v224 offset:2240
    ds_read_b64 v[62:63], v224 offset:4320
    ds_read_b64 v[34:35], v224 offset:4168
    ds_read_b64 v[44:45], v224 offset:168
    ds_read_b64 v[54:55], v224 offset:2248
    ds_read_b64 v[64:65], v224 offset:4328
    ds_read_b64 v[36:37], v224 offset:4176
    ds_read_b64 v[46:47], v224 offset:176
    ds_read_b64 v[56:57], v224 offset:2256
    ds_read_b64 v[66:67], v224 offset:4336
    ds_read_b64 v[38:39], v224 offset:4184
    ds_read_b64 v[48:49], v224 offset:184
    ds_read_b64 v[58:59], v224 offset:2264
    ds_read_b64 v[68:69], v224 offset:4344
    ds_read_b64 v[40:41], v224 offset:4192
    ds_read_b64 v[50:51], v224 offset:192
    ds_read_b64 v[60:61], v224 offset:2272
    ds_read_b64 v[70:71], v224 offset:4352
    s_waitcnt lgkmcnt(15)
    v_mfma_f32_4x4x4_16b_bf16 v[104:107], v[42:43], v[32:33], 0
    v_mfma_f32_4x4x4_16b_bf16 v[108:111], v[52:53], v[32:33], 0
    v_mfma_f32_4x4x4_16b_bf16 v[112:115], v[62:63], v[32:33], 0
    s_waitcnt lgkmcnt(12)
    v_mfma_f32_4x4x4_16b_bf16 v[104:107], v[44:45], v[34:35], v[104:107]
    v_mfma_f32_4x4x4_16b_bf16 v[108:111], v[54:55], v[34:35], v[108:111]
    v_mfma_f32_4x4x4_16b_bf16 v[112:115], v[64:65], v[34:35], v[112:115]
    s_waitcnt lgkmcnt(8)
    v_mfma_f32_4x4x4_16b_bf16 v[104:107], v[46:47], v[36:37], v[104:107]
    v_mfma_f32_4x4x4_16b_bf16 v[108:111], v[56:57], v[36:37], v[108:111]
    v_mfma_f32_4x4x4_16b_bf16 v[112:115], v[66:67], v[36:37], v[112:115]
    s_waitcnt lgkmcnt(4)
    v_mfma_f32_4x4x4_16b_bf16 v[104:107], v[48:49], v[38:39], v[104:107]
    v_mfma_f32_4x4x4_16b_bf16 v[108:111], v[58:59], v[38:39], v[108:111]
    v_mfma_f32_4x4x4_16b_bf16 v[112:115], v[68:69], v[38:39], v[112:115]
    s_waitcnt lgkmcnt(0)
    v_mfma_f32_4x4x4_16b_bf16 v[104:107], v[50:51], v[40:41], v[104:107]
    ds_read_b64_tr_b16 v[82:83], v225 offset:2400
    v_mfma_f32_4x4x4_16b_bf16 v[108:111], v[60:61], v[40:41], v[108:111]
    ds_read_b64_tr_b16 v[84:85], v225 offset:2408
    v_mfma_f32_4x4x4_16b_bf16 v[112:115], v[70:71], v[40:41], v[112:115]
    ds_read_b64_tr_b16 v[86:87], v225 offset:2416
    ds_read_b64_tr_b16 v[88:89], v225 offset:2424
    ds_read_b64_tr_b16 v[90:91], v225 offset:2432
    ds_read_b64_tr_b16 v[92:93], v225 offset:4480
    ds_read_b64_tr_b16 v[94:95], v225 offset:4488
    ds_read_b64_tr_b16 v[96:97], v225 offset:4496
    ds_read_b64_tr_b16 v[98:99], v225 offset:4504
    ds_read_b64_tr_b16 v[100:101], v225 offset:4512
    ds_read_b64_tr_b16 v[72:73], v225 offset:320
    ds_read_b64_tr_b16 v[74:75], v225 offset:328
    ds_read_b64_tr_b16 v[76:77], v225 offset:336
    ds_read_b64_tr_b16 v[78:79], v225 offset:344
    ds_read_b64_tr_b16 v[80:81], v225 offset:352
    buffer_load_dword v251, v252, s[40:43], 0 offen sc1
    s_cmp_lg_u32 s7, 0
    s_cselect_b32 s12, 2, s3
    s_nop 2
    v_bfi_b32 v113, v247, v113, v105
    v_bfi_b32 v114, v248, v114, v106
    v_bfi_b32 v115, v249, v115, v107
    s_cmp_ge_u32 s12, 2
    s_cbranch_scc1 L_nomask
    v_mov_b32 v17, 0xff800000
    v_add_u32 v18, 4, v232
    v_cmp_gt_u32 vcc, v18, v228
    s_nop 1
    v_cndmask_b32 v108, v108, v17, vcc
    v_subrev_u32 v18, 0, v232
    v_and_b32 v18, 7, v18
    v_cmp_gt_u32 vcc, v18, v228
    s_nop 1
    v_cndmask_b32 v112, v112, v17, vcc
    v_add_u32 v18, 3, v232
    v_cmp_gt_u32 vcc, v18, v228
    s_nop 1
    v_cndmask_b32 v109, v109, v17, vcc
    v_subrev_u32 v18, 1, v232
    v_and_b32 v18, 7, v18
    v_cmp_gt_u32 vcc, v18, v228
    s_nop 1
    v_cndmask_b32 v113, v113, v17, vcc
    v_add_u32 v18, 2, v232
    v_cmp_gt_u32 vcc, v18, v228
    s_nop 1
    v_cndmask_b32 v110, v110, v17, vcc
    v_subrev_u32 v18, 2, v232
    v_and_b32 v18, 7, v18
    v_cmp_gt_u32 vcc, v18, v228
    s_nop 1
    v_cndmask_b32 v114, v114, v17, vcc
    v_add_u32 v18, 1, v232
    v_cmp_gt_u32 vcc, v18, v228
    s_nop 1
    v_cndmask_b32 v111, v111, v17, vcc
    v_subrev_u32 v18, 3, v232
    v_and_b32 v18, 7, v18
    v_cmp_gt_u32 vcc, v18, v228
    s_nop 1
    v_cndmask_b32 v115, v115, v17, vcc
L_nomask:
    v_max3_f32 v17, v108, v109, v110
    v_max3_f32 v18, v111, v112, v113
    v_max3_f32 v17, v17, v114, v115
    v_max_f32 v17, v17, v18
    v_mul_f32 v17, v250, v17
    v_fma_f32 v108, v108, v250, -v17
    v_fma_f32 v109, v109, v250, -v17
    v_fma_f32 v110, v110, v250, -v17
    v_fma_f32 v111, v111, v250, -v17
    v_fma_f32 v112, v112, v250, -v17
    v_fma_f32 v113, v113, v250, -v17
    v_fma_f32 v114, v114, v250, -v17
    v_fma_f32 v115, v115, v250, -v17
    v_exp_f32 v108, v108
    v_exp_f32 v109, v109
    v_exp_f32 v110, v110
    v_exp_f32 v111, v111
    v_exp_f32 v112, v112
    v_exp_f32 v113, v113
    v_exp_f32 v114, v114
    v_exp_f32 v115, v115
    s_waitcnt lgkmcnt(0)
    s_barrier
    v_add_f32 v17, v108, v109
    v_add_f32 v18, v110, v111
    v_add_f32 v19, v112, v113
    v_add_f32 v20, v114, v115
    v_add_f32 v17, v17, v18
    v_add_f32 v19, v19, v20
    v_add_f32 v17, v17, v19
    v_rcp_f32 v17, v17
    s_nop 0
    v_mul_f32 v108, v108, v17
    v_mul_f32 v109, v109, v17
    v_mul_f32 v110, v110, v17
    v_mul_f32 v111, v111, v17
    v_mul_f32 v112, v112, v17
    v_mul_f32 v113, v113, v17
    v_mul_f32 v114, v114, v17
    v_mul_f32 v115, v115, v17
    v_cvt_pk_bf16_f32 v20, v108, v109
    v_cvt_pk_bf16_f32 v21, v110, v111
    v_cvt_pk_bf16_f32 v26, v112, v113
    v_cvt_pk_bf16_f32 v27, v114, v115
    v_mfma_f32_4x4x4_16b_bf16 v[32:35], v[82:83], v[20:21], 0
    v_and_b32 v22, v26, v226
    v_and_b32 v23, v27, v227
    v_mfma_f32_4x4x4_16b_bf16 v[36:39], v[84:85], v[20:21], 0
    v_xor_b32 v18, v26, v22
    v_xor_b32 v19, v27, v23
    v_mfma_f32_4x4x4_16b_bf16 v[40:43], v[86:87], v[20:21], 0
    v_mfma_f32_4x4x4_16b_bf16 v[44:47], v[88:89], v[20:21], 0
    v_mfma_f32_4x4x4_16b_bf16 v[48:51], v[90:91], v[20:21], 0
    v_mfma_f32_4x4x4_16b_bf16 v[32:35], v[92:93], v[22:23], v[32:35]
    v_mfma_f32_4x4x4_16b_bf16 v[36:39], v[94:95], v[22:23], v[36:39]
    v_mfma_f32_4x4x4_16b_bf16 v[40:43], v[96:97], v[22:23], v[40:43]
    v_mfma_f32_4x4x4_16b_bf16 v[44:47], v[98:99], v[22:23], v[44:47]
    v_mfma_f32_4x4x4_16b_bf16 v[48:51], v[100:101], v[22:23], v[48:51]
    v_mfma_f32_4x4x4_16b_bf16 v[32:35], v[72:73], v[18:19], v[32:35]
    v_mfma_f32_4x4x4_16b_bf16 v[36:39], v[74:75], v[18:19], v[36:39]
    v_mfma_f32_4x4x4_16b_bf16 v[40:43], v[76:77], v[18:19], v[40:43]
    v_mfma_f32_4x4x4_16b_bf16 v[44:47], v[78:79], v[18:19], v[44:47]
    v_mfma_f32_4x4x4_16b_bf16 v[48:51], v[80:81], v[18:19], v[48:51]
    s_nop 1
    v_cvt_pk_bf16_f32 v52, v32, v33
    v_cvt_pk_bf16_f32 v53, v34, v35
    v_cvt_pk_bf16_f32 v54, v36, v37
    v_cvt_pk_bf16_f32 v55, v38, v39
    buffer_store_dwordx4 v[52:55], v229, s[36:39], 0 offen sc1
    v_cvt_pk_bf16_f32 v56, v40, v41
    v_cvt_pk_bf16_f32 v57, v42, v43
    v_cvt_pk_bf16_f32 v58, v44, v45
    v_cvt_pk_bf16_f32 v59, v46, v47
    buffer_store_dwordx4 v[56:59], v230, s[36:39], 0 offen sc1
    v_cvt_pk_bf16_f32 v60, v48, v49
    v_cvt_pk_bf16_f32 v61, v50, v51
    v_mov_b32 v62, v60
    v_mov_b32 v63, v61
    s_nop 1
    v_permlane32_swap_b32 v60, v62
    v_permlane32_swap_b32 v61, v63
    buffer_store_dwordx4 v[60:63], v231, s[36:39], 0 offen sc1
    s_waitcnt vmcnt(3)
    s_barrier
    s_cmp_ge_u32 s5, 20
    s_cbranch_scc1 L_nor1
    ds_read_b64_tr_b16 v[64:65], v235 offset:0
    ds_read_b64_tr_b16 v[66:67], v235 offset:1024
    ds_read_b64_tr_b16 v[68:69], v236 offset:0
    ds_read_b64_tr_b16 v[70:71], v236 offset:1024
    ds_read_b64_tr_b16 v[72:73], v235 offset:8192
    ds_read_b64_tr_b16 v[74:75], v235 offset:9216
    ds_read_b64_tr_b16 v[76:77], v236 offset:8192
    ds_read_b64_tr_b16 v[78:79], v236 offset:9216
    ds_read_b64_tr_b16 v[80:81], v235 offset:16384
    ds_read_b64_tr_b16 v[82:83], v235 offset:17408
    ds_read_b64_tr_b16 v[84:85], v236 offset:16384
    ds_read_b64_tr_b16 v[86:87], v236 offset:17408
    ds_read_b64_tr_b16 v[88:89], v235 offset:24576
    ds_read_b64_tr_b16 v[90:91], v235 offset:25600
    ds_read_b64_tr_b16 v[92:93], v236 offset:24576
    ds_read_b64_tr_b16 v[94:95], v236 offset:25600
    ds_read_b64_tr_b16 v[96:97], v235 offset:32768
    ds_read_b64_tr_b16 v[98:99], v235 offset:33792
    ds_read_b64_tr_b16 v[100:101], v236 offset:32768
    ds_read_b64_tr_b16 v[102:103], v236 offset:33792
    ds_read_b64_tr_b16 v[104:105], v235 offset:40960
    ds_read_b64_tr_b16 v[106:107], v235 offset:41984
    ds_read_b64_tr_b16 v[108:109], v236 offset:40960
    ds_read_b64_tr_b16 v[110:111], v236 offset:41984
    ds_read_b64_tr_b16 v[112:113], v235 offset:49152
    ds_read_b64_tr_b16 v[114:115], v235 offset:50176
    ds_read_b64_tr_b16 v[116:117], v236 offset:49152
    ds_read_b64_tr_b16 v[118:119], v236 offset:50176
    ds_read_b64_tr_b16 v[120:121], v235 offset:57344
    ds_read_b64_tr_b16 v[122:123], v235 offset:58368
    ds_read_b64_tr_b16 v[124:125], v236 offset:57344
    ds_read_b64_tr_b16 v[126:127], v236 offset:58368
    ds_read_b64_tr_b16 v[128:129], v237 offset:0
    ds_read_b64_tr_b16 v[130:131], v237 offset:1024
    ds_read_b64_tr_b16 v[132:133], v238 offset:0
    ds_read_b64_tr_b16 v[134:135], v238 offset:1024
    ds_read_b64_tr_b16 v[136:137], v237 offset:8192
    ds_read_b64_tr_b16 v[138:139], v237 offset:9216
    ds_read_b64_tr_b16 v[140:141], v238 offset:8192
    ds_read_b64_tr_b16 v[142:143], v238 offset:9216
L_nor1:
    s_cmp_lg_u32 s3, 0
    s_cbranch_scc1 L_nep
    v_readfirstlane_b32 s56, v251
    s_mov_b32 s57, 0
L_epb:
    s_cmp_lg_u32 s56, 0
    s_cbranch_scc1 L_gotepb
    buffer_load_dword v251, v252, s[40:43], 0 offen sc1
    s_add_u32 s57, s57, 1
    s_waitcnt vmcnt(0)
    v_readfirstlane_b32 s56, v251
    s_cmp_lt_u32 s57, 262144
    s_cbranch_scc1 L_epb
L_gotepb:
    v_lshl_add_u32 v1, v0, 2, s61
    v_mov_b32 v2, s56
L_nep:
    s_waitcnt vmcnt(0)
L_b13:
    s_barrier
    s_cmp_lg_u32 s3, 0
    s_cbranch_scc1 L_noflag
    s_mov_b64 exec, 0xffffffff
    buffer_store_dword v2, v1, s[36:39], 0 offen sc1
    s_mov_b64 exec, -1
L_noflag:
    s_cmp_ge_u32 s5, 20
    s_cbranch_scc1 L_fin
L_r2:
    s_barrier
    ds_read_b64_tr_b16 v[144:145], v239 offset:8192
    ds_read_b64_tr_b16 v[146:147], v239 offset:9216
    ds_read_b64_tr_b16 v[148:149], v240 offset:8192
    ds_read_b64_tr_b16 v[150:151], v240 offset:9216
    ds_read_b64_tr_b16 v[152:153], v239 offset:0
    ds_read_b64_tr_b16 v[154:155], v239 offset:1024
    ds_read_b64_tr_b16 v[156:157], v240 offset:0
    ds_read_b64_tr_b16 v[158:159], v240 offset:1024
    ds_read_b64_tr_b16 v[160:161], v233 offset:57344
    ds_read_b64_tr_b16 v[162:163], v233 offset:58368
    ds_read_b64_tr_b16 v[164:165], v234 offset:57344
    ds_read_b64_tr_b16 v[166:167], v234 offset:58368
    ds_read_b64_tr_b16 v[168:169], v233 offset:49152
    ds_read_b64_tr_b16 v[170:171], v233 offset:50176
    ds_read_b64_tr_b16 v[172:173], v234 offset:49152
    ds_read_b64_tr_b16 v[174:175], v234 offset:50176
    ds_read_b64_tr_b16 v[176:177], v233 offset:40960
    ds_read_b64_tr_b16 v[178:179], v233 offset:41984
    ds_read_b64_tr_b16 v[180:181], v234 offset:40960
    ds_read_b64_tr_b16 v[182:183], v234 offset:41984
    ds_read_b64_tr_b16 v[184:185], v233 offset:32768
    ds_read_b64_tr_b16 v[186:187], v233 offset:33792
    ds_read_b64_tr_b16 v[188:189], v234 offset:32768
    ds_read_b64_tr_b16 v[190:191], v234 offset:33792
    ds_read_b64_tr_b16 v[192:193], v233 offset:24576
    ds_read_b64_tr_b16 v[194:195], v233 offset:25600
    ds_read_b64_tr_b16 v[196:197], v234 offset:24576
    ds_read_b64_tr_b16 v[198:199], v234 offset:25600
    ds_read_b64_tr_b16 v[200:201], v233 offset:16384
    ds_read_b64_tr_b16 v[202:203], v233 offset:17408
    ds_read_b64_tr_b16 v[204:205], v234 offset:16384
    ds_read_b64_tr_b16 v[206:207], v234 offset:17408
    ds_read_b64_tr_b16 v[208:209], v233 offset:8192
    ds_read_b64_tr_b16 v[210:211], v233 offset:9216
    ds_read_b64_tr_b16 v[212:213], v234 offset:8192
    ds_read_b64_tr_b16 v[214:215], v234 offset:9216
    ds_read_b64_tr_b16 v[216:217], v233 offset:0
    ds_read_b64_tr_b16 v[218:219], v233 offset:1024
    ds_read_b64_tr_b16 v[220:221], v234 offset:0
    ds_read_b64_tr_b16 v[222:223], v234 offset:1024
    s_cmp_lg_u32 s3, 0
    s_cbranch_scc1 L_polledb
    buffer_load_dword v4, v246, s[36:39], 0 offen sc1
    s_sleep 2
    buffer_load_dword v5, v246, s[36:39], 0 offen sc1
    s_sleep 2
    buffer_load_dword v6, v246, s[36:39], 0 offen sc1
    s_sleep 2
L_pollb:
    buffer_load_dword v7, v246, s[36:39], 0 offen sc1
    s_waitcnt vmcnt(3)
    v_cmp_ne_u32 vcc, s56, v4
    s_cbranch_vccz L_polledb
    buffer_load_dword v4, v246, s[36:39], 0 offen sc1
    s_waitcnt vmcnt(3)
    v_cmp_ne_u32 vcc, s56, v5
    s_cbranch_vccz L_polledb
    buffer_load_dword v5, v246, s[36:39], 0 offen sc1
    s_waitcnt vmcnt(3)
    v_cmp_ne_u32 vcc, s56, v6
    s_cbranch_vccz L_polledb
    buffer_load_dword v6, v246, s[36:39], 0 offen sc1
    s_waitcnt vmcnt(3)
    v_cmp_ne_u32 vcc, s56, v7
    s_cbranch_vccz L_polledb
    s_add_u32 s57, s57, 1
    s_cmp_lt_u32 s57, 262144
    s_cbranch_scc1 L_pollb
L_polledb:
    s_waitcnt lgkmcnt(0)
    s_barrier
    s_add_u32 s14, s63, 0
    s_add_u32 m0, s60, 0
    s_sub_u32 s15, s14, 2621440
    s_min_u32 s14, s14, s15
    buffer_load_dwordx4 v241, s[36:39], s14 offen sc1 lds
    s_add_u32 s14, s63, 262144
    s_add_u32 m0, s60, 8192
    s_sub_u32 s15, s14, 2621440
    s_min_u32 s14, s14, s15
    buffer_load_dwordx4 v241, s[36:39], s14 offen sc1 lds
    s_add_u32 s14, s63, 524288
    s_add_u32 m0, s60, 16384
    s_sub_u32 s15, s14, 2621440
    s_min_u32 s14, s14, s15
    buffer_load_dwordx4 v241, s[36:39], s14 offen sc1 lds
    s_add_u32 s14, s63, 786432
    s_add_u32 m0, s60, 24576
    s_sub_u32 s15, s14, 2621440
    s_min_u32 s14, s14, s15
    buffer_load_dwordx4 v241, s[36:39], s14 offen sc1 lds
    s_waitcnt vmcnt(2)
    s_barrier
    ds_read_b128 v[8:11], v242 offset:0
    ds_read_b128 v[12:15], v242 offset:256
    ds_read_b128 v[16:19], v242 offset:4096
    ds_read_b128 v[20:23], v242 offset:4352
    s_waitcnt lgkmcnt(2)
    v_mfma_f32_16x16x32_bf16 v[32:35], v[64:67], v[8:11], 0
    ds_read_b128 v[24:27], v242 offset:8192
    v_mfma_f32_16x16x32_bf16 v[36:39], v[68:71], v[8:11], 0
    ds_read_b128 v[28:31], v242 offset:8448
    v_mfma_f32_16x16x32_bf16 v[40:43], v[64:67], v[12:15], 0
    s_add_u32 s14, s63, 1048576
    s_add_u32 m0, s60, 32768
    s_sub_u32 s15, s14, 2621440
    s_min_u32 s14, s14, s15
    buffer_load_dwordx4 v241, s[36:39], s14 offen sc1 lds
    v_mfma_f32_16x16x32_bf16 v[44:47], v[68:71], v[12:15], 0
    s_waitcnt lgkmcnt(2)
    v_mfma_f32_16x16x32_bf16 v[32:35], v[72:75], v[16:19], v[32:35]
    ds_read_b128 v[8:11], v242 offset:12288
    v_mfma_f32_16x16x32_bf16 v[36:39], v[76:79], v[16:19], v[36:39]
    ds_read_b128 v[12:15], v242 offset:12544
    v_mfma_f32_16x16x32_bf16 v[40:43], v[72:75], v[20:23], v[40:43]
    s_add_u32 s14, s63, 1310720
    s_add_u32 m0, s60, 40960
    s_sub_u32 s15, s14, 2621440
    s_min_u32 s14, s14, s15
    buffer_load_dwordx4 v241, s[36:39], s14 offen sc1 lds
    v_mfma_f32_16x16x32_bf16 v[44:47], v[76:79], v[20:23], v[44:47]
    s_waitcnt lgkmcnt(2)
    s_waitcnt vmcnt(0)
    s_barrier
    v_mfma_f32_16x16x32_bf16 v[32:35], v[80:83], v[24:27], v[32:35]
    ds_read_b128 v[16:19], v242 offset:16384
    v_mfma_f32_16x16x32_bf16 v[36:39], v[84:87], v[24:27], v[36:39]
    ds_read_b128 v[20:23], v242 offset:16640
    v_mfma_f32_16x16x32_bf16 v[40:43], v[80:83], v[28:31], v[40:43]
    s_add_u32 s14, s63, 1572864
    s_add_u32 m0, s60, 49152
    s_sub_u32 s15, s14, 2621440
    s_min_u32 s14, s14, s15
    buffer_load_dwordx4 v241, s[36:39], s14 offen sc1 lds
    v_mfma_f32_16x16x32_bf16 v[44:47], v[84:87], v[28:31], v[44:47]
    s_waitcnt lgkmcnt(2)
    v_mfma_f32_16x16x32_bf16 v[32:35], v[88:91], v[8:11], v[32:35]
    ds_read_b128 v[24:27], v242 offset:20480
    v_mfma_f32_16x16x32_bf16 v[36:39], v[92:95], v[8:11], v[36:39]
    ds_read_b128 v[28:31], v242 offset:20736
    v_mfma_f32_16x16x32_bf16 v[40:43], v[88:91], v[12:15], v[40:43]
    s_add_u32 s14, s63, 1835008
    s_add_u32 m0, s60, 57344
    s_sub_u32 s15, s14, 2621440
    s_min_u32 s14, s14, s15
    buffer_load_dwordx4 v241, s[36:39], s14 offen sc1 lds
    v_mfma_f32_16x16x32_bf16 v[44:47], v[92:95], v[12:15], v[44:47]
    s_waitcnt lgkmcnt(2)
    v_mfma_f32_16x16x32_bf16 v[32:35], v[96:99], v[16:19], v[32:35]
    ds_read_b128 v[8:11], v242 offset:24576
    v_mfma_f32_16x16x32_bf16 v[36:39], v[100:103], v[16:19], v[36:39]
    ds_read_b128 v[12:15], v242 offset:24832
    v_mfma_f32_16x16x32_bf16 v[40:43], v[96:99], v[20:23], v[40:43]
    s_add_u32 s14, s63, 2097152
    s_add_u32 m0, s60, 65536
    s_sub_u32 s15, s14, 2621440
    s_min_u32 s14, s14, s15
    buffer_load_dwordx4 v241, s[36:39], s14 offen sc1 lds
    v_mfma_f32_16x16x32_bf16 v[44:47], v[100:103], v[20:23], v[44:47]
    s_waitcnt lgkmcnt(2)
    v_mfma_f32_16x16x32_bf16 v[32:35], v[104:107], v[24:27], v[32:35]
    ds_read_b128 v[16:19], v242 offset:28672
    v_mfma_f32_16x16x32_bf16 v[36:39], v[108:111], v[24:27], v[36:39]
    ds_read_b128 v[20:23], v242 offset:28928
    v_mfma_f32_16x16x32_bf16 v[40:43], v[104:107], v[28:31], v[40:43]
    s_add_u32 s14, s63, 2359296
    s_add_u32 m0, s60, 73728
    s_sub_u32 s15, s14, 2621440
    s_min_u32 s14, s14, s15
    buffer_load_dwordx4 v241, s[36:39], s14 offen sc1 lds
    v_mfma_f32_16x16x32_bf16 v[44:47], v[108:111], v[28:31], v[44:47]
    s_waitcnt lgkmcnt(2)
    v_mfma_f32_16x16x32_bf16 v[32:35], v[112:115], v[8:11], v[32:35]
    ds_read_b128 v[24:27], v242 offset:32768
    v_mfma_f32_16x16x32_bf16 v[36:39], v[116:119], v[8:11], v[36:39]
    ds_read_b128 v[28:31], v242 offset:33024
    v_mfma_f32_16x16x32_bf16 v[40:43], v[112:115], v[12:15], v[40:43]
    v_mfma_f32_16x16x32_bf16 v[44:47], v[116:119], v[12:15], v[44:47]
    s_waitcnt lgkmcnt(2)
    v_mfma_f32_16x16x32_bf16 v[32:35], v[120:123], v[16:19], v[32:35]
    ds_read_b128 v[8:11], v242 offset:36864
    v_mfma_f32_16x16x32_bf16 v[36:39], v[124:127], v[16:19], v[36:39]
    ds_read_b128 v[12:15], v242 offset:37120
    v_mfma_f32_16x16x32_bf16 v[40:43], v[120:123], v[20:23], v[40:43]
    v_mfma_f32_16x16x32_bf16 v[44:47], v[124:127], v[20:23], v[44:47]
    s_waitcnt lgkmcnt(2)
    v_mfma_f32_16x16x32_bf16 v[32:35], v[128:131], v[24:27], v[32:35]
    ds_read_b128 v[16:19], v242 offset:40960
    v_mfma_f32_16x16x32_bf16 v[36:39], v[132:135], v[24:27], v[36:39]
    ds_read_b128 v[20:23], v242 offset:41216
    v_mfma_f32_16x16x32_bf16 v[40:43], v[128:131], v[28:31], v[40:43]
    v_mfma_f32_16x16x32_bf16 v[44:47], v[132:135], v[28:31], v[44:47]
    s_waitcnt lgkmcnt(2)
    v_mfma_f32_16x16x32_bf16 v[32:35], v[136:139], v[8:11], v[32:35]
    ds_read_b128 v[24:27], v242 offset:45056
    v_mfma_f32_16x16x32_bf16 v[36:39], v[140:143], v[8:11], v[36:39]
    ds_read_b128 v[28:31], v242 offset:45312
    v_mfma_f32_16x16x32_bf16 v[40:43], v[136:139], v[12:15], v[40:43]
    v_mfma_f32_16x16x32_bf16 v[44:47], v[140:143], v[12:15], v[44:47]
    s_waitcnt lgkmcnt(2)
    s_waitcnt vmcnt(0)
    s_barrier
    v_mfma_f32_16x16x32_bf16 v[32:35], v[144:147], v[16:19], v[32:35]
    ds_read_b128 v[8:11], v243 offset:0
    v_mfma_f32_16x16x32_bf16 v[36:39], v[148:151], v[16:19], v[36:39]
    ds_read_b128 v[12:15], v243 offset:256
    v_mfma_f32_16x16x32_bf16 v[40:43], v[144:147], v[20:23], v[40:43]
    v_mfma_f32_16x16x32_bf16 v[44:47], v[148:151], v[20:23], v[44:47]
    s_waitcnt lgkmcnt(2)
    v_mfma_f32_16x16x32_bf16 v[32:35], v[152:155], v[24:27], v[32:35]
    ds_read_b128 v[16:19], v243 offset:4096
    v_mfma_f32_16x16x32_bf16 v[36:39], v[156:159], v[24:27], v[36:39]
    ds_read_b128 v[20:23], v243 offset:4352
    v_mfma_f32_16x16x32_bf16 v[40:43], v[152:155], v[28:31], v[40:43]
    v_mfma_f32_16x16x32_bf16 v[44:47], v[156:159], v[28:31], v[44:47]
    s_waitcnt lgkmcnt(2)
    v_mfma_f32_16x16x32_bf16 v[32:35], v[160:163], v[8:11], v[32:35]
    ds_read_b128 v[24:27], v243 offset:8192
    v_mfma_f32_16x16x32_bf16 v[36:39], v[164:167], v[8:11], v[36:39]
    ds_read_b128 v[28:31], v243 offset:8448
    v_mfma_f32_16x16x32_bf16 v[40:43], v[160:163], v[12:15], v[40:43]
    v_mfma_f32_16x16x32_bf16 v[44:47], v[164:167], v[12:15], v[44:47]
    s_waitcnt lgkmcnt(2)
    v_mfma_f32_16x16x32_bf16 v[32:35], v[168:171], v[16:19], v[32:35]
    ds_read_b128 v[8:11], v243 offset:12288
    v_mfma_f32_16x16x32_bf16 v[36:39], v[172:175], v[16:19], v[36:39]
    ds_read_b128 v[12:15], v243 offset:12544
    v_mfma_f32_16x16x32_bf16 v[40:43], v[168:171], v[20:23], v[40:43]
    v_mfma_f32_16x16x32_bf16 v[44:47], v[172:175], v[20:23], v[44:47]
    s_waitcnt lgkmcnt(2)
    v_mfma_f32_16x16x32_bf16 v[32:35], v[176:179], v[24:27], v[32:35]
    ds_read_b128 v[16:19], v243 offset:16384
    v_mfma_f32_16x16x32_bf16 v[36:39], v[180:183], v[24:27], v[36:39]
    ds_read_b128 v[20:23], v243 offset:16640
    v_mfma_f32_16x16x32_bf16 v[40:43], v[176:179], v[28:31], v[40:43]
    v_mfma_f32_16x16x32_bf16 v[44:47], v[180:183], v[28:31], v[44:47]
    s_waitcnt lgkmcnt(2)
    v_mfma_f32_16x16x32_bf16 v[32:35], v[184:187], v[8:11], v[32:35]
    ds_read_b128 v[24:27], v243 offset:20480
    v_mfma_f32_16x16x32_bf16 v[36:39], v[188:191], v[8:11], v[36:39]
    ds_read_b128 v[28:31], v243 offset:20736
    v_mfma_f32_16x16x32_bf16 v[40:43], v[184:187], v[12:15], v[40:43]
    v_mfma_f32_16x16x32_bf16 v[44:47], v[188:191], v[12:15], v[44:47]
    s_waitcnt lgkmcnt(2)
    v_mfma_f32_16x16x32_bf16 v[32:35], v[192:195], v[16:19], v[32:35]
    ds_read_b128 v[8:11], v243 offset:24576
    v_mfma_f32_16x16x32_bf16 v[36:39], v[196:199], v[16:19], v[36:39]
    ds_read_b128 v[12:15], v243 offset:24832
    v_mfma_f32_16x16x32_bf16 v[40:43], v[192:195], v[20:23], v[40:43]
    v_mfma_f32_16x16x32_bf16 v[44:47], v[196:199], v[20:23], v[44:47]
    s_waitcnt lgkmcnt(2)
    v_mfma_f32_16x16x32_bf16 v[32:35], v[200:203], v[24:27], v[32:35]
    ds_read_b128 v[16:19], v243 offset:28672
    v_mfma_f32_16x16x32_bf16 v[36:39], v[204:207], v[24:27], v[36:39]
    ds_read_b128 v[20:23], v243 offset:28928
    v_mfma_f32_16x16x32_bf16 v[40:43], v[200:203], v[28:31], v[40:43]
    v_mfma_f32_16x16x32_bf16 v[44:47], v[204:207], v[28:31], v[44:47]
    s_waitcnt lgkmcnt(2)
    v_mfma_f32_16x16x32_bf16 v[32:35], v[208:211], v[8:11], v[32:35]
    v_mfma_f32_16x16x32_bf16 v[36:39], v[212:215], v[8:11], v[36:39]
    v_mfma_f32_16x16x32_bf16 v[40:43], v[208:211], v[12:15], v[40:43]
    v_mfma_f32_16x16x32_bf16 v[44:47], v[212:215], v[12:15], v[44:47]
    s_waitcnt lgkmcnt(0)
    v_mfma_f32_16x16x32_bf16 v[32:35], v[216:219], v[16:19], v[32:35]
    v_mfma_f32_16x16x32_bf16 v[36:39], v[220:223], v[16:19], v[36:39]
    v_mfma_f32_16x16x32_bf16 v[40:43], v[216:219], v[20:23], v[40:43]
    v_mfma_f32_16x16x32_bf16 v[44:47], v[220:223], v[20:23], v[44:47]
    s_nop 5
    v_cvt_pk_bf16_f32 v48, v32, v33
    v_cvt_pk_bf16_f32 v49, v34, v35
    v_cvt_pk_bf16_f32 v50, v36, v37
    v_cvt_pk_bf16_f32 v51, v38, v39
    s_nop 1
    v_permlane16_swap_b32 v48, v50
    v_permlane16_swap_b32 v49, v51
    buffer_store_dwordx4 v[48:51], v244, s[32:35], 0 offen sc1
    v_cvt_pk_bf16_f32 v52, v40, v41
    v_cvt_pk_bf16_f32 v53, v42, v43
    v_cvt_pk_bf16_f32 v54, v44, v45
    v_cvt_pk_bf16_f32 v55, v46, v47
    s_nop 1
    v_permlane16_swap_b32 v52, v54
    v_permlane16_swap_b32 v53, v55
    buffer_store_dwordx4 v[52:55], v245, s[32:35], 0 offen sc1
L_fin:
    s_endpgm
L_A:
    s_mov_b32 s46, 2621440
    s_mov_b32 s47, 0x20000
    s_sub_u32 s6, s5, 24
    s_lshl_b32 s10, s6, 1
    s_and_b32 s11, s3, 1
    s_add_u32 s10, s10, s11
    s_and_b32 s11, s3, 2
    s_cmp_lg_u32 s11, 0
    s_cbranch_scc1 L_ts_48
    s_mul_i32 s12, s10, 34
    s_bfe_u32 s13, s4, 0x10001
    s_mul_i32 s13, s13, 528
    s_add_u32 s12, s12, s13
    s_sub_u32 s12, s12, 8
    v_min_u32 v1, 33, v0
    v_add_u32 v1, s12, v1
    s_and_b32 s12, s4, 1
    v_lshl_add_u32 v1, v1, 1, s12
    v_mul_i32_i24 v253, 1280, v1
    s_movk_i32 s51, 128
    s_waitcnt lgkmcnt(0)
    s_mov_b64 s[52:53], s[20:21]
    s_mov_b32 s54, 2621440
    s_branch L_ts_49
L_ts_48:
    s_mul_i32 s12, s10, 60
    v_min_u32 v1, 59, v0
    v_add_u32 v1, s12, v1
    v_mul_u32_u24 v2, 13108, v1
    v_lshrrev_b32 v2, 16, v2
    v_mul_u32_u24 v2, 640, v2
    v_lshl_add_u32 v2, v1, 7, v2
    s_lshr_b32 s12, s4, 2
    s_mul_i32 s12, s12, 640
    v_add_u32 v253, s12, v2
    s_mov_b32 s51, 245760
    s_waitcnt lgkmcnt(0)
    s_mov_b64 s[52:53], s[24:25]
    s_mov_b32 s54, 2457600
L_ts_49:
    s_mov_b32 s55, 0x20000
    s_lshr_b32 s10, s3, 2
    s_add_u32 s10, s10, 2
    s_mul_i32 s50, s10, s51
    s_lshl_b32 s49, s51, 1
    buffer_load_dword v255, v253, s[52:55], s50 offen
    s_add_u32 s50, s50, s49
    s_lshr_b32 s7, s6, 1
    s_lshl_b32 s7, s7, 3
    s_add_u32 s7, s7, s4
    s_and_b32 s8, s6, 1
    s_lshr_b32 s9, s3, 1
    s_and_b32 s15, s3, 1
    s_lshl_b32 s15, s15, 3
    s_lshl_b32 s11, s7, 4
    s_add_u32 s10, s15, s11
    s_add_u32 s11, s9, 1
    s_and_b32 s11, s11, 2
    s_movk_i32 s12, 1280
    s_cmp_lg_u32 s11, 0
    s_cselect_b32 s12, -1280, s12
    s_movk_i32 s13, 1024
    s_cmp_eq_u32 s9, 1
    s_cselect_b32 s13, 2048, s13
    s_cmp_eq_u32 s9, 0
    s_cselect_b32 s13, 0, s13
    s_mul_i32 s13, s13, 1280
    s_mul_i32 s14, s10, s12
    s_add_u32 s13, s13, s14
    s_lshl_b32 s14, s12, 2
    s_mul_i32 s16, s3, 10240
    v_lshrrev_b32 v2, 4, v0
    v_or_b32 v3, s15, v2
    v_xor_b32 v3, v3, v0
    v_and_b32 v3, 15, v3
    v_mul_i32_i24 v2, s12, v2
    v_lshl_add_u32 v2, v3, 4, v2
    v_add_u32 v48, s13, v2
    v_xor_b32 v2, 64, v48
    v_add_u32 v49, s14, v2
    s_lshl_b32 s11, s7, 3
    s_add_u32 s11, s11, s3
    s_cmp_lg_u32 s11, 6
    s_cbranch_scc1 L_a_nz
    v_bfrev_b32 v2, 1
    v_cmp_gt_u32 vcc, 16, v0
    s_nop 1
    v_cndmask_b32 v48, v48, v2, vcc
L_a_nz:
    s_mov_b32 s30, 819200
    s_mov_b32 s31, 0x20000
    s_mov_b32 s34, 5242880
    s_mov_b32 s35, 0x20000
    s_mov_b32 s38, 6291456
    s_mov_b32 s39, 0x20000
    s_mov_b32 s42, 256
    s_mov_b32 s43, 0x20000
    s_cmp_lg_u32 s8, 0
    s_cbranch_scc1 L_a_xb
    s_add_u32 m0, s16, 0
    s_nop 0
    buffer_load_dwordx4 v48, s[44:47], 0 offen offset:0 lds
    s_add_u32 m0, s16, 768
    s_nop 0
    buffer_load_dwordx4 v48, s[44:47], 0 offen offset:256 lds
    s_add_u32 m0, s16, 1536
    s_nop 0
    buffer_load_dwordx4 v48, s[44:47], 0 offen offset:512 lds
    s_add_u32 m0, s16, 2304
    s_nop 0
    buffer_load_dwordx4 v48, s[44:47], 0 offen offset:768 lds
    s_add_u32 m0, s16, 3072
    s_nop 0
    buffer_load_dwordx4 v48, s[44:47], 0 offen offset:1024 lds
    s_add_u32 m0, s16, 5120
    s_nop 0
    buffer_load_dwordx4 v49, s[44:47], 0 offen offset:0 lds
    s_add_u32 m0, s16, 5888
    s_nop 0
    buffer_load_dwordx4 v49, s[44:47], 0 offen offset:256 lds
    s_add_u32 m0, s16, 6656
    s_nop 0
    buffer_load_dwordx4 v49, s[44:47], 0 offen offset:512 lds
    s_add_u32 m0, s16, 7424
    s_nop 0
    buffer_load_dwordx4 v49, s[44:47], 0 offen offset:768 lds
    s_add_u32 m0, s16, 8192
    s_nop 0
    buffer_load_dwordx4 v49, s[44:47], 0 offen offset:1024 lds
    s_branch L_a_xc
L_a_xb:
    s_add_u32 m0, s16, 5120
    s_nop 0
    buffer_load_dwordx4 v49, s[44:47], 0 offen offset:0 lds
    s_add_u32 m0, s16, 5888
    s_nop 0
    buffer_load_dwordx4 v49, s[44:47], 0 offen offset:256 lds
    s_add_u32 m0, s16, 6656
    s_nop 0
    buffer_load_dwordx4 v49, s[44:47], 0 offen offset:512 lds
    s_add_u32 m0, s16, 7424
    s_nop 0
    buffer_load_dwordx4 v49, s[44:47], 0 offen offset:768 lds
    s_add_u32 m0, s16, 8192
    s_nop 0
    buffer_load_dwordx4 v49, s[44:47], 0 offen offset:1024 lds
    s_add_u32 m0, s16, 0
    s_nop 0
    buffer_load_dwordx4 v48, s[44:47], 0 offen offset:0 lds
    s_add_u32 m0, s16, 768
    s_nop 0
    buffer_load_dwordx4 v48, s[44:47], 0 offen offset:256 lds
    s_add_u32 m0, s16, 1536
    s_nop 0
    buffer_load_dwordx4 v48, s[44:47], 0 offen offset:512 lds
    s_add_u32 m0, s16, 2304
    s_nop 0
    buffer_load_dwordx4 v48, s[44:47], 0 offen offset:768 lds
    s_add_u32 m0, s16, 3072
    s_nop 0
    buffer_load_dwordx4 v48, s[44:47], 0 offen offset:1024 lds
L_a_xc:
    s_cmp_lg_u32 s3, 7
    s_cbranch_scc1 L_a_nx
    v_lshlrev_b32 v1, 4, v0
    v_add_u32 v1, 655360, v1
    v_cmp_gt_u32 vcc, 16, v0
    v_add_u32 v2, 1309440, v1
    s_mov_b32 m0, 81920
    v_cndmask_b32 v3, v2, v1, vcc
    buffer_load_dwordx4 v1, s[44:47], 0 offen lds
    v_cmp_gt_u32 vcc, 32, v0
    v_bfrev_b32 v1, 1
    buffer_load_dwordx4 v3, s[44:47], 0 offen offset:1024 lds
    v_cndmask_b32 v2, v1, v2, vcc
    buffer_load_dwordx4 v2, s[44:47], 0 offen offset:2048 lds
L_a_nx:
    s_mul_i32 s10, s7, 37
    s_lshr_b32 s10, s10, 8
    s_mul_i32 s10, s10, 7
    s_sub_u32 s10, s7, s10
    s_cmp_eq_u32 s3, 7
    s_cselect_b32 s9, s10, s3
    s_mul_i32 s10, s9, 48
    v_and_b32 v1, 15, v0
    v_lshrrev_b32 v2, 4, v0
    v_lshlrev_b32 v3, 3, v2
    v_cvt_f32_u32 v6, v3
    s_cmp_eq_u32 s8, 0
    s_cselect_b32 s11, 0, 0xbe800000
    s_cselect_b32 s18, 1.0, -1.0
    v_mov_b32 v5, s11
    v_and_b32 v3, 1, v0
    v_mul_u32_u24 v7, 0x8000, v3
    v_lshl_or_b32 v190, v7, 16, v7
    v_add_u32 v3, s10, v1
    v_cvt_f32_u32 v8, v3
    v_mul_f32 v4, 0x3acccccd, v8
    v_mul_f32 v10, 0x3d4ccccd, v8
    v_fma_f32 v32, v6, v4, v5
    v_cos_f32 v9, v4
    v_add_f32 v40, v32, v10
    v_cos_f32 v10, v10
    v_add_f32 v33, v32, v4
    v_add_f32 v41, v40, v4
    v_cos_f32 v32, v32
    v_cos_f32 v40, v40
    v_cos_f32 v33, v33
    v_cos_f32 v41, v41
    v_add_f32 v9, v9, v9
    v_add_f32 v10, v10, v10
    v_fma_f32 v34, v9, v33, -v32
    v_fma_f32 v42, v9, v41, -v40
    v_fma_f32 v35, v9, v34, -v33
    v_fma_f32 v43, v9, v42, -v41
    v_fma_f32 v36, v9, v35, -v34
    v_fma_f32 v44, v9, v43, -v42
    v_fma_f32 v37, v9, v36, -v35
    v_fma_f32 v45, v9, v44, -v43
    v_fma_f32 v38, v9, v37, -v36
    v_fma_f32 v46, v9, v45, -v44
    v_fma_f32 v39, v9, v38, -v37
    v_fma_f32 v47, v9, v46, -v45
    v_cvt_pk_bf16_f32 v64, v32, v33
    v_cvt_pk_bf16_f32 v65, v34, v35
    v_cvt_pk_bf16_f32 v66, v36, v37
    v_cvt_pk_bf16_f32 v67, v38, v39
    v_cvt_pk_bf16_f32 v68, v40, v41
    v_cvt_pk_bf16_f32 v69, v42, v43
    v_cvt_pk_bf16_f32 v70, v44, v45
    v_cvt_pk_bf16_f32 v71, v46, v47
    v_pk_fma_f32 v[32:33], v[10:11], v[40:41], v[32:33] op_sel_hi:[0,1,1] neg_lo:[0,0,1] neg_hi:[0,0,1]
    v_pk_fma_f32 v[34:35], v[10:11], v[42:43], v[34:35] op_sel_hi:[0,1,1] neg_lo:[0,0,1] neg_hi:[0,0,1]
    v_pk_fma_f32 v[36:37], v[10:11], v[44:45], v[36:37] op_sel_hi:[0,1,1] neg_lo:[0,0,1] neg_hi:[0,0,1]
    v_pk_fma_f32 v[38:39], v[10:11], v[46:47], v[38:39] op_sel_hi:[0,1,1] neg_lo:[0,0,1] neg_hi:[0,0,1]
    v_cvt_pk_bf16_f32 v72, v32, v33
    v_cvt_pk_bf16_f32 v73, v34, v35
    v_cvt_pk_bf16_f32 v74, v36, v37
    v_cvt_pk_bf16_f32 v75, v38, v39
    v_pk_fma_f32 v[40:41], v[10:11], v[32:33], v[40:41] op_sel_hi:[0,1,1] neg_lo:[0,0,1] neg_hi:[0,0,1]
    v_pk_fma_f32 v[42:43], v[10:11], v[34:35], v[42:43] op_sel_hi:[0,1,1] neg_lo:[0,0,1] neg_hi:[0,0,1]
    v_pk_fma_f32 v[44:45], v[10:11], v[36:37], v[44:45] op_sel_hi:[0,1,1] neg_lo:[0,0,1] neg_hi:[0,0,1]
    v_pk_fma_f32 v[46:47], v[10:11], v[38:39], v[46:47] op_sel_hi:[0,1,1] neg_lo:[0,0,1] neg_hi:[0,0,1]
    v_cvt_pk_bf16_f32 v76, v40, v41
    v_cvt_pk_bf16_f32 v77, v42, v43
    v_cvt_pk_bf16_f32 v78, v44, v45
    v_cvt_pk_bf16_f32 v79, v46, v47
    v_pk_fma_f32 v[32:33], v[10:11], v[40:41], v[32:33] op_sel_hi:[0,1,1] neg_lo:[0,0,1] neg_hi:[0,0,1]
    v_pk_fma_f32 v[34:35], v[10:11], v[42:43], v[34:35] op_sel_hi:[0,1,1] neg_lo:[0,0,1] neg_hi:[0,0,1]
    v_pk_fma_f32 v[36:37], v[10:11], v[44:45], v[36:37] op_sel_hi:[0,1,1] neg_lo:[0,0,1] neg_hi:[0,0,1]
    v_pk_fma_f32 v[38:39], v[10:11], v[46:47], v[38:39] op_sel_hi:[0,1,1] neg_lo:[0,0,1] neg_hi:[0,0,1]
    v_cvt_pk_bf16_f32 v80, v32, v33
    v_cvt_pk_bf16_f32 v81, v34, v35
    v_cvt_pk_bf16_f32 v82, v36, v37
    v_cvt_pk_bf16_f32 v83, v38, v39
    v_xor_b32 v84, v190, v64
    v_xor_b32 v85, v190, v65
    v_xor_b32 v86, v190, v66
    v_xor_b32 v87, v190, v67
    v_xor_b32 v88, v190, v68
    v_xor_b32 v89, v190, v69
    v_xor_b32 v90, v190, v70
    v_xor_b32 v91, v190, v71
    v_xor_b32 v92, v190, v72
    v_xor_b32 v93, v190, v73
    v_xor_b32 v94, v190, v74
    v_xor_b32 v95, v190, v75
    v_xor_b32 v96, v190, v76
    v_xor_b32 v97, v190, v77
    v_xor_b32 v98, v190, v78
    v_xor_b32 v99, v190, v79
    v_xor_b32 v100, v190, v80
    v_xor_b32 v101, v190, v81
    v_xor_b32 v102, v190, v82
    v_xor_b32 v103, v190, v83
    v_add_u32 v3, 16, v3
    v_cvt_f32_u32 v8, v3
    v_mul_f32 v4, 0x3acccccd, v8
    v_mul_f32 v10, 0x3d4ccccd, v8
    v_fma_f32 v32, v6, v4, v5
    v_cos_f32 v9, v4
    v_add_f32 v40, v32, v10
    v_cos_f32 v10, v10
    v_add_f32 v33, v32, v4
    v_add_f32 v41, v40, v4
    v_cos_f32 v32, v32
    v_cos_f32 v40, v40
    v_cos_f32 v33, v33
    v_cos_f32 v41, v41
    v_add_f32 v9, v9, v9
    v_add_f32 v10, v10, v10
    v_fma_f32 v34, v9, v33, -v32
    v_fma_f32 v42, v9, v41, -v40
    v_fma_f32 v35, v9, v34, -v33
    v_fma_f32 v43, v9, v42, -v41
    v_fma_f32 v36, v9, v35, -v34
    v_fma_f32 v44, v9, v43, -v42
    v_fma_f32 v37, v9, v36, -v35
    v_fma_f32 v45, v9, v44, -v43
    v_fma_f32 v38, v9, v37, -v36
    v_fma_f32 v46, v9, v45, -v44
    v_fma_f32 v39, v9, v38, -v37
    v_fma_f32 v47, v9, v46, -v45
    v_cvt_pk_bf16_f32 v104, v32, v33
    v_cvt_pk_bf16_f32 v105, v34, v35
    v_cvt_pk_bf16_f32 v106, v36, v37
    v_cvt_pk_bf16_f32 v107, v38, v39
    v_cvt_pk_bf16_f32 v108, v40, v41
    v_cvt_pk_bf16_f32 v109, v42, v43
    v_cvt_pk_bf16_f32 v110, v44, v45
    v_cvt_pk_bf16_f32 v111, v46, v47
    v_pk_fma_f32 v[32:33], v[10:11], v[40:41], v[32:33] op_sel_hi:[0,1,1] neg_lo:[0,0,1] neg_hi:[0,0,1]
    v_pk_fma_f32 v[34:35], v[10:11], v[42:43], v[34:35] op_sel_hi:[0,1,1] neg_lo:[0,0,1] neg_hi:[0,0,1]
    v_pk_fma_f32 v[36:37], v[10:11], v[44:45], v[36:37] op_sel_hi:[0,1,1] neg_lo:[0,0,1] neg_hi:[0,0,1]
    v_pk_fma_f32 v[38:39], v[10:11], v[46:47], v[38:39] op_sel_hi:[0,1,1] neg_lo:[0,0,1] neg_hi:[0,0,1]
    v_cvt_pk_bf16_f32 v112, v32, v33
    v_cvt_pk_bf16_f32 v113, v34, v35
    v_cvt_pk_bf16_f32 v114, v36, v37
    v_cvt_pk_bf16_f32 v115, v38, v39
    v_pk_fma_f32 v[40:41], v[10:11], v[32:33], v[40:41] op_sel_hi:[0,1,1] neg_lo:[0,0,1] neg_hi:[0,0,1]
    v_pk_fma_f32 v[42:43], v[10:11], v[34:35], v[42:43] op_sel_hi:[0,1,1] neg_lo:[0,0,1] neg_hi:[0,0,1]
    v_pk_fma_f32 v[44:45], v[10:11], v[36:37], v[44:45] op_sel_hi:[0,1,1] neg_lo:[0,0,1] neg_hi:[0,0,1]
    v_pk_fma_f32 v[46:47], v[10:11], v[38:39], v[46:47] op_sel_hi:[0,1,1] neg_lo:[0,0,1] neg_hi:[0,0,1]
    v_cvt_pk_bf16_f32 v116, v40, v41
    v_cvt_pk_bf16_f32 v117, v42, v43
    v_cvt_pk_bf16_f32 v118, v44, v45
    v_cvt_pk_bf16_f32 v119, v46, v47
    v_pk_fma_f32 v[32:33], v[10:11], v[40:41], v[32:33] op_sel_hi:[0,1,1] neg_lo:[0,0,1] neg_hi:[0,0,1]
    v_pk_fma_f32 v[34:35], v[10:11], v[42:43], v[34:35] op_sel_hi:[0,1,1] neg_lo:[0,0,1] neg_hi:[0,0,1]
    v_pk_fma_f32 v[36:37], v[10:11], v[44:45], v[36:37] op_sel_hi:[0,1,1] neg_lo:[0,0,1] neg_hi:[0,0,1]
    v_pk_fma_f32 v[38:39], v[10:11], v[46:47], v[38:39] op_sel_hi:[0,1,1] neg_lo:[0,0,1] neg_hi:[0,0,1]
    v_cvt_pk_bf16_f32 v120, v32, v33
    v_cvt_pk_bf16_f32 v121, v34, v35
    v_cvt_pk_bf16_f32 v122, v36, v37
    v_cvt_pk_bf16_f32 v123, v38, v39
    v_xor_b32 v124, v190, v104
    v_xor_b32 v125, v190, v105
    v_xor_b32 v126, v190, v106
    v_xor_b32 v127, v190, v107
    v_xor_b32 v128, v190, v108
    v_xor_b32 v129, v190, v109
    v_xor_b32 v130, v190, v110
    v_xor_b32 v131, v190, v111
    v_xor_b32 v132, v190, v112
    v_xor_b32 v133, v190, v113
    v_xor_b32 v134, v190, v114
    v_xor_b32 v135, v190, v115
    v_xor_b32 v136, v190, v116
    v_xor_b32 v137, v190, v117
    v_xor_b32 v138, v190, v118
    v_xor_b32 v139, v190, v119
    v_xor_b32 v140, v190, v120
    v_xor_b32 v141, v190, v121
    v_xor_b32 v142, v190, v122
    v_xor_b32 v143, v190, v123
    v_add_u32 v3, 16, v3
    v_cvt_f32_u32 v8, v3
    v_mul_f32 v4, 0x3acccccd, v8
    v_mul_f32 v10, 0x3d4ccccd, v8
    v_fma_f32 v32, v6, v4, v5
    v_cos_f32 v9, v4
    v_add_f32 v40, v32, v10
    v_cos_f32 v10, v10
    v_add_f32 v33, v32, v4
    v_add_f32 v41, v40, v4
    v_cos_f32 v32, v32
    v_cos_f32 v40, v40
    v_cos_f32 v33, v33
    v_cos_f32 v41, v41
    v_add_f32 v9, v9, v9
    v_add_f32 v10, v10, v10
    v_fma_f32 v34, v9, v33, -v32
    v_fma_f32 v42, v9, v41, -v40
    v_fma_f32 v35, v9, v34, -v33
    v_fma_f32 v43, v9, v42, -v41
    v_fma_f32 v36, v9, v35, -v34
    v_fma_f32 v44, v9, v43, -v42
    v_fma_f32 v37, v9, v36, -v35
    v_fma_f32 v45, v9, v44, -v43
    v_fma_f32 v38, v9, v37, -v36
    v_fma_f32 v46, v9, v45, -v44
    v_fma_f32 v39, v9, v38, -v37
    v_fma_f32 v47, v9, v46, -v45
    v_cvt_pk_bf16_f32 v144, v32, v33
    v_cvt_pk_bf16_f32 v145, v34, v35
    v_cvt_pk_bf16_f32 v146, v36, v37
    v_cvt_pk_bf16_f32 v147, v38, v39
    v_cvt_pk_bf16_f32 v148, v40, v41
    v_cvt_pk_bf16_f32 v149, v42, v43
    v_cvt_pk_bf16_f32 v150, v44, v45
    v_cvt_pk_bf16_f32 v151, v46, v47
    v_pk_fma_f32 v[32:33], v[10:11], v[40:41], v[32:33] op_sel_hi:[0,1,1] neg_lo:[0,0,1] neg_hi:[0,0,1]
    v_pk_fma_f32 v[34:35], v[10:11], v[42:43], v[34:35] op_sel_hi:[0,1,1] neg_lo:[0,0,1] neg_hi:[0,0,1]
    v_pk_fma_f32 v[36:37], v[10:11], v[44:45], v[36:37] op_sel_hi:[0,1,1] neg_lo:[0,0,1] neg_hi:[0,0,1]
    v_pk_fma_f32 v[38:39], v[10:11], v[46:47], v[38:39] op_sel_hi:[0,1,1] neg_lo:[0,0,1] neg_hi:[0,0,1]
    v_cvt_pk_bf16_f32 v152, v32, v33
    v_cvt_pk_bf16_f32 v153, v34, v35
    v_cvt_pk_bf16_f32 v154, v36, v37
    v_cvt_pk_bf16_f32 v155, v38, v39
    v_pk_fma_f32 v[40:41], v[10:11], v[32:33], v[40:41] op_sel_hi:[0,1,1] neg_lo:[0,0,1] neg_hi:[0,0,1]
    v_pk_fma_f32 v[42:43], v[10:11], v[34:35], v[42:43] op_sel_hi:[0,1,1] neg_lo:[0,0,1] neg_hi:[0,0,1]
    v_pk_fma_f32 v[44:45], v[10:11], v[36:37], v[44:45] op_sel_hi:[0,1,1] neg_lo:[0,0,1] neg_hi:[0,0,1]
    v_pk_fma_f32 v[46:47], v[10:11], v[38:39], v[46:47] op_sel_hi:[0,1,1] neg_lo:[0,0,1] neg_hi:[0,0,1]
    v_cvt_pk_bf16_f32 v156, v40, v41
    v_cvt_pk_bf16_f32 v157, v42, v43
    v_cvt_pk_bf16_f32 v158, v44, v45
    v_cvt_pk_bf16_f32 v159, v46, v47
    v_pk_fma_f32 v[32:33], v[10:11], v[40:41], v[32:33] op_sel_hi:[0,1,1] neg_lo:[0,0,1] neg_hi:[0,0,1]
    v_pk_fma_f32 v[34:35], v[10:11], v[42:43], v[34:35] op_sel_hi:[0,1,1] neg_lo:[0,0,1] neg_hi:[0,0,1]
    v_pk_fma_f32 v[36:37], v[10:11], v[44:45], v[36:37] op_sel_hi:[0,1,1] neg_lo:[0,0,1] neg_hi:[0,0,1]
    v_pk_fma_f32 v[38:39], v[10:11], v[46:47], v[38:39] op_sel_hi:[0,1,1] neg_lo:[0,0,1] neg_hi:[0,0,1]
    v_cvt_pk_bf16_f32 v160, v32, v33
    v_cvt_pk_bf16_f32 v161, v34, v35
    v_cvt_pk_bf16_f32 v162, v36, v37
    v_cvt_pk_bf16_f32 v163, v38, v39
    v_xor_b32 v164, v190, v144
    v_xor_b32 v165, v190, v145
    v_xor_b32 v166, v190, v146
    v_xor_b32 v167, v190, v147
    v_xor_b32 v168, v190, v148
    v_xor_b32 v169, v190, v149
    v_xor_b32 v170, v190, v150
    v_xor_b32 v171, v190, v151
    v_xor_b32 v172, v190, v152
    v_xor_b32 v173, v190, v153
    v_xor_b32 v174, v190, v154
    v_xor_b32 v175, v190, v155
    v_xor_b32 v176, v190, v156
    v_xor_b32 v177, v190, v157
    v_xor_b32 v178, v190, v158
    v_xor_b32 v179, v190, v159
    v_xor_b32 v180, v190, v160
    v_xor_b32 v181, v190, v161
    v_xor_b32 v182, v190, v162
    v_xor_b32 v183, v190, v163
    buffer_load_dword v255, v253, s[52:55], s50 offen
    s_add_u32 s50, s50, s49
    v_subrev_u32 v3, s8, v0
    v_and_b32 v4, 2, v3
    v_lshlrev_b32 v4, 14, v4
    v_or_b32 v4, 0x3f80, v4
    v_and_b32 v3, 1, v3
    v_and_or_b32 v3, v0, 48, v3
    v_cmp_eq_u32 vcc, 0, v3
    v_mov_b32 v185, 0
    v_mov_b32 v186, 0
    v_mov_b32 v187, 0
    v_cndmask_b32 v184, 0, v4, vcc
    v_mov_b32 v189, s18
    s_cmp_eq_u32 s3, 7
    s_cbranch_scc1 L_a_xr
    s_lshr_b32 s11, s18, 16
    v_mov_b32 v3, 0x3f80
    v_mov_b32 v4, s11
    v_cmp_gt_u32 vcc, 32, v0
    v_and_b32 v5, 1, v2
    v_lshlrev_b32 v6, 3, v5
    v_cndmask_b32 v7, v4, v3, vcc
    v_cndmask_b32 v8, v3, v4, vcc
    v_sub_u32 v9, v1, v6
    v_sub_u32 v10, 16, v1
    v_sub_u32 v10, v10, v6
    v_and_b32 v11, 1, v1
    v_lshlrev_b32 v11, 4, v11
    v_lshlrev_b32 v7, v11, v7
    v_lshlrev_b32 v8, v11, v8
    v_ashrrev_i32 v9, 1, v9
    v_ashrrev_i32 v10, 1, v10
    v_cmp_eq_u32 vcc, 0, v9
    v_cmp_eq_u32 s[12:13], 0, v10
    v_mov_b32 v40, 0
    v_mov_b32 v44, 0
    v_cndmask_b32 v32, 0, v7, vcc
    v_cndmask_b32 v36, 0, v8, s[12:13]
    v_cmp_eq_u32 vcc, 1, v9
    v_cmp_eq_u32 s[12:13], 1, v10
    v_mov_b32 v41, 0
    v_mov_b32 v45, 0
    v_cndmask_b32 v33, 0, v7, vcc
    v_cndmask_b32 v37, 0, v8, s[12:13]
    v_cmp_eq_u32 vcc, 2, v9
    v_cmp_eq_u32 s[12:13], 2, v10
    v_mov_b32 v42, 0
    v_mov_b32 v46, 0
    v_cndmask_b32 v34, 0, v7, vcc
    v_cndmask_b32 v38, 0, v8, s[12:13]
    v_cmp_eq_u32 vcc, 3, v9
    v_cmp_eq_u32 s[12:13], 3, v10
    v_mov_b32 v43, 0
    v_mov_b32 v47, 0
    v_cndmask_b32 v35, 0, v7, vcc
    v_cndmask_b32 v39, 0, v8, s[12:13]
    v_writelane_b32 v40, s11, 0
    v_writelane_b32 v44, s11, 32
    s_movk_i32 s11, 0x3f80
    v_writelane_b32 v40, s11, 16
    v_writelane_b32 v44, s11, 48
    v_lshrrev_b32 v3, 2, v1
    v_mul_u32_u24 v3, 5120, v3
    v_and_b32 v4, 3, v0
    v_lshl_add_u32 v3, v4, 8, v3
    s_movk_i32 s10, 20480
    v_mad_u32_u24 v6, v2, s10, v3
    v_lshrrev_b32 v8, 1, v2
    v_mad_u32_u24 v4, v8, s10, v3
    v_xor_b32 v7, v1, v5
    v_lshlrev_b32 v8, 8, v8
    v_lshl_add_u32 v8, v1, 4, v8
    v_lshl_add_u32 v8, v5, 3, v8
    s_mul_i32 s10, s3, 1536
    s_add_u32 s10, s10, 86016
    v_add_u32 v60, s10, v8
    s_mul_i32 s13, s3, 6
    s_add_u32 s13, s13, 0
    s_sub_u32 s11, s13, 20
    s_min_u32 s58, s11, s13
    s_cmp_lt_u32 s11, 20
    s_cselect_b32 s13, 40, 0
    s_add_u32 s14, s58, s13
    s_sub_u32 s15, 80, s14
    s_lshr_b32 s10, s14, 4
    s_mul_i32 s10, s10, 48
    s_add_u32 s10, s10, s14
    v_xor_b32 v8, s10, v7
    v_lshl_add_u32 v48, v8, 4, v4
    s_lshr_b32 s10, s15, 4
    s_mul_i32 s10, s10, 48
    s_add_u32 s10, s10, s15
    v_xor_b32 v8, s10, v1
    v_lshl_add_u32 v50, v8, 4, v6
    s_sub_u32 s15, s15, 2
    s_lshr_b32 s10, s15, 4
    s_mul_i32 s10, s10, 48
    s_add_u32 s10, s10, s15
    v_xor_b32 v8, s10, v7
    v_lshl_add_u32 v49, v8, 4, v4
    s_mul_i32 s13, s3, 6
    s_add_u32 s13, s13, 2
    s_sub_u32 s11, s13, 20
    s_min_u32 s59, s11, s13
    s_cmp_lt_u32 s11, 20
    s_cselect_b32 s13, 40, 0
    s_add_u32 s14, s59, s13
    s_sub_u32 s15, 80, s14
    s_lshr_b32 s10, s14, 4
    s_mul_i32 s10, s10, 48
    s_add_u32 s10, s10, s14
    v_xor_b32 v8, s10, v7
    v_lshl_add_u32 v51, v8, 4, v4
    s_lshr_b32 s10, s15, 4
    s_mul_i32 s10, s10, 48
    s_add_u32 s10, s10, s15
    v_xor_b32 v8, s10, v1
    v_lshl_add_u32 v53, v8, 4, v6
    s_sub_u32 s15, s15, 2
    s_lshr_b32 s10, s15, 4
    s_mul_i32 s10, s10, 48
    s_add_u32 s10, s10, s15
    v_xor_b32 v8, s10, v7
    v_lshl_add_u32 v52, v8, 4, v4
    s_mul_i32 s13, s3, 6
    s_add_u32 s13, s13, 4
    s_sub_u32 s11, s13, 20
    s_min_u32 s60, s11, s13
    s_cmp_lt_u32 s11, 20
    s_cselect_b32 s13, 40, 0
    s_add_u32 s14, s60, s13
    s_sub_u32 s15, 80, s14
    s_lshr_b32 s10, s14, 4
    s_mul_i32 s10, s10, 48
    s_add_u32 s10, s10, s14
    v_xor_b32 v8, s10, v7
    v_lshl_add_u32 v54, v8, 4, v4
    s_lshr_b32 s10, s15, 4
    s_mul_i32 s10, s10, 48
    s_add_u32 s10, s10, s15
    v_xor_b32 v8, s10, v1
    v_lshl_add_u32 v56, v8, 4, v6
    s_sub_u32 s15, s15, 2
    s_lshr_b32 s10, s15, 4
    s_mul_i32 s10, s10, 48
    s_add_u32 s10, s10, s15
    v_xor_b32 v8, s10, v7
    v_lshl_add_u32 v55, v8, 4, v4
    s_waitcnt vmcnt(1)
    s_barrier
    ds_read_b128 v[192:195], v48
    ds_read_b128 v[196:199], v48 offset:40960
    ds_read_b128 v[200:203], v49
    ds_read_b128 v[204:207], v49 offset:40960
    ds_read_b128 v[208:211], v50
    ds_read_b128 v[212:215], v51
    ds_read_b128 v[216:219], v51 offset:40960
    ds_read_b128 v[220:223], v52
    ds_read_b128 v[224:227], v52 offset:40960
    ds_read_b128 v[228:231], v53
    ds_read_b128 v[232:235], v54
    ds_read_b128 v[236:239], v54 offset:40960
    ds_read_b128 v[240:243], v55
    ds_read_b128 v[244:247], v55 offset:40960
    ds_read_b128 v[248:251], v56
    buffer_load_dword v255, v253, s[52:55], s50 offen
    s_add_u32 s50, s50, s49
    s_waitcnt lgkmcnt(10)
    v_mfma_f32_16x16x32_bf16 v[8:11], v[32:35], v[192:195], 0
    v_mfma_f32_16x16x32_bf16 v[12:15], v[32:35], v[196:199], 0
    v_mfma_f32_16x16x32_bf16 v[8:11], v[36:39], v[200:203], v[8:11]
    v_mfma_f32_16x16x32_bf16 v[12:15], v[36:39], v[204:207], v[12:15]
    s_cmp_eq_u32 s58, 0
    s_cbranch_scc1 L_a_e_50
    v_mfma_f32_16x16x32_bf16 v[8:11], v[40:43], v[208:211], v[8:11]
    v_mfma_f32_16x16x32_bf16 v[12:15], v[44:47], v[208:211], v[12:15]
L_a_e_50:
    s_waitcnt lgkmcnt(5)
    v_mfma_f32_16x16x32_bf16 v[16:19], v[32:35], v[212:215], 0
    v_mfma_f32_16x16x32_bf16 v[20:23], v[32:35], v[216:219], 0
    v_mfma_f32_16x16x32_bf16 v[16:19], v[36:39], v[220:223], v[16:19]
    v_mfma_f32_16x16x32_bf16 v[20:23], v[36:39], v[224:227], v[20:23]
    s_cmp_eq_u32 s59, 0
    s_cbranch_scc1 L_a_e_51
    v_mfma_f32_16x16x32_bf16 v[16:19], v[40:43], v[228:231], v[16:19]
    v_mfma_f32_16x16x32_bf16 v[20:23], v[44:47], v[228:231], v[20:23]
L_a_e_51:
    s_waitcnt lgkmcnt(0)
    v_mfma_f32_16x16x32_bf16 v[24:27], v[32:35], v[232:235], 0
    v_mfma_f32_16x16x32_bf16 v[28:31], v[32:35], v[236:239], 0
    v_mfma_f32_16x16x32_bf16 v[24:27], v[36:39], v[240:243], v[24:27]
    v_mfma_f32_16x16x32_bf16 v[28:31], v[36:39], v[244:247], v[28:31]
    s_cmp_eq_u32 s60, 0
    s_cbranch_scc1 L_a_e_52
    v_mfma_f32_16x16x32_bf16 v[24:27], v[40:43], v[248:251], v[24:27]
    v_mfma_f32_16x16x32_bf16 v[28:31], v[44:47], v[248:251], v[28:31]
L_a_e_52:
    v_fma_f32 v192, v12, v189, v8
    v_fma_f32 v196, -v12, v189, v8
    v_fma_f32 v193, v13, v189, v9
    v_fma_f32 v197, -v13, v189, v9
    v_fma_f32 v194, v14, v189, v10
    v_fma_f32 v198, -v14, v189, v10
    v_fma_f32 v195, v15, v189, v11
    v_fma_f32 v199, -v15, v189, v11
    v_cvt_pk_bf16_f32 v200, v192, v193
    v_cvt_pk_bf16_f32 v201, v194, v195
    v_cvt_pk_bf16_f32 v202, v196, v197
    v_cvt_pk_bf16_f32 v203, v198, v199
    ds_write_b64 v60, v[200:201] offset:0
    ds_write_b64 v60, v[202:203] offset:10752
    v_fma_f32 v204, v20, v189, v16
    v_fma_f32 v208, -v20, v189, v16
    v_fma_f32 v205, v21, v189, v17
    v_fma_f32 v209, -v21, v189, v17
    v_fma_f32 v206, v22, v189, v18
    v_fma_f32 v210, -v22, v189, v18
    v_fma_f32 v207, v23, v189, v19
    v_fma_f32 v211, -v23, v189, v19
    v_cvt_pk_bf16_f32 v212, v204, v205
    v_cvt_pk_bf16_f32 v213, v206, v207
    v_cvt_pk_bf16_f32 v214, v208, v209
    v_cvt_pk_bf16_f32 v215, v210, v211
    ds_write_b64 v60, v[212:213] offset:512
    ds_write_b64 v60, v[214:215] offset:11264
    s_nop 1
    v_fma_f32 v216, v28, v189, v24
    v_fma_f32 v220, -v28, v189, v24
    v_fma_f32 v217, v29, v189, v25
    v_fma_f32 v221, -v29, v189, v25
    v_fma_f32 v218, v30, v189, v26
    v_fma_f32 v222, -v30, v189, v26
    v_fma_f32 v219, v31, v189, v27
    v_fma_f32 v223, -v31, v189, v27
    v_cvt_pk_bf16_f32 v224, v216, v217
    v_cvt_pk_bf16_f32 v225, v218, v219
    v_cvt_pk_bf16_f32 v226, v220, v221
    v_cvt_pk_bf16_f32 v227, v222, v223
    ds_write_b64 v60, v[224:225] offset:1024
    ds_write_b64 v60, v[226:227] offset:11776
    s_branch L_a_fdone
L_a_xr:
    v_min_u32 v9, 40, v0
    v_subrev_u32 v11, 20, v9
    v_cmp_gt_u32 vcc, 20, v11
    v_min_u32 v12, v9, v11
    v_mov_b32 v13, 640
    v_lshlrev_b32 v12, 4, v12
    v_cndmask_b32 v11, 0, v13, vcc
    v_add_u32 v11, v11, v12
    v_add_u32 v48, 81920, v11
    v_sub_u32 v49, 83184, v11
    v_cmp_eq_u32 vcc, 0, v12
    v_lshlrev_b32 v50, 8, v9
    v_add_u32 v50, 107520, v50
    v_cndmask_b32 v51, -1, 0, vcc
    v_mov_b32 v52, 0xffff0000
    s_waitcnt vmcnt(1)
    s_barrier
    ds_read_b128 v[32:35], v48 offset:0
    ds_read_b128 v[36:39], v49 offset:0
    ds_read_b32 v54, v49 offset:16
    ds_read_b128 v[40:43], v48 offset:1280
    ds_read_b128 v[44:47], v49 offset:1280
    ds_read_b32 v55, v49 offset:1296
    buffer_load_dword v255, v253, s[52:55], s50 offen
    s_add_u32 s50, s50, s49
    s_waitcnt lgkmcnt(0)
    v_and_b32 v54, v51, v54
    v_and_b32 v55, v51, v55
    v_lshlrev_b32 v8, 16, v32
    v_and_b32 v9, v52, v32
    v_lshlrev_b32 v10, 16, v54
    v_and_b32 v11, v52, v39
    v_lshlrev_b32 v12, 16, v40
    v_and_b32 v13, v52, v40
    v_lshlrev_b32 v14, 16, v55
    v_and_b32 v15, v52, v47
    v_add_f32 v8, v8, v14
    v_add_f32 v9, v9, v15
    v_add_f32 v10, v10, v12
    v_add_f32 v11, v11, v13
    v_fma_f32 v8, v10, v189, v8
    v_fma_f32 v9, v11, v189, v9
    v_cvt_pk_bf16_f32 v24, v8, v9
    v_lshlrev_b32 v8, 16, v33
    v_and_b32 v9, v52, v33
    v_lshlrev_b32 v10, 16, v39
    v_and_b32 v11, v52, v38
    v_lshlrev_b32 v12, 16, v41
    v_and_b32 v13, v52, v41
    v_lshlrev_b32 v14, 16, v47
    v_and_b32 v15, v52, v46
    v_add_f32 v8, v8, v14
    v_add_f32 v9, v9, v15
    v_add_f32 v10, v10, v12
    v_add_f32 v11, v11, v13
    v_fma_f32 v8, v10, v189, v8
    v_fma_f32 v9, v11, v189, v9
    v_cvt_pk_bf16_f32 v25, v8, v9
    v_lshlrev_b32 v8, 16, v34
    v_and_b32 v9, v52, v34
    v_lshlrev_b32 v10, 16, v38
    v_and_b32 v11, v52, v37
    v_lshlrev_b32 v12, 16, v42
    v_and_b32 v13, v52, v42
    v_lshlrev_b32 v14, 16, v46
    v_and_b32 v15, v52, v45
    v_add_f32 v8, v8, v14
    v_add_f32 v9, v9, v15
    v_add_f32 v10, v10, v12
    v_add_f32 v11, v11, v13
    v_fma_f32 v8, v10, v189, v8
    v_fma_f32 v9, v11, v189, v9
    v_cvt_pk_bf16_f32 v26, v8, v9
    v_lshlrev_b32 v8, 16, v35
    v_and_b32 v9, v52, v35
    v_lshlrev_b32 v10, 16, v37
    v_and_b32 v11, v52, v36
    v_lshlrev_b32 v12, 16, v43
    v_and_b32 v13, v52, v43
    v_lshlrev_b32 v14, 16, v45
    v_and_b32 v15, v52, v44
    v_add_f32 v8, v8, v14
    v_add_f32 v9, v9, v15
    v_add_f32 v10, v10, v12
    v_add_f32 v11, v11, v13
    v_fma_f32 v8, v10, v189, v8
    v_fma_f32 v9, v11, v189, v9
    v_cvt_pk_bf16_f32 v27, v8, v9
    ds_write_b128 v50, v[24:27]
L_a_fdone:
    v_and_b32 v1, 15, v0
    v_lshrrev_b32 v2, 4, v0
    v_lshlrev_b32 v10, 4, v0
    v_and_b32 v8, 0xf0, v10
    v_add_u32 v10, 96256, v8
    v_lshl_add_u32 v8, v2, 8, v8
    v_add_u32 v8, 86016, v8
    v_mov_b32 v245, 252
    s_cmp_lg_u32 s3, 4
    s_cbranch_scc1 L_a_n4
    buffer_load_dword v244, v245, s[40:43], 0 offen sc1
L_a_n4:
    s_cmp_lg_u32 s3, 7
    s_cbranch_scc1 L_a_n7
    v_lshlrev_b32 v8, 8, v2
    v_add_u32 v8, 107520, v8
    v_mov_b32 v10, 117760
L_a_n7:
    s_lshl_b32 s11, s8, 7
    s_lshl_b32 s12, s7, 1
    s_add_u32 s11, s11, s12
    v_and_b32 v3, 1, v2
    v_lshrrev_b32 v4, 1, v2
    v_lshl_add_u32 v3, v3, 6, v4
    v_add_u32 v3, s11, v3
    v_mul_u32_u24 v3, 336, v3
    s_mul_i32 s11, s9, 48
    v_add3_u32 v3, v3, v1, s11
    v_lshlrev_b32 v3, 4, v3
    v_add_u32 v11, 2752512, v3
    s_cmp_lg_u32 s3, 3
    s_cbranch_scc1 L_a_nt
    v_mul_u32_u24 v1, 0x289000, v0
    v_add_u32 v1, 0xf000, v1
    v_mul_u32_u24 v2, 2099200, v0
    v_add_u32 v2, 1280, v2
    buffer_load_dword v255, v1, s[36:39], 0 offen
    buffer_load_dword v255, v2, s[32:35], 0 offen
    v_and_b32 v1, 15, v0
    v_lshrrev_b32 v2, 4, v0
L_a_nt:
    s_waitcnt lgkmcnt(0)
    s_barrier
    ds_read_b128 v[32:35], v8 offset:0
    ds_read_b128 v[36:39], v8 offset:10752
    s_waitcnt lgkmcnt(0)
    ds_read_b128 v[40:43], v8 offset:1024
    v_mfma_f32_16x16x32_bf16 v[192:195], v[32:35], v[64:67], 0
    ds_read_b128 v[44:47], v8 offset:11776
    v_mfma_f32_16x16x32_bf16 v[196:199], v[32:35], v[104:107], 0
    v_mfma_f32_16x16x32_bf16 v[200:203], v[32:35], v[144:147], 0
    v_mfma_f32_16x16x32_bf16 v[204:207], v[36:39], v[64:67], 0
    v_mfma_f32_16x16x32_bf16 v[208:211], v[36:39], v[104:107], 0
    v_mfma_f32_16x16x32_bf16 v[212:215], v[36:39], v[144:147], 0
    buffer_load_dword v255, v253, s[52:55], s50 offen
    s_add_u32 s50, s50, s49
    s_waitcnt lgkmcnt(0)
    ds_read_b128 v[32:35], v8 offset:2048
    v_mfma_f32_16x16x32_bf16 v[192:195], v[40:43], v[68:71], v[192:195]
    ds_read_b128 v[36:39], v8 offset:12800
    v_mfma_f32_16x16x32_bf16 v[196:199], v[40:43], v[108:111], v[196:199]
    v_mfma_f32_16x16x32_bf16 v[200:203], v[40:43], v[148:151], v[200:203]
    v_mfma_f32_16x16x32_bf16 v[204:207], v[44:47], v[68:71], v[204:207]
    v_mfma_f32_16x16x32_bf16 v[208:211], v[44:47], v[108:111], v[208:211]
    v_mfma_f32_16x16x32_bf16 v[212:215], v[44:47], v[148:151], v[212:215]
    s_waitcnt lgkmcnt(0)
    ds_read_b128 v[40:43], v8 offset:3072
    v_mfma_f32_16x16x32_bf16 v[192:195], v[32:35], v[72:75], v[192:195]
    ds_read_b128 v[44:47], v8 offset:13824
    v_mfma_f32_16x16x32_bf16 v[196:199], v[32:35], v[112:115], v[196:199]
    v_mfma_f32_16x16x32_bf16 v[200:203], v[32:35], v[152:155], v[200:203]
    v_mfma_f32_16x16x32_bf16 v[204:207], v[36:39], v[72:75], v[204:207]
    v_mfma_f32_16x16x32_bf16 v[208:211], v[36:39], v[112:115], v[208:211]
    v_mfma_f32_16x16x32_bf16 v[212:215], v[36:39], v[152:155], v[212:215]
    s_waitcnt lgkmcnt(0)
    ds_read_b128 v[32:35], v8 offset:4096
    v_mfma_f32_16x16x32_bf16 v[192:195], v[40:43], v[76:79], v[192:195]
    ds_read_b128 v[36:39], v8 offset:14848
    v_mfma_f32_16x16x32_bf16 v[196:199], v[40:43], v[116:119], v[196:199]
    v_mfma_f32_16x16x32_bf16 v[200:203], v[40:43], v[156:159], v[200:203]
    v_mfma_f32_16x16x32_bf16 v[204:207], v[44:47], v[76:79], v[204:207]
    v_mfma_f32_16x16x32_bf16 v[208:211], v[44:47], v[116:119], v[208:211]
    v_mfma_f32_16x16x32_bf16 v[212:215], v[44:47], v[156:159], v[212:215]
    s_waitcnt lgkmcnt(0)
    ds_read_b128 v[40:43], v8 offset:5120
    v_mfma_f32_16x16x32_bf16 v[192:195], v[32:35], v[80:83], v[192:195]
    ds_read_b128 v[44:47], v8 offset:15872
    v_mfma_f32_16x16x32_bf16 v[196:199], v[32:35], v[120:123], v[196:199]
    v_mfma_f32_16x16x32_bf16 v[200:203], v[32:35], v[160:163], v[200:203]
    v_mfma_f32_16x16x32_bf16 v[204:207], v[36:39], v[80:83], v[204:207]
    v_mfma_f32_16x16x32_bf16 v[208:211], v[36:39], v[120:123], v[208:211]
    v_mfma_f32_16x16x32_bf16 v[212:215], v[36:39], v[160:163], v[212:215]
    s_waitcnt lgkmcnt(0)
    ds_read_b128 v[32:35], v8 offset:6144
    v_mfma_f32_16x16x32_bf16 v[192:195], v[40:43], v[84:87], v[192:195]
    ds_read_b128 v[36:39], v8 offset:16896
    v_mfma_f32_16x16x32_bf16 v[196:199], v[40:43], v[124:127], v[196:199]
    v_mfma_f32_16x16x32_bf16 v[200:203], v[40:43], v[164:167], v[200:203]
    v_mfma_f32_16x16x32_bf16 v[204:207], v[44:47], v[84:87], v[204:207]
    v_mfma_f32_16x16x32_bf16 v[208:211], v[44:47], v[124:127], v[208:211]
    v_mfma_f32_16x16x32_bf16 v[212:215], v[44:47], v[164:167], v[212:215]
    s_waitcnt lgkmcnt(0)
    ds_read_b128 v[40:43], v8 offset:7168
    v_mfma_f32_16x16x32_bf16 v[192:195], v[32:35], v[88:91], v[192:195]
    ds_read_b128 v[44:47], v8 offset:17920
    v_mfma_f32_16x16x32_bf16 v[196:199], v[32:35], v[128:131], v[196:199]
    v_mfma_f32_16x16x32_bf16 v[200:203], v[32:35], v[168:171], v[200:203]
    v_mfma_f32_16x16x32_bf16 v[204:207], v[36:39], v[88:91], v[204:207]
    v_mfma_f32_16x16x32_bf16 v[208:211], v[36:39], v[128:131], v[208:211]
    v_mfma_f32_16x16x32_bf16 v[212:215], v[36:39], v[168:171], v[212:215]
    s_waitcnt lgkmcnt(0)
    ds_read_b128 v[32:35], v8 offset:8192
    v_mfma_f32_16x16x32_bf16 v[192:195], v[40:43], v[92:95], v[192:195]
    ds_read_b128 v[36:39], v8 offset:18944
    v_mfma_f32_16x16x32_bf16 v[196:199], v[40:43], v[132:135], v[196:199]
    v_mfma_f32_16x16x32_bf16 v[200:203], v[40:43], v[172:175], v[200:203]
    v_mfma_f32_16x16x32_bf16 v[204:207], v[44:47], v[92:95], v[204:207]
    v_mfma_f32_16x16x32_bf16 v[208:211], v[44:47], v[132:135], v[208:211]
    v_mfma_f32_16x16x32_bf16 v[212:215], v[44:47], v[172:175], v[212:215]
    s_waitcnt lgkmcnt(0)
    ds_read_b128 v[40:43], v8 offset:9216
    v_mfma_f32_16x16x32_bf16 v[192:195], v[32:35], v[96:99], v[192:195]
    ds_read_b128 v[44:47], v8 offset:19968
    v_mfma_f32_16x16x32_bf16 v[196:199], v[32:35], v[136:139], v[196:199]
    v_mfma_f32_16x16x32_bf16 v[200:203], v[32:35], v[176:179], v[200:203]
    v_mfma_f32_16x16x32_bf16 v[204:207], v[36:39], v[96:99], v[204:207]
    v_mfma_f32_16x16x32_bf16 v[208:211], v[36:39], v[136:139], v[208:211]
    v_mfma_f32_16x16x32_bf16 v[212:215], v[36:39], v[176:179], v[212:215]
    s_waitcnt lgkmcnt(0)
    ds_read_b128 v[32:35], v10 offset:0
    v_mfma_f32_16x16x32_bf16 v[192:195], v[40:43], v[100:103], v[192:195]
    ds_read_b128 v[36:39], v10 offset:10752
    v_mfma_f32_16x16x32_bf16 v[196:199], v[40:43], v[140:143], v[196:199]
    v_mfma_f32_16x16x32_bf16 v[200:203], v[40:43], v[180:183], v[200:203]
    v_mfma_f32_16x16x32_bf16 v[204:207], v[44:47], v[100:103], v[204:207]
    v_mfma_f32_16x16x32_bf16 v[208:211], v[44:47], v[140:143], v[208:211]
    v_mfma_f32_16x16x32_bf16 v[212:215], v[44:47], v[180:183], v[212:215]
    s_waitcnt lgkmcnt(0)
    v_mfma_f32_16x16x32_bf16 v[192:195], v[32:35], v[184:187], v[192:195]
    v_mfma_f32_16x16x32_bf16 v[196:199], v[32:35], v[184:187], v[196:199]
    v_mfma_f32_16x16x32_bf16 v[200:203], v[32:35], v[184:187], v[200:203]
    v_mfma_f32_16x16x32_bf16 v[204:207], v[36:39], v[184:187], v[204:207]
    v_mfma_f32_16x16x32_bf16 v[208:211], v[36:39], v[184:187], v[208:211]
    v_mfma_f32_16x16x32_bf16 v[212:215], v[36:39], v[184:187], v[212:215]
    s_cmp_eq_u32 s3, 7
    s_cbranch_scc1 L_a_v
    s_nop 4
    v_cvt_pk_bf16_f32 v12, v192, v193
    v_cvt_pk_bf16_f32 v13, v194, v195
    v_cvt_pk_bf16_f32 v14, v204, v205
    v_cvt_pk_bf16_f32 v15, v206, v207
    s_nop 1
    v_permlane16_swap_b32 v12, v14
    v_permlane16_swap_b32 v13, v15
    buffer_store_dwordx4 v[12:15], v11, s[36:39], 0 offen offset:0 sc1
    v_cvt_pk_bf16_f32 v16, v196, v197
    v_cvt_pk_bf16_f32 v17, v198, v199
    v_cvt_pk_bf16_f32 v18, v208, v209
    v_cvt_pk_bf16_f32 v19, v210, v211
    s_nop 1
    v_permlane16_swap_b32 v16, v18
    v_permlane16_swap_b32 v17, v19
    buffer_store_dwordx4 v[16:19], v11, s[36:39], 0 offen offset:256 sc1
    v_cvt_pk_bf16_f32 v20, v200, v201
    v_cvt_pk_bf16_f32 v21, v202, v203
    v_cvt_pk_bf16_f32 v22, v212, v213
    v_cvt_pk_bf16_f32 v23, v214, v215
    s_nop 1
    v_permlane16_swap_b32 v20, v22
    v_permlane16_swap_b32 v21, v23
    buffer_store_dwordx4 v[20:23], v11, s[36:39], 0 offen offset:512 sc1
    s_branch L_a_pub
L_a_v:
    v_mov_b32 v16, 0
    s_cmp_ge_u32 s7, 7
    s_cbranch_scc1 L_a_pub
    s_mul_i32 s11, s8, 336
    s_mul_i32 s12, s9, 48
    s_add_u32 s11, s11, s12
    s_lshl_b32 s11, s11, 2
    s_add_u32 s11, s11, 49152
    v_lshl_add_u32 v3, v0, 2, s11
    s_mov_b64 exec, 0xffff
    buffer_store_dword v192, v3, s[36:39], 0 offen sc1
    buffer_store_dword v196, v3, s[36:39], 0 offen offset:64 sc1
    buffer_store_dword v200, v3, s[36:39], 0 offen offset:128 sc1
    s_mov_b64 exec, -1
L_a_pub:
    s_lshl_b32 s10, s4, 1
    s_add_u32 s10, s10, s6
    s_sub_u32 s10, s10, 6
    s_cmp_ge_u32 s10, 6
    s_cselect_b32 s11, 9, 8
    s_cselect_b32 s12, 6, 0
    s_sub_u32 s12, s10, s12
    s_cmp_lt_u32 s6, 6
    s_cselect_b32 s9, s4, s11
    s_cselect_b32 s14, s6, s12
    s_cmp_ge_u32 s9, 5
    s_cselect_b32 s12, 1, 0
    s_mul_i32 s10, s12, 5
    s_sub_u32 s13, s9, s10
    s_and_b32 s15, s3, 1
    s_bfe_u32 s10, s3, 0x10001
    s_add_u32 s10, s10, 4
    s_cmp_lt_u32 s3, 4
    s_cselect_b32 s16, s3, s10
    v_lshlrev_b32 v3, 3, v2
    s_cmp_eq_u32 s15, 0
    s_cselect_b32 s11, 0, 0xbe800000
    v_mov_b32 v5, s11
    s_mul_i32 s10, s14, 6
    s_add_u32 s10, s10, s16
    s_lshl_b32 s10, s10, 5
    s_add_u32 s62, s10, s12
    v_lshl_add_u32 v30, v1, 1, s62
    v_cvt_f32_u32 v6, v3
    v_xor_b32 v31, 32, v30
    s_cmp_ge_u32 s3, 4
    s_cbranch_scc1 L_a_g0
    v_cvt_f32_u32 v8, v31
    v_mul_f32 v4, 0x3a000000, v8
    v_mul_f32 v10, 0x3c800000, v8
    v_fma_f32 v32, v6, v4, v5
    v_cos_f32 v9, v4
    v_add_f32 v40, v32, v10
    v_cos_f32 v10, v10
    v_add_f32 v33, v32, v4
    v_add_f32 v41, v40, v4
    v_cos_f32 v32, v32
    v_cos_f32 v40, v40
    v_cos_f32 v33, v33
    v_cos_f32 v41, v41
    v_add_f32 v9, v9, v9
    v_add_f32 v10, v10, v10
    v_fma_f32 v34, v9, v33, -v32
    v_fma_f32 v42, v9, v41, -v40
    v_fma_f32 v35, v9, v34, -v33
    v_fma_f32 v43, v9, v42, -v41
    v_fma_f32 v36, v9, v35, -v34
    v_fma_f32 v44, v9, v43, -v42
    v_fma_f32 v37, v9, v36, -v35
    v_fma_f32 v45, v9, v44, -v43
    v_fma_f32 v38, v9, v37, -v36
    v_fma_f32 v46, v9, v45, -v44
    v_fma_f32 v39, v9, v38, -v37
    v_fma_f32 v47, v9, v46, -v45
    v_cvt_pk_bf16_f32 v128, v32, v33
    v_cvt_pk_bf16_f32 v129, v34, v35
    v_cvt_pk_bf16_f32 v130, v36, v37
    v_cvt_pk_bf16_f32 v131, v38, v39
    v_cvt_pk_bf16_f32 v132, v40, v41
    v_cvt_pk_bf16_f32 v133, v42, v43
    v_cvt_pk_bf16_f32 v134, v44, v45
    v_cvt_pk_bf16_f32 v135, v46, v47
    v_pk_fma_f32 v[32:33], v[10:11], v[40:41], v[32:33] op_sel_hi:[0,1,1] neg_lo:[0,0,1] neg_hi:[0,0,1]
    v_pk_fma_f32 v[34:35], v[10:11], v[42:43], v[34:35] op_sel_hi:[0,1,1] neg_lo:[0,0,1] neg_hi:[0,0,1]
    v_pk_fma_f32 v[36:37], v[10:11], v[44:45], v[36:37] op_sel_hi:[0,1,1] neg_lo:[0,0,1] neg_hi:[0,0,1]
    v_pk_fma_f32 v[38:39], v[10:11], v[46:47], v[38:39] op_sel_hi:[0,1,1] neg_lo:[0,0,1] neg_hi:[0,0,1]
    v_cvt_pk_bf16_f32 v136, v32, v33
    v_cvt_pk_bf16_f32 v137, v34, v35
    v_cvt_pk_bf16_f32 v138, v36, v37
    v_cvt_pk_bf16_f32 v139, v38, v39
    v_pk_fma_f32 v[40:41], v[10:11], v[32:33], v[40:41] op_sel_hi:[0,1,1] neg_lo:[0,0,1] neg_hi:[0,0,1]
    v_pk_fma_f32 v[42:43], v[10:11], v[34:35], v[42:43] op_sel_hi:[0,1,1] neg_lo:[0,0,1] neg_hi:[0,0,1]
    v_pk_fma_f32 v[44:45], v[10:11], v[36:37], v[44:45] op_sel_hi:[0,1,1] neg_lo:[0,0,1] neg_hi:[0,0,1]
    v_pk_fma_f32 v[46:47], v[10:11], v[38:39], v[46:47] op_sel_hi:[0,1,1] neg_lo:[0,0,1] neg_hi:[0,0,1]
    v_cvt_pk_bf16_f32 v140, v40, v41
    v_cvt_pk_bf16_f32 v141, v42, v43
    v_cvt_pk_bf16_f32 v142, v44, v45
    v_cvt_pk_bf16_f32 v143, v46, v47
    v_pk_fma_f32 v[32:33], v[10:11], v[40:41], v[32:33] op_sel_hi:[0,1,1] neg_lo:[0,0,1] neg_hi:[0,0,1]
    v_pk_fma_f32 v[34:35], v[10:11], v[42:43], v[34:35] op_sel_hi:[0,1,1] neg_lo:[0,0,1] neg_hi:[0,0,1]
    v_pk_fma_f32 v[36:37], v[10:11], v[44:45], v[36:37] op_sel_hi:[0,1,1] neg_lo:[0,0,1] neg_hi:[0,0,1]
    v_pk_fma_f32 v[38:39], v[10:11], v[46:47], v[38:39] op_sel_hi:[0,1,1] neg_lo:[0,0,1] neg_hi:[0,0,1]
    v_cvt_pk_bf16_f32 v144, v32, v33
    v_cvt_pk_bf16_f32 v145, v34, v35
    v_cvt_pk_bf16_f32 v146, v36, v37
    v_cvt_pk_bf16_f32 v147, v38, v39
    v_pk_fma_f32 v[40:41], v[10:11], v[32:33], v[40:41] op_sel_hi:[0,1,1] neg_lo:[0,0,1] neg_hi:[0,0,1]
    v_pk_fma_f32 v[42:43], v[10:11], v[34:35], v[42:43] op_sel_hi:[0,1,1] neg_lo:[0,0,1] neg_hi:[0,0,1]
    v_pk_fma_f32 v[44:45], v[10:11], v[36:37], v[44:45] op_sel_hi:[0,1,1] neg_lo:[0,0,1] neg_hi:[0,0,1]
    v_pk_fma_f32 v[46:47], v[10:11], v[38:39], v[46:47] op_sel_hi:[0,1,1] neg_lo:[0,0,1] neg_hi:[0,0,1]
    v_cvt_pk_bf16_f32 v148, v40, v41
    v_cvt_pk_bf16_f32 v149, v42, v43
    v_cvt_pk_bf16_f32 v150, v44, v45
    v_cvt_pk_bf16_f32 v151, v46, v47
    v_pk_fma_f32 v[32:33], v[10:11], v[40:41], v[32:33] op_sel_hi:[0,1,1] neg_lo:[0,0,1] neg_hi:[0,0,1]
    v_pk_fma_f32 v[34:35], v[10:11], v[42:43], v[34:35] op_sel_hi:[0,1,1] neg_lo:[0,0,1] neg_hi:[0,0,1]
    v_pk_fma_f32 v[36:37], v[10:11], v[44:45], v[36:37] op_sel_hi:[0,1,1] neg_lo:[0,0,1] neg_hi:[0,0,1]
    v_pk_fma_f32 v[38:39], v[10:11], v[46:47], v[38:39] op_sel_hi:[0,1,1] neg_lo:[0,0,1] neg_hi:[0,0,1]
    v_cvt_pk_bf16_f32 v152, v32, v33
    v_cvt_pk_bf16_f32 v153, v34, v35
    v_cvt_pk_bf16_f32 v154, v36, v37
    v_cvt_pk_bf16_f32 v155, v38, v39
    v_pk_fma_f32 v[40:41], v[10:11], v[32:33], v[40:41] op_sel_hi:[0,1,1] neg_lo:[0,0,1] neg_hi:[0,0,1]
    v_pk_fma_f32 v[42:43], v[10:11], v[34:35], v[42:43] op_sel_hi:[0,1,1] neg_lo:[0,0,1] neg_hi:[0,0,1]
    v_pk_fma_f32 v[44:45], v[10:11], v[36:37], v[44:45] op_sel_hi:[0,1,1] neg_lo:[0,0,1] neg_hi:[0,0,1]
    v_pk_fma_f32 v[46:47], v[10:11], v[38:39], v[46:47] op_sel_hi:[0,1,1] neg_lo:[0,0,1] neg_hi:[0,0,1]
    v_cvt_pk_bf16_f32 v156, v40, v41
    v_cvt_pk_bf16_f32 v157, v42, v43
    v_cvt_pk_bf16_f32 v158, v44, v45
    v_cvt_pk_bf16_f32 v159, v46, v47
    v_pk_fma_f32 v[32:33], v[10:11], v[40:41], v[32:33] op_sel_hi:[0,1,1] neg_lo:[0,0,1] neg_hi:[0,0,1]
    v_pk_fma_f32 v[34:35], v[10:11], v[42:43], v[34:35] op_sel_hi:[0,1,1] neg_lo:[0,0,1] neg_hi:[0,0,1]
    v_pk_fma_f32 v[36:37], v[10:11], v[44:45], v[36:37] op_sel_hi:[0,1,1] neg_lo:[0,0,1] neg_hi:[0,0,1]
    v_pk_fma_f32 v[38:39], v[10:11], v[46:47], v[38:39] op_sel_hi:[0,1,1] neg_lo:[0,0,1] neg_hi:[0,0,1]
    v_cvt_pk_bf16_f32 v160, v32, v33
    v_cvt_pk_bf16_f32 v161, v34, v35
    v_cvt_pk_bf16_f32 v162, v36, v37
    v_cvt_pk_bf16_f32 v163, v38, v39
    v_pk_fma_f32 v[40:41], v[10:11], v[32:33], v[40:41] op_sel_hi:[0,1,1] neg_lo:[0,0,1] neg_hi:[0,0,1]
    v_pk_fma_f32 v[42:43], v[10:11], v[34:35], v[42:43] op_sel_hi:[0,1,1] neg_lo:[0,0,1] neg_hi:[0,0,1]
    v_pk_fma_f32 v[44:45], v[10:11], v[36:37], v[44:45] op_sel_hi:[0,1,1] neg_lo:[0,0,1] neg_hi:[0,0,1]
    v_pk_fma_f32 v[46:47], v[10:11], v[38:39], v[46:47] op_sel_hi:[0,1,1] neg_lo:[0,0,1] neg_hi:[0,0,1]
    v_cvt_pk_bf16_f32 v164, v40, v41
    v_cvt_pk_bf16_f32 v165, v42, v43
    v_cvt_pk_bf16_f32 v166, v44, v45
    v_cvt_pk_bf16_f32 v167, v46, v47
    v_pk_fma_f32 v[32:33], v[10:11], v[40:41], v[32:33] op_sel_hi:[0,1,1] neg_lo:[0,0,1] neg_hi:[0,0,1]
    v_pk_fma_f32 v[34:35], v[10:11], v[42:43], v[34:35] op_sel_hi:[0,1,1] neg_lo:[0,0,1] neg_hi:[0,0,1]
    v_pk_fma_f32 v[36:37], v[10:11], v[44:45], v[36:37] op_sel_hi:[0,1,1] neg_lo:[0,0,1] neg_hi:[0,0,1]
    v_pk_fma_f32 v[38:39], v[10:11], v[46:47], v[38:39] op_sel_hi:[0,1,1] neg_lo:[0,0,1] neg_hi:[0,0,1]
    v_cvt_pk_bf16_f32 v168, v32, v33
    v_cvt_pk_bf16_f32 v169, v34, v35
    v_cvt_pk_bf16_f32 v170, v36, v37
    v_cvt_pk_bf16_f32 v171, v38, v39
    v_pk_fma_f32 v[40:41], v[10:11], v[32:33], v[40:41] op_sel_hi:[0,1,1] neg_lo:[0,0,1] neg_hi:[0,0,1]
    v_pk_fma_f32 v[42:43], v[10:11], v[34:35], v[42:43] op_sel_hi:[0,1,1] neg_lo:[0,0,1] neg_hi:[0,0,1]
    v_pk_fma_f32 v[44:45], v[10:11], v[36:37], v[44:45] op_sel_hi:[0,1,1] neg_lo:[0,0,1] neg_hi:[0,0,1]
    v_pk_fma_f32 v[46:47], v[10:11], v[38:39], v[46:47] op_sel_hi:[0,1,1] neg_lo:[0,0,1] neg_hi:[0,0,1]
    v_cvt_pk_bf16_f32 v172, v40, v41
    v_cvt_pk_bf16_f32 v173, v42, v43
    v_cvt_pk_bf16_f32 v174, v44, v45
    v_cvt_pk_bf16_f32 v175, v46, v47
    v_pk_fma_f32 v[32:33], v[10:11], v[40:41], v[32:33] op_sel_hi:[0,1,1] neg_lo:[0,0,1] neg_hi:[0,0,1]
    v_pk_fma_f32 v[34:35], v[10:11], v[42:43], v[34:35] op_sel_hi:[0,1,1] neg_lo:[0,0,1] neg_hi:[0,0,1]
    v_pk_fma_f32 v[36:37], v[10:11], v[44:45], v[36:37] op_sel_hi:[0,1,1] neg_lo:[0,0,1] neg_hi:[0,0,1]
    v_pk_fma_f32 v[38:39], v[10:11], v[46:47], v[38:39] op_sel_hi:[0,1,1] neg_lo:[0,0,1] neg_hi:[0,0,1]
    v_cvt_pk_bf16_f32 v176, v32, v33
    v_cvt_pk_bf16_f32 v177, v34, v35
    v_cvt_pk_bf16_f32 v178, v36, v37
    v_cvt_pk_bf16_f32 v179, v38, v39
    v_pk_fma_f32 v[40:41], v[10:11], v[32:33], v[40:41] op_sel_hi:[0,1,1] neg_lo:[0,0,1] neg_hi:[0,0,1]
    v_pk_fma_f32 v[42:43], v[10:11], v[34:35], v[42:43] op_sel_hi:[0,1,1] neg_lo:[0,0,1] neg_hi:[0,0,1]
    v_pk_fma_f32 v[44:45], v[10:11], v[36:37], v[44:45] op_sel_hi:[0,1,1] neg_lo:[0,0,1] neg_hi:[0,0,1]
    v_pk_fma_f32 v[46:47], v[10:11], v[38:39], v[46:47] op_sel_hi:[0,1,1] neg_lo:[0,0,1] neg_hi:[0,0,1]
    v_cvt_pk_bf16_f32 v180, v40, v41
    v_cvt_pk_bf16_f32 v181, v42, v43
    v_cvt_pk_bf16_f32 v182, v44, v45
    v_cvt_pk_bf16_f32 v183, v46, v47
    v_pk_fma_f32 v[32:33], v[10:11], v[40:41], v[32:33] op_sel_hi:[0,1,1] neg_lo:[0,0,1] neg_hi:[0,0,1]
    v_pk_fma_f32 v[34:35], v[10:11], v[42:43], v[34:35] op_sel_hi:[0,1,1] neg_lo:[0,0,1] neg_hi:[0,0,1]
    v_pk_fma_f32 v[36:37], v[10:11], v[44:45], v[36:37] op_sel_hi:[0,1,1] neg_lo:[0,0,1] neg_hi:[0,0,1]
    v_pk_fma_f32 v[38:39], v[10:11], v[46:47], v[38:39] op_sel_hi:[0,1,1] neg_lo:[0,0,1] neg_hi:[0,0,1]
    v_cvt_pk_bf16_f32 v184, v32, v33
    v_cvt_pk_bf16_f32 v185, v34, v35
    v_cvt_pk_bf16_f32 v186, v36, v37
    v_cvt_pk_bf16_f32 v187, v38, v39
    v_pk_fma_f32 v[40:41], v[10:11], v[32:33], v[40:41] op_sel_hi:[0,1,1] neg_lo:[0,0,1] neg_hi:[0,0,1]
    v_pk_fma_f32 v[42:43], v[10:11], v[34:35], v[42:43] op_sel_hi:[0,1,1] neg_lo:[0,0,1] neg_hi:[0,0,1]
    v_pk_fma_f32 v[44:45], v[10:11], v[36:37], v[44:45] op_sel_hi:[0,1,1] neg_lo:[0,0,1] neg_hi:[0,0,1]
    v_pk_fma_f32 v[46:47], v[10:11], v[38:39], v[46:47] op_sel_hi:[0,1,1] neg_lo:[0,0,1] neg_hi:[0,0,1]
    v_cvt_pk_bf16_f32 v188, v40, v41
    v_cvt_pk_bf16_f32 v189, v42, v43
    v_cvt_pk_bf16_f32 v190, v44, v45
    v_cvt_pk_bf16_f32 v191, v46, v47
    s_branch L_a_g2
L_a_g0:
    v_mov_b32 v63, v5
    v_mov_b32 v52, v6
    s_mul_i32 s17, s15, 81920
    s_lshl_b32 s10, s15, 1
    s_add_u32 s10, s10, s12
    s_lshl_b32 s10, s10, 4
    s_bfe_u32 s11, s3, 0x10001
    s_add_u32 s10, s10, s11
    s_mul_i32 s10, s10, 21504
    s_lshl_b32 s18, s13, 10
    s_add_u32 s10, s10, s18
    s_add_u32 s10, s10, 2752512
    s_mul_i32 s11, s11, 5120
    s_add_u32 s48, s17, s11
    v_bfrev_b32 v7, 1
    v_add_u32 v3, 0, v0
    v_mul_u32_u24 v4, 820, v3
    v_lshrrev_b32 v4, 16, v4
    v_mul_u32_u24 v5, 80, v4
    v_sub_u32 v5, v3, v5
    v_cmp_gt_u32 vcc, 72, v5
    v_lshlrev_b32 v4, 12, v4
    v_lshl_add_u32 v3, v3, 4, v4
    v_add_u32 v3, s10, v3
    v_cndmask_b32 v12, v7, v3, vcc
    v_add_u32 v3, 64, v0
    v_mul_u32_u24 v4, 820, v3
    v_lshrrev_b32 v4, 16, v4
    v_mul_u32_u24 v5, 80, v4
    v_sub_u32 v5, v3, v5
    v_cmp_gt_u32 vcc, 72, v5
    v_lshlrev_b32 v4, 12, v4
    v_lshl_add_u32 v3, v3, 4, v4
    v_add_u32 v3, s10, v3
    v_cndmask_b32 v13, v7, v3, vcc
    v_add_u32 v3, 128, v0
    v_mul_u32_u24 v4, 820, v3
    v_lshrrev_b32 v4, 16, v4
    v_mul_u32_u24 v5, 80, v4
    v_sub_u32 v5, v3, v5
    v_cmp_gt_u32 vcc, 72, v5
    v_lshlrev_b32 v4, 12, v4
    v_lshl_add_u32 v3, v3, 4, v4
    v_add_u32 v3, s10, v3
    v_cndmask_b32 v14, v7, v3, vcc
    v_add_u32 v3, 192, v0
    v_mul_u32_u24 v4, 820, v3
    v_lshrrev_b32 v4, 16, v4
    v_mul_u32_u24 v5, 80, v4
    v_sub_u32 v5, v3, v5
    v_cmp_gt_u32 vcc, 72, v5
    v_lshlrev_b32 v4, 12, v4
    v_lshl_add_u32 v3, v3, 4, v4
    v_add_u32 v3, s10, v3
    v_cndmask_b32 v15, v7, v3, vcc
    v_add_u32 v3, 256, v0
    v_mul_u32_u24 v4, 820, v3
    v_lshrrev_b32 v4, 16, v4
    v_mul_u32_u24 v5, 80, v4
    v_sub_u32 v5, v3, v5
    v_cmp_gt_u32 vcc, 72, v5
    v_lshlrev_b32 v4, 12, v4
    v_lshl_add_u32 v3, v3, 4, v4
    v_add_u32 v3, s10, v3
    v_cndmask_b32 v16, v7, v3, vcc
    v_mul_u32_u24 v9, 1280, v2
    v_lshl_add_u32 v9, v1, 4, v9
    v_add_u32 v9, s17, v9
    v_add_u32 v8, 40960, v9
    s_mul_i32 s10, s12, 336
    s_lshl_b32 s11, s13, 6
    s_add_u32 s10, s10, s11
    s_lshl_b32 s10, s10, 2
    s_add_u32 s10, s10, 49152
    v_lshl_add_u32 v10, v0, 3, s10
    v_and_b32 v3, 1, v0
    v_lshlrev_b32 v3, 31, v3
    v_or_b32 v11, 1.0, v3
    s_lshr_b32 s10, s3, 2
    s_mul_i32 s10, s10, 81920
    s_and_b32 s11, s3, 3
    s_mul_i32 s11, s11, 5120
    s_add_u32 s19, s10, s11
    s_and_b32 s11, s14, 3
    s_mul_i32 s10, s11, 20480
    s_add_u32 s10, s10, s19
    v_lshl_add_u32 v17, v0, 4, s10
    s_cmp_eq_u32 s15, 0
    s_movk_i32 s18, 5120
    s_cselect_b32 s18, s18, -5120
    v_add_u32 v18, s18, v17
    s_add_u32 s11, s11, 2
    s_and_b32 s11, s11, 3
    s_mul_i32 s18, s11, 20480
    s_add_u32 s18, s18, s19
    s_add_u32 s11, s11, 3
    s_and_b32 s11, s11, 3
    s_mul_i32 s10, s11, 20480
    s_add_u32 s10, s10, s19
    v_and_b32 v3, 1, v2
    v_lshl_add_u32 v3, v3, 4, v1
    v_mul_u32_u24 v3, 144, v3
    v_lshrrev_b32 v4, 1, v2
    v_lshlrev_b32 v4, 4, v4
    v_add3_u32 v19, v3, v4, s10
    v_sub_u32 v3, v3, v4
    s_add_u32 s11, s18, 16
    v_add_u32 v20, s11, v3
    v_lshrrev_b32 v3, 3, v0
    v_and_b32 v4, 7, v0
    v_lshlrev_b32 v4, 4, v4
    v_mul_u32_u24 v5, 144, v3
    v_add3_u32 v21, v5, v4, s10
    v_add3_u32 v57, v5, v4, s18
    s_sub_u32 s11, s10, s19
    s_add_u32 s11, s11, 4608
    v_lshl_add_u32 v56, v2, 4, s11
    v_lshl_add_u32 v62, v0, 3, s11
    v_lshl_add_u32 v3, v3, 1, s62
    v_bfrev_b32 v7, 1
    s_movk_i32 s10, 2560
    v_sub_u32 v5, 2048, v3
    v_cmp_gt_u32 vcc, 1025, v3
    v_mad_u32_u24 v6, v3, s10, v4
    v_mad_u32_u24 v5, v5, s10, v4
    v_cndmask_b32 v24, v7, v6, vcc
    v_cmp_gt_u32 vcc, 1024, v3
    v_add_u32 v3, 16, v3
    v_mov_b32 v23, 0xffff
    v_cndmask_b32 v26, v7, v5, vcc
    v_sub_u32 v5, 2048, v3
    v_cmp_gt_u32 vcc, 1025, v3
    v_mad_u32_u24 v6, v3, s10, v4
    v_mad_u32_u24 v5, v5, s10, v4
    v_cndmask_b32 v25, v7, v6, vcc
    v_cmp_gt_u32 vcc, 1024, v3
    v_add_u32 v3, 16, v3
    v_mov_b32 v23, 0xffff
    v_cndmask_b32 v27, v7, v5, vcc
    v_subrev_u32 v28, 32, v0
    v_ashrrev_i32 v28, 31, v28
    v_and_b32 v28, v28, v23
    v_xor_b32 v29, v28, v23
    s_lshl_b32 s58, s13, 7
    s_sub_u32 s59, 1152, s58
    v_mov_b32 v53, v8
    v_mov_b32 v54, v9
    v_mov_b32 v55, v10
    v_mov_b32 v5, v63
    v_mov_b32 v6, v52
L_a_g2:
    s_waitcnt vmcnt(0)
    s_barrier
    s_cmp_lg_u32 s3, 4
    s_cbranch_scc1 L_a_noflag
    v_readfirstlane_b32 s56, v244
    s_mov_b32 s57, 0
L_epa:
    s_cmp_lg_u32 s56, 0
    s_cbranch_scc1 L_gotepa
    buffer_load_dword v244, v245, s[40:43], 0 offen sc1
    s_add_u32 s57, s57, 1
    s_waitcnt vmcnt(0)
    v_readfirstlane_b32 s56, v244
    s_cmp_lt_u32 s57, 262144
    s_cbranch_scc1 L_epa
L_gotepa:
    s_lshl_b32 s10, s7, 1
    s_add_u32 s10, s10, s8
    s_lshl_b32 s10, s10, 7
    s_add_u32 s10, s10, 32768
    v_lshl_add_u32 v1, v0, 2, s10
    v_mov_b32 v2, s56
    s_mov_b64 exec, 0xffffffff
    buffer_store_dword v2, v1, s[36:39], 0 offen sc1
    s_mov_b64 exec, -1
    v_and_b32 v1, 15, v0
    v_lshrrev_b32 v2, 4, v0
L_a_noflag:
    s_cmp_ge_u32 s14, 6
    s_cbranch_scc1 L_a_fin
    v_cvt_f32_u32 v8, v30
    v_mul_f32 v4, 0x3a000000, v8
    v_mul_f32 v10, 0x3c800000, v8
    v_fma_f32 v32, v6, v4, v5
    v_cos_f32 v9, v4
    v_add_f32 v40, v32, v10
    v_cos_f32 v10, v10
    v_add_f32 v33, v32, v4
    v_add_f32 v41, v40, v4
    v_cos_f32 v32, v32
    v_cos_f32 v40, v40
    v_cos_f32 v33, v33
    v_cos_f32 v41, v41
    v_add_f32 v9, v9, v9
    v_add_f32 v10, v10, v10
    v_fma_f32 v34, v9, v33, -v32
    v_fma_f32 v42, v9, v41, -v40
    v_fma_f32 v35, v9, v34, -v33
    v_fma_f32 v43, v9, v42, -v41
    v_fma_f32 v36, v9, v35, -v34
    v_fma_f32 v44, v9, v43, -v42
    v_fma_f32 v37, v9, v36, -v35
    v_fma_f32 v45, v9, v44, -v43
    v_fma_f32 v38, v9, v37, -v36
    v_fma_f32 v46, v9, v45, -v44
    v_fma_f32 v39, v9, v38, -v37
    v_fma_f32 v47, v9, v46, -v45
    v_cvt_pk_bf16_f32 v64, v32, v33
    v_cvt_pk_bf16_f32 v65, v34, v35
    v_cvt_pk_bf16_f32 v66, v36, v37
    v_cvt_pk_bf16_f32 v67, v38, v39
    v_cvt_pk_bf16_f32 v68, v40, v41
    v_cvt_pk_bf16_f32 v69, v42, v43
    v_cvt_pk_bf16_f32 v70, v44, v45
    v_cvt_pk_bf16_f32 v71, v46, v47
    v_pk_fma_f32 v[32:33], v[10:11], v[40:41], v[32:33] op_sel_hi:[0,1,1] neg_lo:[0,0,1] neg_hi:[0,0,1]
    v_pk_fma_f32 v[34:35], v[10:11], v[42:43], v[34:35] op_sel_hi:[0,1,1] neg_lo:[0,0,1] neg_hi:[0,0,1]
    v_pk_fma_f32 v[36:37], v[10:11], v[44:45], v[36:37] op_sel_hi:[0,1,1] neg_lo:[0,0,1] neg_hi:[0,0,1]
    v_pk_fma_f32 v[38:39], v[10:11], v[46:47], v[38:39] op_sel_hi:[0,1,1] neg_lo:[0,0,1] neg_hi:[0,0,1]
    v_cvt_pk_bf16_f32 v72, v32, v33
    v_cvt_pk_bf16_f32 v73, v34, v35
    v_cvt_pk_bf16_f32 v74, v36, v37
    v_cvt_pk_bf16_f32 v75, v38, v39
    v_pk_fma_f32 v[40:41], v[10:11], v[32:33], v[40:41] op_sel_hi:[0,1,1] neg_lo:[0,0,1] neg_hi:[0,0,1]
    v_pk_fma_f32 v[42:43], v[10:11], v[34:35], v[42:43] op_sel_hi:[0,1,1] neg_lo:[0,0,1] neg_hi:[0,0,1]
    v_pk_fma_f32 v[44:45], v[10:11], v[36:37], v[44:45] op_sel_hi:[0,1,1] neg_lo:[0,0,1] neg_hi:[0,0,1]
    v_pk_fma_f32 v[46:47], v[10:11], v[38:39], v[46:47] op_sel_hi:[0,1,1] neg_lo:[0,0,1] neg_hi:[0,0,1]
    v_cvt_pk_bf16_f32 v76, v40, v41
    v_cvt_pk_bf16_f32 v77, v42, v43
    v_cvt_pk_bf16_f32 v78, v44, v45
    v_cvt_pk_bf16_f32 v79, v46, v47
    v_pk_fma_f32 v[32:33], v[10:11], v[40:41], v[32:33] op_sel_hi:[0,1,1] neg_lo:[0,0,1] neg_hi:[0,0,1]
    v_pk_fma_f32 v[34:35], v[10:11], v[42:43], v[34:35] op_sel_hi:[0,1,1] neg_lo:[0,0,1] neg_hi:[0,0,1]
    v_pk_fma_f32 v[36:37], v[10:11], v[44:45], v[36:37] op_sel_hi:[0,1,1] neg_lo:[0,0,1] neg_hi:[0,0,1]
    v_pk_fma_f32 v[38:39], v[10:11], v[46:47], v[38:39] op_sel_hi:[0,1,1] neg_lo:[0,0,1] neg_hi:[0,0,1]
    v_cvt_pk_bf16_f32 v80, v32, v33
    v_cvt_pk_bf16_f32 v81, v34, v35
    v_cvt_pk_bf16_f32 v82, v36, v37
    v_cvt_pk_bf16_f32 v83, v38, v39
    v_pk_fma_f32 v[40:41], v[10:11], v[32:33], v[40:41] op_sel_hi:[0,1,1] neg_lo:[0,0,1] neg_hi:[0,0,1]
    v_pk_fma_f32 v[42:43], v[10:11], v[34:35], v[42:43] op_sel_hi:[0,1,1] neg_lo:[0,0,1] neg_hi:[0,0,1]
    v_pk_fma_f32 v[44:45], v[10:11], v[36:37], v[44:45] op_sel_hi:[0,1,1] neg_lo:[0,0,1] neg_hi:[0,0,1]
    v_pk_fma_f32 v[46:47], v[10:11], v[38:39], v[46:47] op_sel_hi:[0,1,1] neg_lo:[0,0,1] neg_hi:[0,0,1]
    v_cvt_pk_bf16_f32 v84, v40, v41
    v_cvt_pk_bf16_f32 v85, v42, v43
    v_cvt_pk_bf16_f32 v86, v44, v45
    v_cvt_pk_bf16_f32 v87, v46, v47
    v_pk_fma_f32 v[32:33], v[10:11], v[40:41], v[32:33] op_sel_hi:[0,1,1] neg_lo:[0,0,1] neg_hi:[0,0,1]
    v_pk_fma_f32 v[34:35], v[10:11], v[42:43], v[34:35] op_sel_hi:[0,1,1] neg_lo:[0,0,1] neg_hi:[0,0,1]
    v_pk_fma_f32 v[36:37], v[10:11], v[44:45], v[36:37] op_sel_hi:[0,1,1] neg_lo:[0,0,1] neg_hi:[0,0,1]
    v_pk_fma_f32 v[38:39], v[10:11], v[46:47], v[38:39] op_sel_hi:[0,1,1] neg_lo:[0,0,1] neg_hi:[0,0,1]
    v_cvt_pk_bf16_f32 v88, v32, v33
    v_cvt_pk_bf16_f32 v89, v34, v35
    v_cvt_pk_bf16_f32 v90, v36, v37
    v_cvt_pk_bf16_f32 v91, v38, v39
    v_pk_fma_f32 v[40:41], v[10:11], v[32:33], v[40:41] op_sel_hi:[0,1,1] neg_lo:[0,0,1] neg_hi:[0,0,1]
    v_pk_fma_f32 v[42:43], v[10:11], v[34:35], v[42:43] op_sel_hi:[0,1,1] neg_lo:[0,0,1] neg_hi:[0,0,1]
    v_pk_fma_f32 v[44:45], v[10:11], v[36:37], v[44:45] op_sel_hi:[0,1,1] neg_lo:[0,0,1] neg_hi:[0,0,1]
    v_pk_fma_f32 v[46:47], v[10:11], v[38:39], v[46:47] op_sel_hi:[0,1,1] neg_lo:[0,0,1] neg_hi:[0,0,1]
    v_cvt_pk_bf16_f32 v92, v40, v41
    v_cvt_pk_bf16_f32 v93, v42, v43
    v_cvt_pk_bf16_f32 v94, v44, v45
    v_cvt_pk_bf16_f32 v95, v46, v47
    v_pk_fma_f32 v[32:33], v[10:11], v[40:41], v[32:33] op_sel_hi:[0,1,1] neg_lo:[0,0,1] neg_hi:[0,0,1]
    v_pk_fma_f32 v[34:35], v[10:11], v[42:43], v[34:35] op_sel_hi:[0,1,1] neg_lo:[0,0,1] neg_hi:[0,0,1]
    v_pk_fma_f32 v[36:37], v[10:11], v[44:45], v[36:37] op_sel_hi:[0,1,1] neg_lo:[0,0,1] neg_hi:[0,0,1]
    v_pk_fma_f32 v[38:39], v[10:11], v[46:47], v[38:39] op_sel_hi:[0,1,1] neg_lo:[0,0,1] neg_hi:[0,0,1]
    v_cvt_pk_bf16_f32 v96, v32, v33
    v_cvt_pk_bf16_f32 v97, v34, v35
    v_cvt_pk_bf16_f32 v98, v36, v37
    v_cvt_pk_bf16_f32 v99, v38, v39
    v_pk_fma_f32 v[40:41], v[10:11], v[32:33], v[40:41] op_sel_hi:[0,1,1] neg_lo:[0,0,1] neg_hi:[0,0,1]
    v_pk_fma_f32 v[42:43], v[10:11], v[34:35], v[42:43] op_sel_hi:[0,1,1] neg_lo:[0,0,1] neg_hi:[0,0,1]
    v_pk_fma_f32 v[44:45], v[10:11], v[36:37], v[44:45] op_sel_hi:[0,1,1] neg_lo:[0,0,1] neg_hi:[0,0,1]
    v_pk_fma_f32 v[46:47], v[10:11], v[38:39], v[46:47] op_sel_hi:[0,1,1] neg_lo:[0,0,1] neg_hi:[0,0,1]
    v_cvt_pk_bf16_f32 v100, v40, v41
    v_cvt_pk_bf16_f32 v101, v42, v43
    v_cvt_pk_bf16_f32 v102, v44, v45
    v_cvt_pk_bf16_f32 v103, v46, v47
    v_pk_fma_f32 v[32:33], v[10:11], v[40:41], v[32:33] op_sel_hi:[0,1,1] neg_lo:[0,0,1] neg_hi:[0,0,1]
    v_pk_fma_f32 v[34:35], v[10:11], v[42:43], v[34:35] op_sel_hi:[0,1,1] neg_lo:[0,0,1] neg_hi:[0,0,1]
    v_pk_fma_f32 v[36:37], v[10:11], v[44:45], v[36:37] op_sel_hi:[0,1,1] neg_lo:[0,0,1] neg_hi:[0,0,1]
    v_pk_fma_f32 v[38:39], v[10:11], v[46:47], v[38:39] op_sel_hi:[0,1,1] neg_lo:[0,0,1] neg_hi:[0,0,1]
    v_cvt_pk_bf16_f32 v104, v32, v33
    v_cvt_pk_bf16_f32 v105, v34, v35
    v_cvt_pk_bf16_f32 v106, v36, v37
    v_cvt_pk_bf16_f32 v107, v38, v39
    v_pk_fma_f32 v[40:41], v[10:11], v[32:33], v[40:41] op_sel_hi:[0,1,1] neg_lo:[0,0,1] neg_hi:[0,0,1]
    v_pk_fma_f32 v[42:43], v[10:11], v[34:35], v[42:43] op_sel_hi:[0,1,1] neg_lo:[0,0,1] neg_hi:[0,0,1]
    v_pk_fma_f32 v[44:45], v[10:11], v[36:37], v[44:45] op_sel_hi:[0,1,1] neg_lo:[0,0,1] neg_hi:[0,0,1]
    v_pk_fma_f32 v[46:47], v[10:11], v[38:39], v[46:47] op_sel_hi:[0,1,1] neg_lo:[0,0,1] neg_hi:[0,0,1]
    v_cvt_pk_bf16_f32 v108, v40, v41
    v_cvt_pk_bf16_f32 v109, v42, v43
    v_cvt_pk_bf16_f32 v110, v44, v45
    v_cvt_pk_bf16_f32 v111, v46, v47
    v_pk_fma_f32 v[32:33], v[10:11], v[40:41], v[32:33] op_sel_hi:[0,1,1] neg_lo:[0,0,1] neg_hi:[0,0,1]
    v_pk_fma_f32 v[34:35], v[10:11], v[42:43], v[34:35] op_sel_hi:[0,1,1] neg_lo:[0,0,1] neg_hi:[0,0,1]
    v_pk_fma_f32 v[36:37], v[10:11], v[44:45], v[36:37] op_sel_hi:[0,1,1] neg_lo:[0,0,1] neg_hi:[0,0,1]
    v_pk_fma_f32 v[38:39], v[10:11], v[46:47], v[38:39] op_sel_hi:[0,1,1] neg_lo:[0,0,1] neg_hi:[0,0,1]
    v_cvt_pk_bf16_f32 v112, v32, v33
    v_cvt_pk_bf16_f32 v113, v34, v35
    v_cvt_pk_bf16_f32 v114, v36, v37
    v_cvt_pk_bf16_f32 v115, v38, v39
    v_pk_fma_f32 v[40:41], v[10:11], v[32:33], v[40:41] op_sel_hi:[0,1,1] neg_lo:[0,0,1] neg_hi:[0,0,1]
    v_pk_fma_f32 v[42:43], v[10:11], v[34:35], v[42:43] op_sel_hi:[0,1,1] neg_lo:[0,0,1] neg_hi:[0,0,1]
    v_pk_fma_f32 v[44:45], v[10:11], v[36:37], v[44:45] op_sel_hi:[0,1,1] neg_lo:[0,0,1] neg_hi:[0,0,1]
    v_pk_fma_f32 v[46:47], v[10:11], v[38:39], v[46:47] op_sel_hi:[0,1,1] neg_lo:[0,0,1] neg_hi:[0,0,1]
    v_cvt_pk_bf16_f32 v116, v40, v41
    v_cvt_pk_bf16_f32 v117, v42, v43
    v_cvt_pk_bf16_f32 v118, v44, v45
    v_cvt_pk_bf16_f32 v119, v46, v47
    v_pk_fma_f32 v[32:33], v[10:11], v[40:41], v[32:33] op_sel_hi:[0,1,1] neg_lo:[0,0,1] neg_hi:[0,0,1]
    v_pk_fma_f32 v[34:35], v[10:11], v[42:43], v[34:35] op_sel_hi:[0,1,1] neg_lo:[0,0,1] neg_hi:[0,0,1]
    v_pk_fma_f32 v[36:37], v[10:11], v[44:45], v[36:37] op_sel_hi:[0,1,1] neg_lo:[0,0,1] neg_hi:[0,0,1]
    v_pk_fma_f32 v[38:39], v[10:11], v[46:47], v[38:39] op_sel_hi:[0,1,1] neg_lo:[0,0,1] neg_hi:[0,0,1]
    v_cvt_pk_bf16_f32 v120, v32, v33
    v_cvt_pk_bf16_f32 v121, v34, v35
    v_cvt_pk_bf16_f32 v122, v36, v37
    v_cvt_pk_bf16_f32 v123, v38, v39
    v_pk_fma_f32 v[40:41], v[10:11], v[32:33], v[40:41] op_sel_hi:[0,1,1] neg_lo:[0,0,1] neg_hi:[0,0,1]
    v_pk_fma_f32 v[42:43], v[10:11], v[34:35], v[42:43] op_sel_hi:[0,1,1] neg_lo:[0,0,1] neg_hi:[0,0,1]
    v_pk_fma_f32 v[44:45], v[10:11], v[36:37], v[44:45] op_sel_hi:[0,1,1] neg_lo:[0,0,1] neg_hi:[0,0,1]
    v_pk_fma_f32 v[46:47], v[10:11], v[38:39], v[46:47] op_sel_hi:[0,1,1] neg_lo:[0,0,1] neg_hi:[0,0,1]
    v_cvt_pk_bf16_f32 v124, v40, v41
    v_cvt_pk_bf16_f32 v125, v42, v43
    v_cvt_pk_bf16_f32 v126, v44, v45
    v_cvt_pk_bf16_f32 v127, v46, v47
    s_cmp_ge_u32 s3, 4
    s_cbranch_scc1 L_a_s1
    s_mul_i32 s17, s15, 81920
    v_mul_u32_u24 v9, 1280, v2
    v_lshl_add_u32 v9, v1, 4, v9
    v_add_u32 v9, s17, v9
    v_add_u32 v8, 40960, v9
    s_mul_i32 s10, s12, 336
    s_lshl_b32 s11, s13, 6
    s_add_u32 s10, s10, s11
    s_lshl_b32 s10, s10, 2
    s_add_u32 s10, s10, 49152
    v_lshl_add_u32 v10, v0, 3, s10
    v_and_b32 v3, 1, v0
    v_lshlrev_b32 v3, 31, v3
    v_or_b32 v11, 1.0, v3
    s_lshr_b32 s10, s3, 2
    s_mul_i32 s10, s10, 81920
    s_and_b32 s11, s3, 3
    s_mul_i32 s11, s11, 5120
    s_add_u32 s19, s10, s11
    s_and_b32 s11, s14, 3
    s_mul_i32 s10, s11, 20480
    s_add_u32 s10, s10, s19
    v_lshl_add_u32 v17, v0, 4, s10
    s_cmp_eq_u32 s15, 0
    s_movk_i32 s18, 5120
    s_cselect_b32 s18, s18, -5120
    v_add_u32 v18, s18, v17
    s_add_u32 s11, s11, 2
    s_and_b32 s11, s11, 3
    s_mul_i32 s18, s11, 20480
    s_add_u32 s18, s18, s19
    s_add_u32 s11, s11, 3
    s_and_b32 s11, s11, 3
    s_mul_i32 s10, s11, 20480
    s_add_u32 s10, s10, s19
    v_and_b32 v3, 1, v2
    v_lshl_add_u32 v3, v3, 4, v1
    v_mul_u32_u24 v3, 144, v3
    v_lshrrev_b32 v4, 1, v2
    v_lshlrev_b32 v4, 4, v4
    v_add3_u32 v19, v3, v4, s10
    v_sub_u32 v3, v3, v4
    s_add_u32 s11, s18, 16
    v_add_u32 v20, s11, v3
    v_lshrrev_b32 v3, 3, v0
    v_and_b32 v4, 7, v0
    v_lshlrev_b32 v4, 4, v4
    v_mul_u32_u24 v5, 144, v3
    v_add3_u32 v21, v5, v4, s10
    v_add3_u32 v57, v5, v4, s18
    s_sub_u32 s11, s10, s19
    s_add_u32 s11, s11, 4608
    v_lshl_add_u32 v56, v2, 4, s11
    v_lshl_add_u32 v62, v0, 3, s11
    v_lshl_add_u32 v3, v3, 1, s62
    v_bfrev_b32 v7, 1
    s_movk_i32 s10, 2560
    v_sub_u32 v5, 2048, v3
    v_cmp_gt_u32 vcc, 1025, v3
    v_mad_u32_u24 v6, v3, s10, v4
    v_mad_u32_u24 v5, v5, s10, v4
    v_cndmask_b32 v24, v7, v6, vcc
    v_cmp_gt_u32 vcc, 1024, v3
    v_add_u32 v3, 16, v3
    v_mov_b32 v23, 0xffff
    v_cndmask_b32 v26, v7, v5, vcc
    v_sub_u32 v5, 2048, v3
    v_cmp_gt_u32 vcc, 1025, v3
    v_mad_u32_u24 v6, v3, s10, v4
    v_mad_u32_u24 v5, v5, s10, v4
    v_cndmask_b32 v25, v7, v6, vcc
    v_cmp_gt_u32 vcc, 1024, v3
    v_add_u32 v3, 16, v3
    v_mov_b32 v23, 0xffff
    v_cndmask_b32 v27, v7, v5, vcc
    v_subrev_u32 v28, 32, v0
    v_ashrrev_i32 v28, 31, v28
    v_and_b32 v28, v28, v23
    v_xor_b32 v29, v28, v23
    s_lshl_b32 s58, s13, 7
    s_sub_u32 s59, 1152, s58
    s_branch L_a_s2
L_a_s1:
    v_mov_b32 v8, v53
    v_mov_b32 v9, v54
    v_mov_b32 v10, v55
L_a_s2:
    s_cmp_lg_u32 s3, 4
    s_cbranch_scc1 L_polleda
    v_lshlrev_b32 v22, 7, v0
    v_add_u32 v22, 32768, v22
    buffer_load_dword v4, v22, s[36:39], 0 offen sc1
    s_sleep 2
    buffer_load_dword v5, v22, s[36:39], 0 offen sc1
    s_sleep 2
    buffer_load_dword v6, v22, s[36:39], 0 offen sc1
    s_sleep 2
L_polla:
    buffer_load_dword v7, v22, s[36:39], 0 offen sc1
    s_waitcnt vmcnt(3)
    v_cmp_ne_u32 vcc, s56, v4
    s_cbranch_vccz L_polleda
    buffer_load_dword v4, v22, s[36:39], 0 offen sc1
    s_waitcnt vmcnt(3)
    v_cmp_ne_u32 vcc, s56, v5
    s_cbranch_vccz L_polleda
    buffer_load_dword v5, v22, s[36:39], 0 offen sc1
    s_waitcnt vmcnt(3)
    v_cmp_ne_u32 vcc, s56, v6
    s_cbranch_vccz L_polleda
    buffer_load_dword v6, v22, s[36:39], 0 offen sc1
    s_waitcnt vmcnt(3)
    v_cmp_ne_u32 vcc, s56, v7
    s_cbranch_vccz L_polleda
    s_add_u32 s57, s57, 1
    s_cmp_lt_u32 s57, 262144
    s_cbranch_scc1 L_polla
L_polleda:
    s_barrier
    s_and_b32 s10, s14, 3
    s_cmp_ge_u32 s3, 4
    s_cbranch_scc1 L_a_short
    s_cmp_eq_u32 s10, 1
    s_cbranch_scc1 L_a_g01
    s_cmp_eq_u32 s10, 2
    s_cbranch_scc1 L_a_g02
    s_cmp_eq_u32 s10, 3
    s_cbranch_scc1 L_a_g03
    s_barrier
    ds_read_b128 v[32:35], v9 offset:0
    ds_read_b128 v[36:39], v9 offset:256
    ds_read_b128 v[40:43], v9 offset:512
    ds_read_b128 v[44:47], v9 offset:768
    ds_read_b128 v[48:51], v9 offset:1024
    s_waitcnt lgkmcnt(0)
    v_mfma_f32_16x16x32_bf16 v[192:195], v[32:35], v[64:67], 0
    ds_read_b128 v[232:235], v9 offset:5120
    v_mfma_f32_16x16x32_bf16 v[196:199], v[36:39], v[64:67], 0
    ds_read_b128 v[236:239], v9 offset:5376
    v_mfma_f32_16x16x32_bf16 v[200:203], v[40:43], v[64:67], 0
    ds_read_b128 v[240:243], v9 offset:5632
    v_mfma_f32_16x16x32_bf16 v[204:207], v[44:47], v[64:67], 0
    ds_read_b128 v[244:247], v9 offset:5888
    v_mfma_f32_16x16x32_bf16 v[208:211], v[48:51], v[64:67], 0
    ds_read_b128 v[248:251], v9 offset:6144
    v_mfma_f32_16x16x32_bf16 v[212:215], v[32:35], v[128:131], 0
    v_mfma_f32_16x16x32_bf16 v[216:219], v[36:39], v[128:131], 0
    v_mfma_f32_16x16x32_bf16 v[220:223], v[40:43], v[128:131], 0
    v_mfma_f32_16x16x32_bf16 v[224:227], v[44:47], v[128:131], 0
    v_mfma_f32_16x16x32_bf16 v[228:231], v[48:51], v[128:131], 0
    s_waitcnt lgkmcnt(0)
    s_barrier
    v_mfma_f32_16x16x32_bf16 v[192:195], v[232:235], v[68:71], v[192:195]
    ds_read_b128 v[32:35], v9 offset:10240
    v_mfma_f32_16x16x32_bf16 v[196:199], v[236:239], v[68:71], v[196:199]
    ds_read_b128 v[36:39], v9 offset:10496
    v_mfma_f32_16x16x32_bf16 v[200:203], v[240:243], v[68:71], v[200:203]
    ds_read_b128 v[40:43], v9 offset:10752
    v_mfma_f32_16x16x32_bf16 v[204:207], v[244:247], v[68:71], v[204:207]
    ds_read_b128 v[44:47], v9 offset:11008
    v_mfma_f32_16x16x32_bf16 v[208:211], v[248:251], v[68:71], v[208:211]
    ds_read_b128 v[48:51], v9 offset:11264
    v_mfma_f32_16x16x32_bf16 v[212:215], v[232:235], v[132:135], v[212:215]
    v_mfma_f32_16x16x32_bf16 v[216:219], v[236:239], v[132:135], v[216:219]
    v_mfma_f32_16x16x32_bf16 v[220:223], v[240:243], v[132:135], v[220:223]
    v_mfma_f32_16x16x32_bf16 v[224:227], v[244:247], v[132:135], v[224:227]
    v_mfma_f32_16x16x32_bf16 v[228:231], v[248:251], v[132:135], v[228:231]
    s_waitcnt lgkmcnt(0)
    v_mfma_f32_16x16x32_bf16 v[192:195], v[32:35], v[72:75], v[192:195]
    ds_read_b128 v[232:235], v9 offset:15360
    v_mfma_f32_16x16x32_bf16 v[196:199], v[36:39], v[72:75], v[196:199]
    ds_read_b128 v[236:239], v9 offset:15616
    v_mfma_f32_16x16x32_bf16 v[200:203], v[40:43], v[72:75], v[200:203]
    ds_read_b128 v[240:243], v9 offset:15872
    v_mfma_f32_16x16x32_bf16 v[204:207], v[44:47], v[72:75], v[204:207]
    ds_read_b128 v[244:247], v9 offset:16128
    v_mfma_f32_16x16x32_bf16 v[208:211], v[48:51], v[72:75], v[208:211]
    ds_read_b128 v[248:251], v9 offset:16384
    v_mfma_f32_16x16x32_bf16 v[212:215], v[32:35], v[136:139], v[212:215]
    v_mfma_f32_16x16x32_bf16 v[216:219], v[36:39], v[136:139], v[216:219]
    v_mfma_f32_16x16x32_bf16 v[220:223], v[40:43], v[136:139], v[220:223]
    v_mfma_f32_16x16x32_bf16 v[224:227], v[44:47], v[136:139], v[224:227]
    v_mfma_f32_16x16x32_bf16 v[228:231], v[48:51], v[136:139], v[228:231]
    s_waitcnt lgkmcnt(0)
    s_barrier
    v_mfma_f32_16x16x32_bf16 v[192:195], v[232:235], v[76:79], v[192:195]
    ds_read_b128 v[32:35], v9 offset:20480
    v_mfma_f32_16x16x32_bf16 v[196:199], v[236:239], v[76:79], v[196:199]
    ds_read_b128 v[36:39], v9 offset:20736
    v_mfma_f32_16x16x32_bf16 v[200:203], v[240:243], v[76:79], v[200:203]
    ds_read_b128 v[40:43], v9 offset:20992
    v_mfma_f32_16x16x32_bf16 v[204:207], v[244:247], v[76:79], v[204:207]
    ds_read_b128 v[44:47], v9 offset:21248
    v_mfma_f32_16x16x32_bf16 v[208:211], v[248:251], v[76:79], v[208:211]
    ds_read_b128 v[48:51], v9 offset:21504
    v_mfma_f32_16x16x32_bf16 v[212:215], v[232:235], v[140:143], v[212:215]
    v_mfma_f32_16x16x32_bf16 v[216:219], v[236:239], v[140:143], v[216:219]
    v_mfma_f32_16x16x32_bf16 v[220:223], v[240:243], v[140:143], v[220:223]
    v_mfma_f32_16x16x32_bf16 v[224:227], v[244:247], v[140:143], v[224:227]
    v_mfma_f32_16x16x32_bf16 v[228:231], v[248:251], v[140:143], v[228:231]
    s_waitcnt lgkmcnt(0)
    v_mfma_f32_16x16x32_bf16 v[192:195], v[32:35], v[80:83], v[192:195]
    ds_read_b128 v[232:235], v9 offset:25600
    v_mfma_f32_16x16x32_bf16 v[196:199], v[36:39], v[80:83], v[196:199]
    ds_read_b128 v[236:239], v9 offset:25856
    v_mfma_f32_16x16x32_bf16 v[200:203], v[40:43], v[80:83], v[200:203]
    ds_read_b128 v[240:243], v9 offset:26112
    v_mfma_f32_16x16x32_bf16 v[204:207], v[44:47], v[80:83], v[204:207]
    ds_read_b128 v[244:247], v9 offset:26368
    v_mfma_f32_16x16x32_bf16 v[208:211], v[48:51], v[80:83], v[208:211]
    ds_read_b128 v[248:251], v9 offset:26624
    v_mfma_f32_16x16x32_bf16 v[212:215], v[32:35], v[144:147], v[212:215]
    v_mfma_f32_16x16x32_bf16 v[216:219], v[36:39], v[144:147], v[216:219]
    v_mfma_f32_16x16x32_bf16 v[220:223], v[40:43], v[144:147], v[220:223]
    v_mfma_f32_16x16x32_bf16 v[224:227], v[44:47], v[144:147], v[224:227]
    v_mfma_f32_16x16x32_bf16 v[228:231], v[48:51], v[144:147], v[228:231]
    s_waitcnt lgkmcnt(0)
    s_barrier
    v_mfma_f32_16x16x32_bf16 v[192:195], v[232:235], v[84:87], v[192:195]
    ds_read_b128 v[32:35], v9 offset:30720
    v_mfma_f32_16x16x32_bf16 v[196:199], v[236:239], v[84:87], v[196:199]
    ds_read_b128 v[36:39], v9 offset:30976
    v_mfma_f32_16x16x32_bf16 v[200:203], v[240:243], v[84:87], v[200:203]
    ds_read_b128 v[40:43], v9 offset:31232
    v_mfma_f32_16x16x32_bf16 v[204:207], v[244:247], v[84:87], v[204:207]
    ds_read_b128 v[44:47], v9 offset:31488
    v_mfma_f32_16x16x32_bf16 v[208:211], v[248:251], v[84:87], v[208:211]
    ds_read_b128 v[48:51], v9 offset:31744
    v_mfma_f32_16x16x32_bf16 v[212:215], v[232:235], v[148:151], v[212:215]
    v_mfma_f32_16x16x32_bf16 v[216:219], v[236:239], v[148:151], v[216:219]
    v_mfma_f32_16x16x32_bf16 v[220:223], v[240:243], v[148:151], v[220:223]
    v_mfma_f32_16x16x32_bf16 v[224:227], v[244:247], v[148:151], v[224:227]
    v_mfma_f32_16x16x32_bf16 v[228:231], v[248:251], v[148:151], v[228:231]
    s_waitcnt lgkmcnt(0)
    v_mfma_f32_16x16x32_bf16 v[192:195], v[32:35], v[88:91], v[192:195]
    ds_read_b128 v[232:235], v9 offset:35840
    v_mfma_f32_16x16x32_bf16 v[196:199], v[36:39], v[88:91], v[196:199]
    ds_read_b128 v[236:239], v9 offset:36096
    v_mfma_f32_16x16x32_bf16 v[200:203], v[40:43], v[88:91], v[200:203]
    ds_read_b128 v[240:243], v9 offset:36352
    v_mfma_f32_16x16x32_bf16 v[204:207], v[44:47], v[88:91], v[204:207]
    ds_read_b128 v[244:247], v9 offset:36608
    v_mfma_f32_16x16x32_bf16 v[208:211], v[48:51], v[88:91], v[208:211]
    ds_read_b128 v[248:251], v9 offset:36864
    v_mfma_f32_16x16x32_bf16 v[212:215], v[32:35], v[152:155], v[212:215]
    v_mfma_f32_16x16x32_bf16 v[216:219], v[36:39], v[152:155], v[216:219]
    v_mfma_f32_16x16x32_bf16 v[220:223], v[40:43], v[152:155], v[220:223]
    v_mfma_f32_16x16x32_bf16 v[224:227], v[44:47], v[152:155], v[224:227]
    v_mfma_f32_16x16x32_bf16 v[228:231], v[48:51], v[152:155], v[228:231]
    s_waitcnt lgkmcnt(0)
    s_barrier
    v_mfma_f32_16x16x32_bf16 v[192:195], v[232:235], v[92:95], v[192:195]
    ds_read_b128 v[32:35], v8 offset:0
    v_mfma_f32_16x16x32_bf16 v[196:199], v[236:239], v[92:95], v[196:199]
    ds_read_b128 v[36:39], v8 offset:256
    v_mfma_f32_16x16x32_bf16 v[200:203], v[240:243], v[92:95], v[200:203]
    ds_read_b128 v[40:43], v8 offset:512
    v_mfma_f32_16x16x32_bf16 v[204:207], v[244:247], v[92:95], v[204:207]
    ds_read_b128 v[44:47], v8 offset:768
    v_mfma_f32_16x16x32_bf16 v[208:211], v[248:251], v[92:95], v[208:211]
    ds_read_b128 v[48:51], v8 offset:1024
    v_mfma_f32_16x16x32_bf16 v[212:215], v[232:235], v[156:159], v[212:215]
    v_mfma_f32_16x16x32_bf16 v[216:219], v[236:239], v[156:159], v[216:219]
    v_mfma_f32_16x16x32_bf16 v[220:223], v[240:243], v[156:159], v[220:223]
    v_mfma_f32_16x16x32_bf16 v[224:227], v[244:247], v[156:159], v[224:227]
    v_mfma_f32_16x16x32_bf16 v[228:231], v[248:251], v[156:159], v[228:231]
    s_waitcnt lgkmcnt(0)
    v_mfma_f32_16x16x32_bf16 v[192:195], v[32:35], v[96:99], v[192:195]
    ds_read_b128 v[232:235], v8 offset:5120
    v_mfma_f32_16x16x32_bf16 v[196:199], v[36:39], v[96:99], v[196:199]
    ds_read_b128 v[236:239], v8 offset:5376
    v_mfma_f32_16x16x32_bf16 v[200:203], v[40:43], v[96:99], v[200:203]
    ds_read_b128 v[240:243], v8 offset:5632
    v_mfma_f32_16x16x32_bf16 v[204:207], v[44:47], v[96:99], v[204:207]
    ds_read_b128 v[244:247], v8 offset:5888
    v_mfma_f32_16x16x32_bf16 v[208:211], v[48:51], v[96:99], v[208:211]
    ds_read_b128 v[248:251], v8 offset:6144
    v_mfma_f32_16x16x32_bf16 v[212:215], v[32:35], v[160:163], v[212:215]
    v_mfma_f32_16x16x32_bf16 v[216:219], v[36:39], v[160:163], v[216:219]
    v_mfma_f32_16x16x32_bf16 v[220:223], v[40:43], v[160:163], v[220:223]
    v_mfma_f32_16x16x32_bf16 v[224:227], v[44:47], v[160:163], v[224:227]
    v_mfma_f32_16x16x32_bf16 v[228:231], v[48:51], v[160:163], v[228:231]
    s_waitcnt lgkmcnt(0)
    v_mfma_f32_16x16x32_bf16 v[192:195], v[232:235], v[100:103], v[192:195]
    ds_read_b128 v[32:35], v8 offset:10240
    v_mfma_f32_16x16x32_bf16 v[196:199], v[236:239], v[100:103], v[196:199]
    ds_read_b128 v[36:39], v8 offset:10496
    v_mfma_f32_16x16x32_bf16 v[200:203], v[240:243], v[100:103], v[200:203]
    ds_read_b128 v[40:43], v8 offset:10752
    v_mfma_f32_16x16x32_bf16 v[204:207], v[244:247], v[100:103], v[204:207]
    ds_read_b128 v[44:47], v8 offset:11008
    v_mfma_f32_16x16x32_bf16 v[208:211], v[248:251], v[100:103], v[208:211]
    ds_read_b128 v[48:51], v8 offset:11264
    v_mfma_f32_16x16x32_bf16 v[212:215], v[232:235], v[164:167], v[212:215]
    v_mfma_f32_16x16x32_bf16 v[216:219], v[236:239], v[164:167], v[216:219]
    v_mfma_f32_16x16x32_bf16 v[220:223], v[240:243], v[164:167], v[220:223]
    v_mfma_f32_16x16x32_bf16 v[224:227], v[244:247], v[164:167], v[224:227]
    v_mfma_f32_16x16x32_bf16 v[228:231], v[248:251], v[164:167], v[228:231]
    s_waitcnt lgkmcnt(0)
    v_mfma_f32_16x16x32_bf16 v[192:195], v[32:35], v[104:107], v[192:195]
    ds_read_b128 v[232:235], v8 offset:15360
    v_mfma_f32_16x16x32_bf16 v[196:199], v[36:39], v[104:107], v[196:199]
    ds_read_b128 v[236:239], v8 offset:15616
    v_mfma_f32_16x16x32_bf16 v[200:203], v[40:43], v[104:107], v[200:203]
    ds_read_b128 v[240:243], v8 offset:15872
    v_mfma_f32_16x16x32_bf16 v[204:207], v[44:47], v[104:107], v[204:207]
    ds_read_b128 v[244:247], v8 offset:16128
    v_mfma_f32_16x16x32_bf16 v[208:211], v[48:51], v[104:107], v[208:211]
    ds_read_b128 v[248:251], v8 offset:16384
    v_mfma_f32_16x16x32_bf16 v[212:215], v[32:35], v[168:171], v[212:215]
    v_mfma_f32_16x16x32_bf16 v[216:219], v[36:39], v[168:171], v[216:219]
    v_mfma_f32_16x16x32_bf16 v[220:223], v[40:43], v[168:171], v[220:223]
    v_mfma_f32_16x16x32_bf16 v[224:227], v[44:47], v[168:171], v[224:227]
    v_mfma_f32_16x16x32_bf16 v[228:231], v[48:51], v[168:171], v[228:231]
    s_waitcnt lgkmcnt(0)
    s_barrier
    v_mfma_f32_16x16x32_bf16 v[192:195], v[232:235], v[108:111], v[192:195]
    ds_read_b128 v[32:35], v8 offset:20480
    v_mfma_f32_16x16x32_bf16 v[196:199], v[236:239], v[108:111], v[196:199]
    ds_read_b128 v[36:39], v8 offset:20736
    v_mfma_f32_16x16x32_bf16 v[200:203], v[240:243], v[108:111], v[200:203]
    ds_read_b128 v[40:43], v8 offset:20992
    v_mfma_f32_16x16x32_bf16 v[204:207], v[244:247], v[108:111], v[204:207]
    ds_read_b128 v[44:47], v8 offset:21248
    v_mfma_f32_16x16x32_bf16 v[208:211], v[248:251], v[108:111], v[208:211]
    ds_read_b128 v[48:51], v8 offset:21504
    v_mfma_f32_16x16x32_bf16 v[212:215], v[232:235], v[172:175], v[212:215]
    v_mfma_f32_16x16x32_bf16 v[216:219], v[236:239], v[172:175], v[216:219]
    v_mfma_f32_16x16x32_bf16 v[220:223], v[240:243], v[172:175], v[220:223]
    v_mfma_f32_16x16x32_bf16 v[224:227], v[244:247], v[172:175], v[224:227]
    v_mfma_f32_16x16x32_bf16 v[228:231], v[248:251], v[172:175], v[228:231]
    s_waitcnt lgkmcnt(0)
    v_mfma_f32_16x16x32_bf16 v[192:195], v[32:35], v[112:115], v[192:195]
    ds_read_b128 v[232:235], v8 offset:25600
    v_mfma_f32_16x16x32_bf16 v[196:199], v[36:39], v[112:115], v[196:199]
    ds_read_b128 v[236:239], v8 offset:25856
    v_mfma_f32_16x16x32_bf16 v[200:203], v[40:43], v[112:115], v[200:203]
    ds_read_b128 v[240:243], v8 offset:26112
    v_mfma_f32_16x16x32_bf16 v[204:207], v[44:47], v[112:115], v[204:207]
    ds_read_b128 v[244:247], v8 offset:26368
    v_mfma_f32_16x16x32_bf16 v[208:211], v[48:51], v[112:115], v[208:211]
    ds_read_b128 v[248:251], v8 offset:26624
    v_mfma_f32_16x16x32_bf16 v[212:215], v[32:35], v[176:179], v[212:215]
    v_mfma_f32_16x16x32_bf16 v[216:219], v[36:39], v[176:179], v[216:219]
    v_mfma_f32_16x16x32_bf16 v[220:223], v[40:43], v[176:179], v[220:223]
    v_mfma_f32_16x16x32_bf16 v[224:227], v[44:47], v[176:179], v[224:227]
    v_mfma_f32_16x16x32_bf16 v[228:231], v[48:51], v[176:179], v[228:231]
    s_waitcnt lgkmcnt(0)
    v_mfma_f32_16x16x32_bf16 v[192:195], v[232:235], v[116:119], v[192:195]
    ds_read_b128 v[32:35], v8 offset:30720
    v_mfma_f32_16x16x32_bf16 v[196:199], v[236:239], v[116:119], v[196:199]
    ds_read_b128 v[36:39], v8 offset:30976
    v_mfma_f32_16x16x32_bf16 v[200:203], v[240:243], v[116:119], v[200:203]
    ds_read_b128 v[40:43], v8 offset:31232
    v_mfma_f32_16x16x32_bf16 v[204:207], v[244:247], v[116:119], v[204:207]
    ds_read_b128 v[44:47], v8 offset:31488
    v_mfma_f32_16x16x32_bf16 v[208:211], v[248:251], v[116:119], v[208:211]
    ds_read_b128 v[48:51], v8 offset:31744
    v_mfma_f32_16x16x32_bf16 v[212:215], v[232:235], v[180:183], v[212:215]
    v_mfma_f32_16x16x32_bf16 v[216:219], v[236:239], v[180:183], v[216:219]
    v_mfma_f32_16x16x32_bf16 v[220:223], v[240:243], v[180:183], v[220:223]
    v_mfma_f32_16x16x32_bf16 v[224:227], v[244:247], v[180:183], v[224:227]
    v_mfma_f32_16x16x32_bf16 v[228:231], v[248:251], v[180:183], v[228:231]
    s_waitcnt lgkmcnt(0)
    v_mfma_f32_16x16x32_bf16 v[192:195], v[32:35], v[120:123], v[192:195]
    ds_read_b128 v[232:235], v8 offset:35840
    v_mfma_f32_16x16x32_bf16 v[196:199], v[36:39], v[120:123], v[196:199]
    ds_read_b128 v[236:239], v8 offset:36096
    v_mfma_f32_16x16x32_bf16 v[200:203], v[40:43], v[120:123], v[200:203]
    ds_read_b128 v[240:243], v8 offset:36352
    v_mfma_f32_16x16x32_bf16 v[204:207], v[44:47], v[120:123], v[204:207]
    ds_read_b128 v[244:247], v8 offset:36608
    v_mfma_f32_16x16x32_bf16 v[208:211], v[48:51], v[120:123], v[208:211]
    ds_read_b128 v[248:251], v8 offset:36864
    v_mfma_f32_16x16x32_bf16 v[212:215], v[32:35], v[184:187], v[212:215]
    v_mfma_f32_16x16x32_bf16 v[216:219], v[36:39], v[184:187], v[216:219]
    v_mfma_f32_16x16x32_bf16 v[220:223], v[40:43], v[184:187], v[220:223]
    v_mfma_f32_16x16x32_bf16 v[224:227], v[44:47], v[184:187], v[224:227]
    v_mfma_f32_16x16x32_bf16 v[228:231], v[48:51], v[184:187], v[228:231]
    s_waitcnt lgkmcnt(0)
    v_mfma_f32_16x16x32_bf16 v[192:195], v[232:235], v[124:127], v[192:195]
    v_mfma_f32_16x16x32_bf16 v[196:199], v[236:239], v[124:127], v[196:199]
    v_mfma_f32_16x16x32_bf16 v[200:203], v[240:243], v[124:127], v[200:203]
    v_mfma_f32_16x16x32_bf16 v[204:207], v[244:247], v[124:127], v[204:207]
    v_mfma_f32_16x16x32_bf16 v[208:211], v[248:251], v[124:127], v[208:211]
    v_mfma_f32_16x16x32_bf16 v[212:215], v[232:235], v[188:191], v[212:215]
    v_mfma_f32_16x16x32_bf16 v[216:219], v[236:239], v[188:191], v[216:219]
    v_mfma_f32_16x16x32_bf16 v[220:223], v[240:243], v[188:191], v[220:223]
    v_mfma_f32_16x16x32_bf16 v[224:227], v[244:247], v[188:191], v[224:227]
    v_mfma_f32_16x16x32_bf16 v[228:231], v[248:251], v[188:191], v[228:231]
    s_nop 4
    ds_write_b128 v17, v[212:215] offset:0
    ds_write_b128 v17, v[216:219] offset:1024
    ds_write_b128 v17, v[220:223] offset:2048
    ds_write_b128 v17, v[224:227] offset:3072
    ds_write_b128 v17, v[228:231] offset:4096
    s_branch L_a_x
L_a_g01:
    s_barrier
    ds_read_b128 v[32:35], v9 offset:20480
    ds_read_b128 v[36:39], v9 offset:20736
    ds_read_b128 v[40:43], v9 offset:20992
    ds_read_b128 v[44:47], v9 offset:21248
    ds_read_b128 v[48:51], v9 offset:21504
    s_waitcnt lgkmcnt(0)
    v_mfma_f32_16x16x32_bf16 v[192:195], v[32:35], v[80:83], 0
    ds_read_b128 v[232:235], v9 offset:25600
    v_mfma_f32_16x16x32_bf16 v[196:199], v[36:39], v[80:83], 0
    ds_read_b128 v[236:239], v9 offset:25856
    v_mfma_f32_16x16x32_bf16 v[200:203], v[40:43], v[80:83], 0
    ds_read_b128 v[240:243], v9 offset:26112
    v_mfma_f32_16x16x32_bf16 v[204:207], v[44:47], v[80:83], 0
    ds_read_b128 v[244:247], v9 offset:26368
    v_mfma_f32_16x16x32_bf16 v[208:211], v[48:51], v[80:83], 0
    ds_read_b128 v[248:251], v9 offset:26624
    v_mfma_f32_16x16x32_bf16 v[212:215], v[32:35], v[144:147], 0
    v_mfma_f32_16x16x32_bf16 v[216:219], v[36:39], v[144:147], 0
    v_mfma_f32_16x16x32_bf16 v[220:223], v[40:43], v[144:147], 0
    v_mfma_f32_16x16x32_bf16 v[224:227], v[44:47], v[144:147], 0
    v_mfma_f32_16x16x32_bf16 v[228:231], v[48:51], v[144:147], 0
    s_waitcnt lgkmcnt(0)
    s_barrier
    v_mfma_f32_16x16x32_bf16 v[192:195], v[232:235], v[84:87], v[192:195]
    ds_read_b128 v[32:35], v9 offset:30720
    v_mfma_f32_16x16x32_bf16 v[196:199], v[236:239], v[84:87], v[196:199]
    ds_read_b128 v[36:39], v9 offset:30976
    v_mfma_f32_16x16x32_bf16 v[200:203], v[240:243], v[84:87], v[200:203]
    ds_read_b128 v[40:43], v9 offset:31232
    v_mfma_f32_16x16x32_bf16 v[204:207], v[244:247], v[84:87], v[204:207]
    ds_read_b128 v[44:47], v9 offset:31488
    v_mfma_f32_16x16x32_bf16 v[208:211], v[248:251], v[84:87], v[208:211]
    ds_read_b128 v[48:51], v9 offset:31744
    v_mfma_f32_16x16x32_bf16 v[212:215], v[232:235], v[148:151], v[212:215]
    v_mfma_f32_16x16x32_bf16 v[216:219], v[236:239], v[148:151], v[216:219]
    v_mfma_f32_16x16x32_bf16 v[220:223], v[240:243], v[148:151], v[220:223]
    v_mfma_f32_16x16x32_bf16 v[224:227], v[244:247], v[148:151], v[224:227]
    v_mfma_f32_16x16x32_bf16 v[228:231], v[248:251], v[148:151], v[228:231]
    s_waitcnt lgkmcnt(0)
    v_mfma_f32_16x16x32_bf16 v[192:195], v[32:35], v[88:91], v[192:195]
    ds_read_b128 v[232:235], v9 offset:35840
    v_mfma_f32_16x16x32_bf16 v[196:199], v[36:39], v[88:91], v[196:199]
    ds_read_b128 v[236:239], v9 offset:36096
    v_mfma_f32_16x16x32_bf16 v[200:203], v[40:43], v[88:91], v[200:203]
    ds_read_b128 v[240:243], v9 offset:36352
    v_mfma_f32_16x16x32_bf16 v[204:207], v[44:47], v[88:91], v[204:207]
    ds_read_b128 v[244:247], v9 offset:36608
    v_mfma_f32_16x16x32_bf16 v[208:211], v[48:51], v[88:91], v[208:211]
    ds_read_b128 v[248:251], v9 offset:36864
    v_mfma_f32_16x16x32_bf16 v[212:215], v[32:35], v[152:155], v[212:215]
    v_mfma_f32_16x16x32_bf16 v[216:219], v[36:39], v[152:155], v[216:219]
    v_mfma_f32_16x16x32_bf16 v[220:223], v[40:43], v[152:155], v[220:223]
    v_mfma_f32_16x16x32_bf16 v[224:227], v[44:47], v[152:155], v[224:227]
    v_mfma_f32_16x16x32_bf16 v[228:231], v[48:51], v[152:155], v[228:231]
    s_waitcnt lgkmcnt(0)
    s_barrier
    v_mfma_f32_16x16x32_bf16 v[192:195], v[232:235], v[92:95], v[192:195]
    ds_read_b128 v[32:35], v8 offset:0
    v_mfma_f32_16x16x32_bf16 v[196:199], v[236:239], v[92:95], v[196:199]
    ds_read_b128 v[36:39], v8 offset:256
    v_mfma_f32_16x16x32_bf16 v[200:203], v[240:243], v[92:95], v[200:203]
    ds_read_b128 v[40:43], v8 offset:512
    v_mfma_f32_16x16x32_bf16 v[204:207], v[244:247], v[92:95], v[204:207]
    ds_read_b128 v[44:47], v8 offset:768
    v_mfma_f32_16x16x32_bf16 v[208:211], v[248:251], v[92:95], v[208:211]
    ds_read_b128 v[48:51], v8 offset:1024
    v_mfma_f32_16x16x32_bf16 v[212:215], v[232:235], v[156:159], v[212:215]
    v_mfma_f32_16x16x32_bf16 v[216:219], v[236:239], v[156:159], v[216:219]
    v_mfma_f32_16x16x32_bf16 v[220:223], v[240:243], v[156:159], v[220:223]
    v_mfma_f32_16x16x32_bf16 v[224:227], v[244:247], v[156:159], v[224:227]
    v_mfma_f32_16x16x32_bf16 v[228:231], v[248:251], v[156:159], v[228:231]
    s_waitcnt lgkmcnt(0)
    v_mfma_f32_16x16x32_bf16 v[192:195], v[32:35], v[96:99], v[192:195]
    ds_read_b128 v[232:235], v8 offset:5120
    v_mfma_f32_16x16x32_bf16 v[196:199], v[36:39], v[96:99], v[196:199]
    ds_read_b128 v[236:239], v8 offset:5376
    v_mfma_f32_16x16x32_bf16 v[200:203], v[40:43], v[96:99], v[200:203]
    ds_read_b128 v[240:243], v8 offset:5632
    v_mfma_f32_16x16x32_bf16 v[204:207], v[44:47], v[96:99], v[204:207]
    ds_read_b128 v[244:247], v8 offset:5888
    v_mfma_f32_16x16x32_bf16 v[208:211], v[48:51], v[96:99], v[208:211]
    ds_read_b128 v[248:251], v8 offset:6144
    v_mfma_f32_16x16x32_bf16 v[212:215], v[32:35], v[160:163], v[212:215]
    v_mfma_f32_16x16x32_bf16 v[216:219], v[36:39], v[160:163], v[216:219]
    v_mfma_f32_16x16x32_bf16 v[220:223], v[40:43], v[160:163], v[220:223]
    v_mfma_f32_16x16x32_bf16 v[224:227], v[44:47], v[160:163], v[224:227]
    v_mfma_f32_16x16x32_bf16 v[228:231], v[48:51], v[160:163], v[228:231]
    s_waitcnt lgkmcnt(0)
    s_barrier
    v_mfma_f32_16x16x32_bf16 v[192:195], v[232:235], v[100:103], v[192:195]
    ds_read_b128 v[32:35], v8 offset:10240
    v_mfma_f32_16x16x32_bf16 v[196:199], v[236:239], v[100:103], v[196:199]
    ds_read_b128 v[36:39], v8 offset:10496
    v_mfma_f32_16x16x32_bf16 v[200:203], v[240:243], v[100:103], v[200:203]
    ds_read_b128 v[40:43], v8 offset:10752
    v_mfma_f32_16x16x32_bf16 v[204:207], v[244:247], v[100:103], v[204:207]
    ds_read_b128 v[44:47], v8 offset:11008
    v_mfma_f32_16x16x32_bf16 v[208:211], v[248:251], v[100:103], v[208:211]
    ds_read_b128 v[48:51], v8 offset:11264
    v_mfma_f32_16x16x32_bf16 v[212:215], v[232:235], v[164:167], v[212:215]
    v_mfma_f32_16x16x32_bf16 v[216:219], v[236:239], v[164:167], v[216:219]
    v_mfma_f32_16x16x32_bf16 v[220:223], v[240:243], v[164:167], v[220:223]
    v_mfma_f32_16x16x32_bf16 v[224:227], v[244:247], v[164:167], v[224:227]
    v_mfma_f32_16x16x32_bf16 v[228:231], v[248:251], v[164:167], v[228:231]
    s_waitcnt lgkmcnt(0)
    v_mfma_f32_16x16x32_bf16 v[192:195], v[32:35], v[104:107], v[192:195]
    ds_read_b128 v[232:235], v8 offset:15360
    v_mfma_f32_16x16x32_bf16 v[196:199], v[36:39], v[104:107], v[196:199]
    ds_read_b128 v[236:239], v8 offset:15616
    v_mfma_f32_16x16x32_bf16 v[200:203], v[40:43], v[104:107], v[200:203]
    ds_read_b128 v[240:243], v8 offset:15872
    v_mfma_f32_16x16x32_bf16 v[204:207], v[44:47], v[104:107], v[204:207]
    ds_read_b128 v[244:247], v8 offset:16128
    v_mfma_f32_16x16x32_bf16 v[208:211], v[48:51], v[104:107], v[208:211]
    ds_read_b128 v[248:251], v8 offset:16384
    v_mfma_f32_16x16x32_bf16 v[212:215], v[32:35], v[168:171], v[212:215]
    v_mfma_f32_16x16x32_bf16 v[216:219], v[36:39], v[168:171], v[216:219]
    v_mfma_f32_16x16x32_bf16 v[220:223], v[40:43], v[168:171], v[220:223]
    v_mfma_f32_16x16x32_bf16 v[224:227], v[44:47], v[168:171], v[224:227]
    v_mfma_f32_16x16x32_bf16 v[228:231], v[48:51], v[168:171], v[228:231]
    s_waitcnt lgkmcnt(0)
    s_barrier
    v_mfma_f32_16x16x32_bf16 v[192:195], v[232:235], v[108:111], v[192:195]
    ds_read_b128 v[32:35], v8 offset:20480
    v_mfma_f32_16x16x32_bf16 v[196:199], v[236:239], v[108:111], v[196:199]
    ds_read_b128 v[36:39], v8 offset:20736
    v_mfma_f32_16x16x32_bf16 v[200:203], v[240:243], v[108:111], v[200:203]
    ds_read_b128 v[40:43], v8 offset:20992
    v_mfma_f32_16x16x32_bf16 v[204:207], v[244:247], v[108:111], v[204:207]
    ds_read_b128 v[44:47], v8 offset:21248
    v_mfma_f32_16x16x32_bf16 v[208:211], v[248:251], v[108:111], v[208:211]
    ds_read_b128 v[48:51], v8 offset:21504
    v_mfma_f32_16x16x32_bf16 v[212:215], v[232:235], v[172:175], v[212:215]
    v_mfma_f32_16x16x32_bf16 v[216:219], v[236:239], v[172:175], v[216:219]
    v_mfma_f32_16x16x32_bf16 v[220:223], v[240:243], v[172:175], v[220:223]
    v_mfma_f32_16x16x32_bf16 v[224:227], v[244:247], v[172:175], v[224:227]
    v_mfma_f32_16x16x32_bf16 v[228:231], v[248:251], v[172:175], v[228:231]
    s_waitcnt lgkmcnt(0)
    v_mfma_f32_16x16x32_bf16 v[192:195], v[32:35], v[112:115], v[192:195]
    ds_read_b128 v[232:235], v8 offset:25600
    v_mfma_f32_16x16x32_bf16 v[196:199], v[36:39], v[112:115], v[196:199]
    ds_read_b128 v[236:239], v8 offset:25856
    v_mfma_f32_16x16x32_bf16 v[200:203], v[40:43], v[112:115], v[200:203]
    ds_read_b128 v[240:243], v8 offset:26112
    v_mfma_f32_16x16x32_bf16 v[204:207], v[44:47], v[112:115], v[204:207]
    ds_read_b128 v[244:247], v8 offset:26368
    v_mfma_f32_16x16x32_bf16 v[208:211], v[48:51], v[112:115], v[208:211]
    ds_read_b128 v[248:251], v8 offset:26624
    v_mfma_f32_16x16x32_bf16 v[212:215], v[32:35], v[176:179], v[212:215]
    v_mfma_f32_16x16x32_bf16 v[216:219], v[36:39], v[176:179], v[216:219]
    v_mfma_f32_16x16x32_bf16 v[220:223], v[40:43], v[176:179], v[220:223]
    v_mfma_f32_16x16x32_bf16 v[224:227], v[44:47], v[176:179], v[224:227]
    v_mfma_f32_16x16x32_bf16 v[228:231], v[48:51], v[176:179], v[228:231]
    s_waitcnt lgkmcnt(0)
    v_mfma_f32_16x16x32_bf16 v[192:195], v[232:235], v[116:119], v[192:195]
    ds_read_b128 v[32:35], v8 offset:30720
    v_mfma_f32_16x16x32_bf16 v[196:199], v[236:239], v[116:119], v[196:199]
    ds_read_b128 v[36:39], v8 offset:30976
    v_mfma_f32_16x16x32_bf16 v[200:203], v[240:243], v[116:119], v[200:203]
    ds_read_b128 v[40:43], v8 offset:31232
    v_mfma_f32_16x16x32_bf16 v[204:207], v[244:247], v[116:119], v[204:207]
    ds_read_b128 v[44:47], v8 offset:31488
    v_mfma_f32_16x16x32_bf16 v[208:211], v[248:251], v[116:119], v[208:211]
    ds_read_b128 v[48:51], v8 offset:31744
    v_mfma_f32_16x16x32_bf16 v[212:215], v[232:235], v[180:183], v[212:215]
    v_mfma_f32_16x16x32_bf16 v[216:219], v[236:239], v[180:183], v[216:219]
    v_mfma_f32_16x16x32_bf16 v[220:223], v[240:243], v[180:183], v[220:223]
    v_mfma_f32_16x16x32_bf16 v[224:227], v[244:247], v[180:183], v[224:227]
    v_mfma_f32_16x16x32_bf16 v[228:231], v[248:251], v[180:183], v[228:231]
    s_waitcnt lgkmcnt(0)
    v_mfma_f32_16x16x32_bf16 v[192:195], v[32:35], v[120:123], v[192:195]
    ds_read_b128 v[232:235], v8 offset:35840
    v_mfma_f32_16x16x32_bf16 v[196:199], v[36:39], v[120:123], v[196:199]
    ds_read_b128 v[236:239], v8 offset:36096
    v_mfma_f32_16x16x32_bf16 v[200:203], v[40:43], v[120:123], v[200:203]
    ds_read_b128 v[240:243], v8 offset:36352
    v_mfma_f32_16x16x32_bf16 v[204:207], v[44:47], v[120:123], v[204:207]
    ds_read_b128 v[244:247], v8 offset:36608
    v_mfma_f32_16x16x32_bf16 v[208:211], v[48:51], v[120:123], v[208:211]
    ds_read_b128 v[248:251], v8 offset:36864
    v_mfma_f32_16x16x32_bf16 v[212:215], v[32:35], v[184:187], v[212:215]
    v_mfma_f32_16x16x32_bf16 v[216:219], v[36:39], v[184:187], v[216:219]
    v_mfma_f32_16x16x32_bf16 v[220:223], v[40:43], v[184:187], v[220:223]
    v_mfma_f32_16x16x32_bf16 v[224:227], v[44:47], v[184:187], v[224:227]
    v_mfma_f32_16x16x32_bf16 v[228:231], v[48:51], v[184:187], v[228:231]
    s_waitcnt lgkmcnt(0)
    s_barrier
    v_mfma_f32_16x16x32_bf16 v[192:195], v[232:235], v[124:127], v[192:195]
    ds_read_b128 v[32:35], v9 offset:0
    v_mfma_f32_16x16x32_bf16 v[196:199], v[236:239], v[124:127], v[196:199]
    ds_read_b128 v[36:39], v9 offset:256
    v_mfma_f32_16x16x32_bf16 v[200:203], v[240:243], v[124:127], v[200:203]
    ds_read_b128 v[40:43], v9 offset:512
    v_mfma_f32_16x16x32_bf16 v[204:207], v[244:247], v[124:127], v[204:207]
    ds_read_b128 v[44:47], v9 offset:768
    v_mfma_f32_16x16x32_bf16 v[208:211], v[248:251], v[124:127], v[208:211]
    ds_read_b128 v[48:51], v9 offset:1024
    v_mfma_f32_16x16x32_bf16 v[212:215], v[232:235], v[188:191], v[212:215]
    v_mfma_f32_16x16x32_bf16 v[216:219], v[236:239], v[188:191], v[216:219]
    v_mfma_f32_16x16x32_bf16 v[220:223], v[240:243], v[188:191], v[220:223]
    v_mfma_f32_16x16x32_bf16 v[224:227], v[244:247], v[188:191], v[224:227]
    v_mfma_f32_16x16x32_bf16 v[228:231], v[248:251], v[188:191], v[228:231]
    s_waitcnt lgkmcnt(0)
    v_mfma_f32_16x16x32_bf16 v[192:195], v[32:35], v[64:67], v[192:195]
    ds_read_b128 v[232:235], v9 offset:5120
    v_mfma_f32_16x16x32_bf16 v[196:199], v[36:39], v[64:67], v[196:199]
    ds_read_b128 v[236:239], v9 offset:5376
    v_mfma_f32_16x16x32_bf16 v[200:203], v[40:43], v[64:67], v[200:203]
    ds_read_b128 v[240:243], v9 offset:5632
    v_mfma_f32_16x16x32_bf16 v[204:207], v[44:47], v[64:67], v[204:207]
    ds_read_b128 v[244:247], v9 offset:5888
    v_mfma_f32_16x16x32_bf16 v[208:211], v[48:51], v[64:67], v[208:211]
    ds_read_b128 v[248:251], v9 offset:6144
    v_mfma_f32_16x16x32_bf16 v[212:215], v[32:35], v[128:131], v[212:215]
    v_mfma_f32_16x16x32_bf16 v[216:219], v[36:39], v[128:131], v[216:219]
    v_mfma_f32_16x16x32_bf16 v[220:223], v[40:43], v[128:131], v[220:223]
    v_mfma_f32_16x16x32_bf16 v[224:227], v[44:47], v[128:131], v[224:227]
    v_mfma_f32_16x16x32_bf16 v[228:231], v[48:51], v[128:131], v[228:231]
    s_waitcnt lgkmcnt(0)
    v_mfma_f32_16x16x32_bf16 v[192:195], v[232:235], v[68:71], v[192:195]
    ds_read_b128 v[32:35], v9 offset:10240
    v_mfma_f32_16x16x32_bf16 v[196:199], v[236:239], v[68:71], v[196:199]
    ds_read_b128 v[36:39], v9 offset:10496
    v_mfma_f32_16x16x32_bf16 v[200:203], v[240:243], v[68:71], v[200:203]
    ds_read_b128 v[40:43], v9 offset:10752
    v_mfma_f32_16x16x32_bf16 v[204:207], v[244:247], v[68:71], v[204:207]
    ds_read_b128 v[44:47], v9 offset:11008
    v_mfma_f32_16x16x32_bf16 v[208:211], v[248:251], v[68:71], v[208:211]
    ds_read_b128 v[48:51], v9 offset:11264
    v_mfma_f32_16x16x32_bf16 v[212:215], v[232:235], v[132:135], v[212:215]
    v_mfma_f32_16x16x32_bf16 v[216:219], v[236:239], v[132:135], v[216:219]
    v_mfma_f32_16x16x32_bf16 v[220:223], v[240:243], v[132:135], v[220:223]
    v_mfma_f32_16x16x32_bf16 v[224:227], v[244:247], v[132:135], v[224:227]
    v_mfma_f32_16x16x32_bf16 v[228:231], v[248:251], v[132:135], v[228:231]
    s_waitcnt lgkmcnt(0)
    v_mfma_f32_16x16x32_bf16 v[192:195], v[32:35], v[72:75], v[192:195]
    ds_read_b128 v[232:235], v9 offset:15360
    v_mfma_f32_16x16x32_bf16 v[196:199], v[36:39], v[72:75], v[196:199]
    ds_read_b128 v[236:239], v9 offset:15616
    v_mfma_f32_16x16x32_bf16 v[200:203], v[40:43], v[72:75], v[200:203]
    ds_read_b128 v[240:243], v9 offset:15872
    v_mfma_f32_16x16x32_bf16 v[204:207], v[44:47], v[72:75], v[204:207]
    ds_read_b128 v[244:247], v9 offset:16128
    v_mfma_f32_16x16x32_bf16 v[208:211], v[48:51], v[72:75], v[208:211]
    ds_read_b128 v[248:251], v9 offset:16384
    v_mfma_f32_16x16x32_bf16 v[212:215], v[32:35], v[136:139], v[212:215]
    v_mfma_f32_16x16x32_bf16 v[216:219], v[36:39], v[136:139], v[216:219]
    v_mfma_f32_16x16x32_bf16 v[220:223], v[40:43], v[136:139], v[220:223]
    v_mfma_f32_16x16x32_bf16 v[224:227], v[44:47], v[136:139], v[224:227]
    v_mfma_f32_16x16x32_bf16 v[228:231], v[48:51], v[136:139], v[228:231]
    s_waitcnt lgkmcnt(0)
    v_mfma_f32_16x16x32_bf16 v[192:195], v[232:235], v[76:79], v[192:195]
    v_mfma_f32_16x16x32_bf16 v[196:199], v[236:239], v[76:79], v[196:199]
    v_mfma_f32_16x16x32_bf16 v[200:203], v[240:243], v[76:79], v[200:203]
    v_mfma_f32_16x16x32_bf16 v[204:207], v[244:247], v[76:79], v[204:207]
    v_mfma_f32_16x16x32_bf16 v[208:211], v[248:251], v[76:79], v[208:211]
    v_mfma_f32_16x16x32_bf16 v[212:215], v[232:235], v[140:143], v[212:215]
    v_mfma_f32_16x16x32_bf16 v[216:219], v[236:239], v[140:143], v[216:219]
    v_mfma_f32_16x16x32_bf16 v[220:223], v[240:243], v[140:143], v[220:223]
    v_mfma_f32_16x16x32_bf16 v[224:227], v[244:247], v[140:143], v[224:227]
    v_mfma_f32_16x16x32_bf16 v[228:231], v[248:251], v[140:143], v[228:231]
    s_nop 4
    ds_write_b128 v17, v[212:215] offset:0
    ds_write_b128 v17, v[216:219] offset:1024
    ds_write_b128 v17, v[220:223] offset:2048
    ds_write_b128 v17, v[224:227] offset:3072
    ds_write_b128 v17, v[228:231] offset:4096
    s_branch L_a_x
L_a_g02:
    s_barrier
    ds_read_b128 v[32:35], v8 offset:0
    ds_read_b128 v[36:39], v8 offset:256
    ds_read_b128 v[40:43], v8 offset:512
    ds_read_b128 v[44:47], v8 offset:768
    ds_read_b128 v[48:51], v8 offset:1024
    s_waitcnt lgkmcnt(0)
    v_mfma_f32_16x16x32_bf16 v[192:195], v[32:35], v[96:99], 0
    ds_read_b128 v[232:235], v8 offset:5120
    v_mfma_f32_16x16x32_bf16 v[196:199], v[36:39], v[96:99], 0
    ds_read_b128 v[236:239], v8 offset:5376
    v_mfma_f32_16x16x32_bf16 v[200:203], v[40:43], v[96:99], 0
    ds_read_b128 v[240:243], v8 offset:5632
    v_mfma_f32_16x16x32_bf16 v[204:207], v[44:47], v[96:99], 0
    ds_read_b128 v[244:247], v8 offset:5888
    v_mfma_f32_16x16x32_bf16 v[208:211], v[48:51], v[96:99], 0
    ds_read_b128 v[248:251], v8 offset:6144
    v_mfma_f32_16x16x32_bf16 v[212:215], v[32:35], v[160:163], 0
    v_mfma_f32_16x16x32_bf16 v[216:219], v[36:39], v[160:163], 0
    v_mfma_f32_16x16x32_bf16 v[220:223], v[40:43], v[160:163], 0
    v_mfma_f32_16x16x32_bf16 v[224:227], v[44:47], v[160:163], 0
    v_mfma_f32_16x16x32_bf16 v[228:231], v[48:51], v[160:163], 0
    s_waitcnt lgkmcnt(0)
    s_barrier
    v_mfma_f32_16x16x32_bf16 v[192:195], v[232:235], v[100:103], v[192:195]
    ds_read_b128 v[32:35], v8 offset:10240
    v_mfma_f32_16x16x32_bf16 v[196:199], v[236:239], v[100:103], v[196:199]
    ds_read_b128 v[36:39], v8 offset:10496
    v_mfma_f32_16x16x32_bf16 v[200:203], v[240:243], v[100:103], v[200:203]
    ds_read_b128 v[40:43], v8 offset:10752
    v_mfma_f32_16x16x32_bf16 v[204:207], v[244:247], v[100:103], v[204:207]
    ds_read_b128 v[44:47], v8 offset:11008
    v_mfma_f32_16x16x32_bf16 v[208:211], v[248:251], v[100:103], v[208:211]
    ds_read_b128 v[48:51], v8 offset:11264
    v_mfma_f32_16x16x32_bf16 v[212:215], v[232:235], v[164:167], v[212:215]
    v_mfma_f32_16x16x32_bf16 v[216:219], v[236:239], v[164:167], v[216:219]
    v_mfma_f32_16x16x32_bf16 v[220:223], v[240:243], v[164:167], v[220:223]
    v_mfma_f32_16x16x32_bf16 v[224:227], v[244:247], v[164:167], v[224:227]
    v_mfma_f32_16x16x32_bf16 v[228:231], v[248:251], v[164:167], v[228:231]
    s_waitcnt lgkmcnt(0)
    v_mfma_f32_16x16x32_bf16 v[192:195], v[32:35], v[104:107], v[192:195]
    ds_read_b128 v[232:235], v8 offset:15360
    v_mfma_f32_16x16x32_bf16 v[196:199], v[36:39], v[104:107], v[196:199]
    ds_read_b128 v[236:239], v8 offset:15616
    v_mfma_f32_16x16x32_bf16 v[200:203], v[40:43], v[104:107], v[200:203]
    ds_read_b128 v[240:243], v8 offset:15872
    v_mfma_f32_16x16x32_bf16 v[204:207], v[44:47], v[104:107], v[204:207]
    ds_read_b128 v[244:247], v8 offset:16128
    v_mfma_f32_16x16x32_bf16 v[208:211], v[48:51], v[104:107], v[208:211]
    ds_read_b128 v[248:251], v8 offset:16384
    v_mfma_f32_16x16x32_bf16 v[212:215], v[32:35], v[168:171], v[212:215]
    v_mfma_f32_16x16x32_bf16 v[216:219], v[36:39], v[168:171], v[216:219]
    v_mfma_f32_16x16x32_bf16 v[220:223], v[40:43], v[168:171], v[220:223]
    v_mfma_f32_16x16x32_bf16 v[224:227], v[44:47], v[168:171], v[224:227]
    v_mfma_f32_16x16x32_bf16 v[228:231], v[48:51], v[168:171], v[228:231]
    s_waitcnt lgkmcnt(0)
    s_barrier
    v_mfma_f32_16x16x32_bf16 v[192:195], v[232:235], v[108:111], v[192:195]
    ds_read_b128 v[32:35], v8 offset:20480
    v_mfma_f32_16x16x32_bf16 v[196:199], v[236:239], v[108:111], v[196:199]
    ds_read_b128 v[36:39], v8 offset:20736
    v_mfma_f32_16x16x32_bf16 v[200:203], v[240:243], v[108:111], v[200:203]
    ds_read_b128 v[40:43], v8 offset:20992
    v_mfma_f32_16x16x32_bf16 v[204:207], v[244:247], v[108:111], v[204:207]
    ds_read_b128 v[44:47], v8 offset:21248
    v_mfma_f32_16x16x32_bf16 v[208:211], v[248:251], v[108:111], v[208:211]
    ds_read_b128 v[48:51], v8 offset:21504
    v_mfma_f32_16x16x32_bf16 v[212:215], v[232:235], v[172:175], v[212:215]
    v_mfma_f32_16x16x32_bf16 v[216:219], v[236:239], v[172:175], v[216:219]
    v_mfma_f32_16x16x32_bf16 v[220:223], v[240:243], v[172:175], v[220:223]
    v_mfma_f32_16x16x32_bf16 v[224:227], v[244:247], v[172:175], v[224:227]
    v_mfma_f32_16x16x32_bf16 v[228:231], v[248:251], v[172:175], v[228:231]
    s_waitcnt lgkmcnt(0)
    v_mfma_f32_16x16x32_bf16 v[192:195], v[32:35], v[112:115], v[192:195]
    ds_read_b128 v[232:235], v8 offset:25600
    v_mfma_f32_16x16x32_bf16 v[196:199], v[36:39], v[112:115], v[196:199]
    ds_read_b128 v[236:239], v8 offset:25856
    v_mfma_f32_16x16x32_bf16 v[200:203], v[40:43], v[112:115], v[200:203]
    ds_read_b128 v[240:243], v8 offset:26112
    v_mfma_f32_16x16x32_bf16 v[204:207], v[44:47], v[112:115], v[204:207]
    ds_read_b128 v[244:247], v8 offset:26368
    v_mfma_f32_16x16x32_bf16 v[208:211], v[48:51], v[112:115], v[208:211]
    ds_read_b128 v[248:251], v8 offset:26624
    v_mfma_f32_16x16x32_bf16 v[212:215], v[32:35], v[176:179], v[212:215]
    v_mfma_f32_16x16x32_bf16 v[216:219], v[36:39], v[176:179], v[216:219]
    v_mfma_f32_16x16x32_bf16 v[220:223], v[40:43], v[176:179], v[220:223]
    v_mfma_f32_16x16x32_bf16 v[224:227], v[44:47], v[176:179], v[224:227]
    v_mfma_f32_16x16x32_bf16 v[228:231], v[48:51], v[176:179], v[228:231]
    s_waitcnt lgkmcnt(0)
    s_barrier
    v_mfma_f32_16x16x32_bf16 v[192:195], v[232:235], v[116:119], v[192:195]
    ds_read_b128 v[32:35], v8 offset:30720
    v_mfma_f32_16x16x32_bf16 v[196:199], v[236:239], v[116:119], v[196:199]
    ds_read_b128 v[36:39], v8 offset:30976
    v_mfma_f32_16x16x32_bf16 v[200:203], v[240:243], v[116:119], v[200:203]
    ds_read_b128 v[40:43], v8 offset:31232
    v_mfma_f32_16x16x32_bf16 v[204:207], v[244:247], v[116:119], v[204:207]
    ds_read_b128 v[44:47], v8 offset:31488
    v_mfma_f32_16x16x32_bf16 v[208:211], v[248:251], v[116:119], v[208:211]
    ds_read_b128 v[48:51], v8 offset:31744
    v_mfma_f32_16x16x32_bf16 v[212:215], v[232:235], v[180:183], v[212:215]
    v_mfma_f32_16x16x32_bf16 v[216:219], v[236:239], v[180:183], v[216:219]
    v_mfma_f32_16x16x32_bf16 v[220:223], v[240:243], v[180:183], v[220:223]
    v_mfma_f32_16x16x32_bf16 v[224:227], v[244:247], v[180:183], v[224:227]
    v_mfma_f32_16x16x32_bf16 v[228:231], v[248:251], v[180:183], v[228:231]
    s_waitcnt lgkmcnt(0)
    v_mfma_f32_16x16x32_bf16 v[192:195], v[32:35], v[120:123], v[192:195]
    ds_read_b128 v[232:235], v8 offset:35840
    v_mfma_f32_16x16x32_bf16 v[196:199], v[36:39], v[120:123], v[196:199]
    ds_read_b128 v[236:239], v8 offset:36096
    v_mfma_f32_16x16x32_bf16 v[200:203], v[40:43], v[120:123], v[200:203]
    ds_read_b128 v[240:243], v8 offset:36352
    v_mfma_f32_16x16x32_bf16 v[204:207], v[44:47], v[120:123], v[204:207]
    ds_read_b128 v[244:247], v8 offset:36608
    v_mfma_f32_16x16x32_bf16 v[208:211], v[48:51], v[120:123], v[208:211]
    ds_read_b128 v[248:251], v8 offset:36864
    v_mfma_f32_16x16x32_bf16 v[212:215], v[32:35], v[184:187], v[212:215]
    v_mfma_f32_16x16x32_bf16 v[216:219], v[36:39], v[184:187], v[216:219]
    v_mfma_f32_16x16x32_bf16 v[220:223], v[40:43], v[184:187], v[220:223]
    v_mfma_f32_16x16x32_bf16 v[224:227], v[44:47], v[184:187], v[224:227]
    v_mfma_f32_16x16x32_bf16 v[228:231], v[48:51], v[184:187], v[228:231]
    s_waitcnt lgkmcnt(0)
    s_barrier
    v_mfma_f32_16x16x32_bf16 v[192:195], v[232:235], v[124:127], v[192:195]
    ds_read_b128 v[32:35], v9 offset:0
    v_mfma_f32_16x16x32_bf16 v[196:199], v[236:239], v[124:127], v[196:199]
    ds_read_b128 v[36:39], v9 offset:256
    v_mfma_f32_16x16x32_bf16 v[200:203], v[240:243], v[124:127], v[200:203]
    ds_read_b128 v[40:43], v9 offset:512
    v_mfma_f32_16x16x32_bf16 v[204:207], v[244:247], v[124:127], v[204:207]
    ds_read_b128 v[44:47], v9 offset:768
    v_mfma_f32_16x16x32_bf16 v[208:211], v[248:251], v[124:127], v[208:211]
    ds_read_b128 v[48:51], v9 offset:1024
    v_mfma_f32_16x16x32_bf16 v[212:215], v[232:235], v[188:191], v[212:215]
    v_mfma_f32_16x16x32_bf16 v[216:219], v[236:239], v[188:191], v[216:219]
    v_mfma_f32_16x16x32_bf16 v[220:223], v[240:243], v[188:191], v[220:223]
    v_mfma_f32_16x16x32_bf16 v[224:227], v[244:247], v[188:191], v[224:227]
    v_mfma_f32_16x16x32_bf16 v[228:231], v[248:251], v[188:191], v[228:231]
    s_waitcnt lgkmcnt(0)
    v_mfma_f32_16x16x32_bf16 v[192:195], v[32:35], v[64:67], v[192:195]
    ds_read_b128 v[232:235], v9 offset:5120
    v_mfma_f32_16x16x32_bf16 v[196:199], v[36:39], v[64:67], v[196:199]
    ds_read_b128 v[236:239], v9 offset:5376
    v_mfma_f32_16x16x32_bf16 v[200:203], v[40:43], v[64:67], v[200:203]
    ds_read_b128 v[240:243], v9 offset:5632
    v_mfma_f32_16x16x32_bf16 v[204:207], v[44:47], v[64:67], v[204:207]
    ds_read_b128 v[244:247], v9 offset:5888
    v_mfma_f32_16x16x32_bf16 v[208:211], v[48:51], v[64:67], v[208:211]
    ds_read_b128 v[248:251], v9 offset:6144
    v_mfma_f32_16x16x32_bf16 v[212:215], v[32:35], v[128:131], v[212:215]
    v_mfma_f32_16x16x32_bf16 v[216:219], v[36:39], v[128:131], v[216:219]
    v_mfma_f32_16x16x32_bf16 v[220:223], v[40:43], v[128:131], v[220:223]
    v_mfma_f32_16x16x32_bf16 v[224:227], v[44:47], v[128:131], v[224:227]
    v_mfma_f32_16x16x32_bf16 v[228:231], v[48:51], v[128:131], v[228:231]
    s_waitcnt lgkmcnt(0)
    v_mfma_f32_16x16x32_bf16 v[192:195], v[232:235], v[68:71], v[192:195]
    ds_read_b128 v[32:35], v9 offset:10240
    v_mfma_f32_16x16x32_bf16 v[196:199], v[236:239], v[68:71], v[196:199]
    ds_read_b128 v[36:39], v9 offset:10496
    v_mfma_f32_16x16x32_bf16 v[200:203], v[240:243], v[68:71], v[200:203]
    ds_read_b128 v[40:43], v9 offset:10752
    v_mfma_f32_16x16x32_bf16 v[204:207], v[244:247], v[68:71], v[204:207]
    ds_read_b128 v[44:47], v9 offset:11008
    v_mfma_f32_16x16x32_bf16 v[208:211], v[248:251], v[68:71], v[208:211]
    ds_read_b128 v[48:51], v9 offset:11264
    v_mfma_f32_16x16x32_bf16 v[212:215], v[232:235], v[132:135], v[212:215]
    v_mfma_f32_16x16x32_bf16 v[216:219], v[236:239], v[132:135], v[216:219]
    v_mfma_f32_16x16x32_bf16 v[220:223], v[240:243], v[132:135], v[220:223]
    v_mfma_f32_16x16x32_bf16 v[224:227], v[244:247], v[132:135], v[224:227]
    v_mfma_f32_16x16x32_bf16 v[228:231], v[248:251], v[132:135], v[228:231]
    s_waitcnt lgkmcnt(0)
    v_mfma_f32_16x16x32_bf16 v[192:195], v[32:35], v[72:75], v[192:195]
    ds_read_b128 v[232:235], v9 offset:15360
    v_mfma_f32_16x16x32_bf16 v[196:199], v[36:39], v[72:75], v[196:199]
    ds_read_b128 v[236:239], v9 offset:15616
    v_mfma_f32_16x16x32_bf16 v[200:203], v[40:43], v[72:75], v[200:203]
    ds_read_b128 v[240:243], v9 offset:15872
    v_mfma_f32_16x16x32_bf16 v[204:207], v[44:47], v[72:75], v[204:207]
    ds_read_b128 v[244:247], v9 offset:16128
    v_mfma_f32_16x16x32_bf16 v[208:211], v[48:51], v[72:75], v[208:211]
    ds_read_b128 v[248:251], v9 offset:16384
    v_mfma_f32_16x16x32_bf16 v[212:215], v[32:35], v[136:139], v[212:215]
    v_mfma_f32_16x16x32_bf16 v[216:219], v[36:39], v[136:139], v[216:219]
    v_mfma_f32_16x16x32_bf16 v[220:223], v[40:43], v[136:139], v[220:223]
    v_mfma_f32_16x16x32_bf16 v[224:227], v[44:47], v[136:139], v[224:227]
    v_mfma_f32_16x16x32_bf16 v[228:231], v[48:51], v[136:139], v[228:231]
    s_waitcnt lgkmcnt(0)
    s_barrier
    v_mfma_f32_16x16x32_bf16 v[192:195], v[232:235], v[76:79], v[192:195]
    ds_read_b128 v[32:35], v9 offset:20480
    v_mfma_f32_16x16x32_bf16 v[196:199], v[236:239], v[76:79], v[196:199]
    ds_read_b128 v[36:39], v9 offset:20736
    v_mfma_f32_16x16x32_bf16 v[200:203], v[240:243], v[76:79], v[200:203]
    ds_read_b128 v[40:43], v9 offset:20992
    v_mfma_f32_16x16x32_bf16 v[204:207], v[244:247], v[76:79], v[204:207]
    ds_read_b128 v[44:47], v9 offset:21248
    v_mfma_f32_16x16x32_bf16 v[208:211], v[248:251], v[76:79], v[208:211]
    ds_read_b128 v[48:51], v9 offset:21504
    v_mfma_f32_16x16x32_bf16 v[212:215], v[232:235], v[140:143], v[212:215]
    v_mfma_f32_16x16x32_bf16 v[216:219], v[236:239], v[140:143], v[216:219]
    v_mfma_f32_16x16x32_bf16 v[220:223], v[240:243], v[140:143], v[220:223]
    v_mfma_f32_16x16x32_bf16 v[224:227], v[244:247], v[140:143], v[224:227]
    v_mfma_f32_16x16x32_bf16 v[228:231], v[248:251], v[140:143], v[228:231]
    s_waitcnt lgkmcnt(0)
    v_mfma_f32_16x16x32_bf16 v[192:195], v[32:35], v[80:83], v[192:195]
    ds_read_b128 v[232:235], v9 offset:25600
    v_mfma_f32_16x16x32_bf16 v[196:199], v[36:39], v[80:83], v[196:199]
    ds_read_b128 v[236:239], v9 offset:25856
    v_mfma_f32_16x16x32_bf16 v[200:203], v[40:43], v[80:83], v[200:203]
    ds_read_b128 v[240:243], v9 offset:26112
    v_mfma_f32_16x16x32_bf16 v[204:207], v[44:47], v[80:83], v[204:207]
    ds_read_b128 v[244:247], v9 offset:26368
    v_mfma_f32_16x16x32_bf16 v[208:211], v[48:51], v[80:83], v[208:211]
    ds_read_b128 v[248:251], v9 offset:26624
    v_mfma_f32_16x16x32_bf16 v[212:215], v[32:35], v[144:147], v[212:215]
    v_mfma_f32_16x16x32_bf16 v[216:219], v[36:39], v[144:147], v[216:219]
    v_mfma_f32_16x16x32_bf16 v[220:223], v[40:43], v[144:147], v[220:223]
    v_mfma_f32_16x16x32_bf16 v[224:227], v[44:47], v[144:147], v[224:227]
    v_mfma_f32_16x16x32_bf16 v[228:231], v[48:51], v[144:147], v[228:231]
    s_waitcnt lgkmcnt(0)
    v_mfma_f32_16x16x32_bf16 v[192:195], v[232:235], v[84:87], v[192:195]
    ds_read_b128 v[32:35], v9 offset:30720
    v_mfma_f32_16x16x32_bf16 v[196:199], v[236:239], v[84:87], v[196:199]
    ds_read_b128 v[36:39], v9 offset:30976
    v_mfma_f32_16x16x32_bf16 v[200:203], v[240:243], v[84:87], v[200:203]
    ds_read_b128 v[40:43], v9 offset:31232
    v_mfma_f32_16x16x32_bf16 v[204:207], v[244:247], v[84:87], v[204:207]
    ds_read_b128 v[44:47], v9 offset:31488
    v_mfma_f32_16x16x32_bf16 v[208:211], v[248:251], v[84:87], v[208:211]
    ds_read_b128 v[48:51], v9 offset:31744
    v_mfma_f32_16x16x32_bf16 v[212:215], v[232:235], v[148:151], v[212:215]
    v_mfma_f32_16x16x32_bf16 v[216:219], v[236:239], v[148:151], v[216:219]
    v_mfma_f32_16x16x32_bf16 v[220:223], v[240:243], v[148:151], v[220:223]
    v_mfma_f32_16x16x32_bf16 v[224:227], v[244:247], v[148:151], v[224:227]
    v_mfma_f32_16x16x32_bf16 v[228:231], v[248:251], v[148:151], v[228:231]
    s_waitcnt lgkmcnt(0)
    v_mfma_f32_16x16x32_bf16 v[192:195], v[32:35], v[88:91], v[192:195]
    ds_read_b128 v[232:235], v9 offset:35840
    v_mfma_f32_16x16x32_bf16 v[196:199], v[36:39], v[88:91], v[196:199]
    ds_read_b128 v[236:239], v9 offset:36096
    v_mfma_f32_16x16x32_bf16 v[200:203], v[40:43], v[88:91], v[200:203]
    ds_read_b128 v[240:243], v9 offset:36352
    v_mfma_f32_16x16x32_bf16 v[204:207], v[44:47], v[88:91], v[204:207]
    ds_read_b128 v[244:247], v9 offset:36608
    v_mfma_f32_16x16x32_bf16 v[208:211], v[48:51], v[88:91], v[208:211]
    ds_read_b128 v[248:251], v9 offset:36864
    v_mfma_f32_16x16x32_bf16 v[212:215], v[32:35], v[152:155], v[212:215]
    v_mfma_f32_16x16x32_bf16 v[216:219], v[36:39], v[152:155], v[216:219]
    v_mfma_f32_16x16x32_bf16 v[220:223], v[40:43], v[152:155], v[220:223]
    v_mfma_f32_16x16x32_bf16 v[224:227], v[44:47], v[152:155], v[224:227]
    v_mfma_f32_16x16x32_bf16 v[228:231], v[48:51], v[152:155], v[228:231]
    s_waitcnt lgkmcnt(0)
    v_mfma_f32_16x16x32_bf16 v[192:195], v[232:235], v[92:95], v[192:195]
    v_mfma_f32_16x16x32_bf16 v[196:199], v[236:239], v[92:95], v[196:199]
    v_mfma_f32_16x16x32_bf16 v[200:203], v[240:243], v[92:95], v[200:203]
    v_mfma_f32_16x16x32_bf16 v[204:207], v[244:247], v[92:95], v[204:207]
    v_mfma_f32_16x16x32_bf16 v[208:211], v[248:251], v[92:95], v[208:211]
    v_mfma_f32_16x16x32_bf16 v[212:215], v[232:235], v[156:159], v[212:215]
    v_mfma_f32_16x16x32_bf16 v[216:219], v[236:239], v[156:159], v[216:219]
    v_mfma_f32_16x16x32_bf16 v[220:223], v[240:243], v[156:159], v[220:223]
    v_mfma_f32_16x16x32_bf16 v[224:227], v[244:247], v[156:159], v[224:227]
    v_mfma_f32_16x16x32_bf16 v[228:231], v[248:251], v[156:159], v[228:231]
    s_nop 4
    ds_write_b128 v17, v[212:215] offset:0
    ds_write_b128 v17, v[216:219] offset:1024
    ds_write_b128 v17, v[220:223] offset:2048
    ds_write_b128 v17, v[224:227] offset:3072
    ds_write_b128 v17, v[228:231] offset:4096
    s_branch L_a_x
L_a_g03:
    s_barrier
    ds_read_b128 v[32:35], v8 offset:20480
    ds_read_b128 v[36:39], v8 offset:20736
    ds_read_b128 v[40:43], v8 offset:20992
    ds_read_b128 v[44:47], v8 offset:21248
    ds_read_b128 v[48:51], v8 offset:21504
    s_waitcnt lgkmcnt(0)
    v_mfma_f32_16x16x32_bf16 v[192:195], v[32:35], v[112:115], 0
    ds_read_b128 v[232:235], v8 offset:25600
    v_mfma_f32_16x16x32_bf16 v[196:199], v[36:39], v[112:115], 0
    ds_read_b128 v[236:239], v8 offset:25856
    v_mfma_f32_16x16x32_bf16 v[200:203], v[40:43], v[112:115], 0
    ds_read_b128 v[240:243], v8 offset:26112
    v_mfma_f32_16x16x32_bf16 v[204:207], v[44:47], v[112:115], 0
    ds_read_b128 v[244:247], v8 offset:26368
    v_mfma_f32_16x16x32_bf16 v[208:211], v[48:51], v[112:115], 0
    ds_read_b128 v[248:251], v8 offset:26624
    v_mfma_f32_16x16x32_bf16 v[212:215], v[32:35], v[176:179], 0
    v_mfma_f32_16x16x32_bf16 v[216:219], v[36:39], v[176:179], 0
    v_mfma_f32_16x16x32_bf16 v[220:223], v[40:43], v[176:179], 0
    v_mfma_f32_16x16x32_bf16 v[224:227], v[44:47], v[176:179], 0
    v_mfma_f32_16x16x32_bf16 v[228:231], v[48:51], v[176:179], 0
    s_waitcnt lgkmcnt(0)
    s_barrier
    v_mfma_f32_16x16x32_bf16 v[192:195], v[232:235], v[116:119], v[192:195]
    ds_read_b128 v[32:35], v8 offset:30720
    v_mfma_f32_16x16x32_bf16 v[196:199], v[236:239], v[116:119], v[196:199]
    ds_read_b128 v[36:39], v8 offset:30976
    v_mfma_f32_16x16x32_bf16 v[200:203], v[240:243], v[116:119], v[200:203]
    ds_read_b128 v[40:43], v8 offset:31232
    v_mfma_f32_16x16x32_bf16 v[204:207], v[244:247], v[116:119], v[204:207]
    ds_read_b128 v[44:47], v8 offset:31488
    v_mfma_f32_16x16x32_bf16 v[208:211], v[248:251], v[116:119], v[208:211]
    ds_read_b128 v[48:51], v8 offset:31744
    v_mfma_f32_16x16x32_bf16 v[212:215], v[232:235], v[180:183], v[212:215]
    v_mfma_f32_16x16x32_bf16 v[216:219], v[236:239], v[180:183], v[216:219]
    v_mfma_f32_16x16x32_bf16 v[220:223], v[240:243], v[180:183], v[220:223]
    v_mfma_f32_16x16x32_bf16 v[224:227], v[244:247], v[180:183], v[224:227]
    v_mfma_f32_16x16x32_bf16 v[228:231], v[248:251], v[180:183], v[228:231]
    s_waitcnt lgkmcnt(0)
    v_mfma_f32_16x16x32_bf16 v[192:195], v[32:35], v[120:123], v[192:195]
    ds_read_b128 v[232:235], v8 offset:35840
    v_mfma_f32_16x16x32_bf16 v[196:199], v[36:39], v[120:123], v[196:199]
    ds_read_b128 v[236:239], v8 offset:36096
    v_mfma_f32_16x16x32_bf16 v[200:203], v[40:43], v[120:123], v[200:203]
    ds_read_b128 v[240:243], v8 offset:36352
    v_mfma_f32_16x16x32_bf16 v[204:207], v[44:47], v[120:123], v[204:207]
    ds_read_b128 v[244:247], v8 offset:36608
    v_mfma_f32_16x16x32_bf16 v[208:211], v[48:51], v[120:123], v[208:211]
    ds_read_b128 v[248:251], v8 offset:36864
    v_mfma_f32_16x16x32_bf16 v[212:215], v[32:35], v[184:187], v[212:215]
    v_mfma_f32_16x16x32_bf16 v[216:219], v[36:39], v[184:187], v[216:219]
    v_mfma_f32_16x16x32_bf16 v[220:223], v[40:43], v[184:187], v[220:223]
    v_mfma_f32_16x16x32_bf16 v[224:227], v[44:47], v[184:187], v[224:227]
    v_mfma_f32_16x16x32_bf16 v[228:231], v[48:51], v[184:187], v[228:231]
    s_waitcnt lgkmcnt(0)
    s_barrier
    v_mfma_f32_16x16x32_bf16 v[192:195], v[232:235], v[124:127], v[192:195]
    ds_read_b128 v[32:35], v9 offset:0
    v_mfma_f32_16x16x32_bf16 v[196:199], v[236:239], v[124:127], v[196:199]
    ds_read_b128 v[36:39], v9 offset:256
    v_mfma_f32_16x16x32_bf16 v[200:203], v[240:243], v[124:127], v[200:203]
    ds_read_b128 v[40:43], v9 offset:512
    v_mfma_f32_16x16x32_bf16 v[204:207], v[244:247], v[124:127], v[204:207]
    ds_read_b128 v[44:47], v9 offset:768
    v_mfma_f32_16x16x32_bf16 v[208:211], v[248:251], v[124:127], v[208:211]
    ds_read_b128 v[48:51], v9 offset:1024
    v_mfma_f32_16x16x32_bf16 v[212:215], v[232:235], v[188:191], v[212:215]
    v_mfma_f32_16x16x32_bf16 v[216:219], v[236:239], v[188:191], v[216:219]
    v_mfma_f32_16x16x32_bf16 v[220:223], v[240:243], v[188:191], v[220:223]
    v_mfma_f32_16x16x32_bf16 v[224:227], v[244:247], v[188:191], v[224:227]
    v_mfma_f32_16x16x32_bf16 v[228:231], v[248:251], v[188:191], v[228:231]
    s_waitcnt lgkmcnt(0)
    v_mfma_f32_16x16x32_bf16 v[192:195], v[32:35], v[64:67], v[192:195]
    ds_read_b128 v[232:235], v9 offset:5120
    v_mfma_f32_16x16x32_bf16 v[196:199], v[36:39], v[64:67], v[196:199]
    ds_read_b128 v[236:239], v9 offset:5376
    v_mfma_f32_16x16x32_bf16 v[200:203], v[40:43], v[64:67], v[200:203]
    ds_read_b128 v[240:243], v9 offset:5632
    v_mfma_f32_16x16x32_bf16 v[204:207], v[44:47], v[64:67], v[204:207]
    ds_read_b128 v[244:247], v9 offset:5888
    v_mfma_f32_16x16x32_bf16 v[208:211], v[48:51], v[64:67], v[208:211]
    ds_read_b128 v[248:251], v9 offset:6144
    v_mfma_f32_16x16x32_bf16 v[212:215], v[32:35], v[128:131], v[212:215]
    v_mfma_f32_16x16x32_bf16 v[216:219], v[36:39], v[128:131], v[216:219]
    v_mfma_f32_16x16x32_bf16 v[220:223], v[40:43], v[128:131], v[220:223]
    v_mfma_f32_16x16x32_bf16 v[224:227], v[44:47], v[128:131], v[224:227]
    v_mfma_f32_16x16x32_bf16 v[228:231], v[48:51], v[128:131], v[228:231]
    s_waitcnt lgkmcnt(0)
    s_barrier
    v_mfma_f32_16x16x32_bf16 v[192:195], v[232:235], v[68:71], v[192:195]
    ds_read_b128 v[32:35], v9 offset:10240
    v_mfma_f32_16x16x32_bf16 v[196:199], v[236:239], v[68:71], v[196:199]
    ds_read_b128 v[36:39], v9 offset:10496
    v_mfma_f32_16x16x32_bf16 v[200:203], v[240:243], v[68:71], v[200:203]
    ds_read_b128 v[40:43], v9 offset:10752
    v_mfma_f32_16x16x32_bf16 v[204:207], v[244:247], v[68:71], v[204:207]
    ds_read_b128 v[44:47], v9 offset:11008
    v_mfma_f32_16x16x32_bf16 v[208:211], v[248:251], v[68:71], v[208:211]
    ds_read_b128 v[48:51], v9 offset:11264
    v_mfma_f32_16x16x32_bf16 v[212:215], v[232:235], v[132:135], v[212:215]
    v_mfma_f32_16x16x32_bf16 v[216:219], v[236:239], v[132:135], v[216:219]
    v_mfma_f32_16x16x32_bf16 v[220:223], v[240:243], v[132:135], v[220:223]
    v_mfma_f32_16x16x32_bf16 v[224:227], v[244:247], v[132:135], v[224:227]
    v_mfma_f32_16x16x32_bf16 v[228:231], v[248:251], v[132:135], v[228:231]
    s_waitcnt lgkmcnt(0)
    v_mfma_f32_16x16x32_bf16 v[192:195], v[32:35], v[72:75], v[192:195]
    ds_read_b128 v[232:235], v9 offset:15360
    v_mfma_f32_16x16x32_bf16 v[196:199], v[36:39], v[72:75], v[196:199]
    ds_read_b128 v[236:239], v9 offset:15616
    v_mfma_f32_16x16x32_bf16 v[200:203], v[40:43], v[72:75], v[200:203]
    ds_read_b128 v[240:243], v9 offset:15872
    v_mfma_f32_16x16x32_bf16 v[204:207], v[44:47], v[72:75], v[204:207]
    ds_read_b128 v[244:247], v9 offset:16128
    v_mfma_f32_16x16x32_bf16 v[208:211], v[48:51], v[72:75], v[208:211]
    ds_read_b128 v[248:251], v9 offset:16384
    v_mfma_f32_16x16x32_bf16 v[212:215], v[32:35], v[136:139], v[212:215]
    v_mfma_f32_16x16x32_bf16 v[216:219], v[36:39], v[136:139], v[216:219]
    v_mfma_f32_16x16x32_bf16 v[220:223], v[40:43], v[136:139], v[220:223]
    v_mfma_f32_16x16x32_bf16 v[224:227], v[44:47], v[136:139], v[224:227]
    v_mfma_f32_16x16x32_bf16 v[228:231], v[48:51], v[136:139], v[228:231]
    s_waitcnt lgkmcnt(0)
    s_barrier
    v_mfma_f32_16x16x32_bf16 v[192:195], v[232:235], v[76:79], v[192:195]
    ds_read_b128 v[32:35], v9 offset:20480
    v_mfma_f32_16x16x32_bf16 v[196:199], v[236:239], v[76:79], v[196:199]
    ds_read_b128 v[36:39], v9 offset:20736
    v_mfma_f32_16x16x32_bf16 v[200:203], v[240:243], v[76:79], v[200:203]
    ds_read_b128 v[40:43], v9 offset:20992
    v_mfma_f32_16x16x32_bf16 v[204:207], v[244:247], v[76:79], v[204:207]
    ds_read_b128 v[44:47], v9 offset:21248
    v_mfma_f32_16x16x32_bf16 v[208:211], v[248:251], v[76:79], v[208:211]
    ds_read_b128 v[48:51], v9 offset:21504
    v_mfma_f32_16x16x32_bf16 v[212:215], v[232:235], v[140:143], v[212:215]
    v_mfma_f32_16x16x32_bf16 v[216:219], v[236:239], v[140:143], v[216:219]
    v_mfma_f32_16x16x32_bf16 v[220:223], v[240:243], v[140:143], v[220:223]
    v_mfma_f32_16x16x32_bf16 v[224:227], v[244:247], v[140:143], v[224:227]
    v_mfma_f32_16x16x32_bf16 v[228:231], v[248:251], v[140:143], v[228:231]
    s_waitcnt lgkmcnt(0)
    v_mfma_f32_16x16x32_bf16 v[192:195], v[32:35], v[80:83], v[192:195]
    ds_read_b128 v[232:235], v9 offset:25600
    v_mfma_f32_16x16x32_bf16 v[196:199], v[36:39], v[80:83], v[196:199]
    ds_read_b128 v[236:239], v9 offset:25856
    v_mfma_f32_16x16x32_bf16 v[200:203], v[40:43], v[80:83], v[200:203]
    ds_read_b128 v[240:243], v9 offset:26112
    v_mfma_f32_16x16x32_bf16 v[204:207], v[44:47], v[80:83], v[204:207]
    ds_read_b128 v[244:247], v9 offset:26368
    v_mfma_f32_16x16x32_bf16 v[208:211], v[48:51], v[80:83], v[208:211]
    ds_read_b128 v[248:251], v9 offset:26624
    v_mfma_f32_16x16x32_bf16 v[212:215], v[32:35], v[144:147], v[212:215]
    v_mfma_f32_16x16x32_bf16 v[216:219], v[36:39], v[144:147], v[216:219]
    v_mfma_f32_16x16x32_bf16 v[220:223], v[40:43], v[144:147], v[220:223]
    v_mfma_f32_16x16x32_bf16 v[224:227], v[44:47], v[144:147], v[224:227]
    v_mfma_f32_16x16x32_bf16 v[228:231], v[48:51], v[144:147], v[228:231]
    s_waitcnt lgkmcnt(0)
    v_mfma_f32_16x16x32_bf16 v[192:195], v[232:235], v[84:87], v[192:195]
    ds_read_b128 v[32:35], v9 offset:30720
    v_mfma_f32_16x16x32_bf16 v[196:199], v[236:239], v[84:87], v[196:199]
    ds_read_b128 v[36:39], v9 offset:30976
    v_mfma_f32_16x16x32_bf16 v[200:203], v[240:243], v[84:87], v[200:203]
    ds_read_b128 v[40:43], v9 offset:31232
    v_mfma_f32_16x16x32_bf16 v[204:207], v[244:247], v[84:87], v[204:207]
    ds_read_b128 v[44:47], v9 offset:31488
    v_mfma_f32_16x16x32_bf16 v[208:211], v[248:251], v[84:87], v[208:211]
    ds_read_b128 v[48:51], v9 offset:31744
    v_mfma_f32_16x16x32_bf16 v[212:215], v[232:235], v[148:151], v[212:215]
    v_mfma_f32_16x16x32_bf16 v[216:219], v[236:239], v[148:151], v[216:219]
    v_mfma_f32_16x16x32_bf16 v[220:223], v[240:243], v[148:151], v[220:223]
    v_mfma_f32_16x16x32_bf16 v[224:227], v[244:247], v[148:151], v[224:227]
    v_mfma_f32_16x16x32_bf16 v[228:231], v[248:251], v[148:151], v[228:231]
    s_waitcnt lgkmcnt(0)
    v_mfma_f32_16x16x32_bf16 v[192:195], v[32:35], v[88:91], v[192:195]
    ds_read_b128 v[232:235], v9 offset:35840
    v_mfma_f32_16x16x32_bf16 v[196:199], v[36:39], v[88:91], v[196:199]
    ds_read_b128 v[236:239], v9 offset:36096
    v_mfma_f32_16x16x32_bf16 v[200:203], v[40:43], v[88:91], v[200:203]
    ds_read_b128 v[240:243], v9 offset:36352
    v_mfma_f32_16x16x32_bf16 v[204:207], v[44:47], v[88:91], v[204:207]
    ds_read_b128 v[244:247], v9 offset:36608
    v_mfma_f32_16x16x32_bf16 v[208:211], v[48:51], v[88:91], v[208:211]
    ds_read_b128 v[248:251], v9 offset:36864
    v_mfma_f32_16x16x32_bf16 v[212:215], v[32:35], v[152:155], v[212:215]
    v_mfma_f32_16x16x32_bf16 v[216:219], v[36:39], v[152:155], v[216:219]
    v_mfma_f32_16x16x32_bf16 v[220:223], v[40:43], v[152:155], v[220:223]
    v_mfma_f32_16x16x32_bf16 v[224:227], v[44:47], v[152:155], v[224:227]
    v_mfma_f32_16x16x32_bf16 v[228:231], v[48:51], v[152:155], v[228:231]
    s_waitcnt lgkmcnt(0)
    s_barrier
    v_mfma_f32_16x16x32_bf16 v[192:195], v[232:235], v[92:95], v[192:195]
    ds_read_b128 v[32:35], v8 offset:0
    v_mfma_f32_16x16x32_bf16 v[196:199], v[236:239], v[92:95], v[196:199]
    ds_read_b128 v[36:39], v8 offset:256
    v_mfma_f32_16x16x32_bf16 v[200:203], v[240:243], v[92:95], v[200:203]
    ds_read_b128 v[40:43], v8 offset:512
    v_mfma_f32_16x16x32_bf16 v[204:207], v[244:247], v[92:95], v[204:207]
    ds_read_b128 v[44:47], v8 offset:768
    v_mfma_f32_16x16x32_bf16 v[208:211], v[248:251], v[92:95], v[208:211]
    ds_read_b128 v[48:51], v8 offset:1024
    v_mfma_f32_16x16x32_bf16 v[212:215], v[232:235], v[156:159], v[212:215]
    v_mfma_f32_16x16x32_bf16 v[216:219], v[236:239], v[156:159], v[216:219]
    v_mfma_f32_16x16x32_bf16 v[220:223], v[240:243], v[156:159], v[220:223]
    v_mfma_f32_16x16x32_bf16 v[224:227], v[244:247], v[156:159], v[224:227]
    v_mfma_f32_16x16x32_bf16 v[228:231], v[248:251], v[156:159], v[228:231]
    s_waitcnt lgkmcnt(0)
    v_mfma_f32_16x16x32_bf16 v[192:195], v[32:35], v[96:99], v[192:195]
    ds_read_b128 v[232:235], v8 offset:5120
    v_mfma_f32_16x16x32_bf16 v[196:199], v[36:39], v[96:99], v[196:199]
    ds_read_b128 v[236:239], v8 offset:5376
    v_mfma_f32_16x16x32_bf16 v[200:203], v[40:43], v[96:99], v[200:203]
    ds_read_b128 v[240:243], v8 offset:5632
    v_mfma_f32_16x16x32_bf16 v[204:207], v[44:47], v[96:99], v[204:207]
    ds_read_b128 v[244:247], v8 offset:5888
    v_mfma_f32_16x16x32_bf16 v[208:211], v[48:51], v[96:99], v[208:211]
    ds_read_b128 v[248:251], v8 offset:6144
    v_mfma_f32_16x16x32_bf16 v[212:215], v[32:35], v[160:163], v[212:215]
    v_mfma_f32_16x16x32_bf16 v[216:219], v[36:39], v[160:163], v[216:219]
    v_mfma_f32_16x16x32_bf16 v[220:223], v[40:43], v[160:163], v[220:223]
    v_mfma_f32_16x16x32_bf16 v[224:227], v[44:47], v[160:163], v[224:227]
    v_mfma_f32_16x16x32_bf16 v[228:231], v[48:51], v[160:163], v[228:231]
    s_waitcnt lgkmcnt(0)
    v_mfma_f32_16x16x32_bf16 v[192:195], v[232:235], v[100:103], v[192:195]
    ds_read_b128 v[32:35], v8 offset:10240
    v_mfma_f32_16x16x32_bf16 v[196:199], v[236:239], v[100:103], v[196:199]
    ds_read_b128 v[36:39], v8 offset:10496
    v_mfma_f32_16x16x32_bf16 v[200:203], v[240:243], v[100:103], v[200:203]
    ds_read_b128 v[40:43], v8 offset:10752
    v_mfma_f32_16x16x32_bf16 v[204:207], v[244:247], v[100:103], v[204:207]
    ds_read_b128 v[44:47], v8 offset:11008
    v_mfma_f32_16x16x32_bf16 v[208:211], v[248:251], v[100:103], v[208:211]
    ds_read_b128 v[48:51], v8 offset:11264
    v_mfma_f32_16x16x32_bf16 v[212:215], v[232:235], v[164:167], v[212:215]
    v_mfma_f32_16x16x32_bf16 v[216:219], v[236:239], v[164:167], v[216:219]
    v_mfma_f32_16x16x32_bf16 v[220:223], v[240:243], v[164:167], v[220:223]
    v_mfma_f32_16x16x32_bf16 v[224:227], v[244:247], v[164:167], v[224:227]
    v_mfma_f32_16x16x32_bf16 v[228:231], v[248:251], v[164:167], v[228:231]
    s_waitcnt lgkmcnt(0)
    v_mfma_f32_16x16x32_bf16 v[192:195], v[32:35], v[104:107], v[192:195]
    ds_read_b128 v[232:235], v8 offset:15360
    v_mfma_f32_16x16x32_bf16 v[196:199], v[36:39], v[104:107], v[196:199]
    ds_read_b128 v[236:239], v8 offset:15616
    v_mfma_f32_16x16x32_bf16 v[200:203], v[40:43], v[104:107], v[200:203]
    ds_read_b128 v[240:243], v8 offset:15872
    v_mfma_f32_16x16x32_bf16 v[204:207], v[44:47], v[104:107], v[204:207]
    ds_read_b128 v[244:247], v8 offset:16128
    v_mfma_f32_16x16x32_bf16 v[208:211], v[48:51], v[104:107], v[208:211]
    ds_read_b128 v[248:251], v8 offset:16384
    v_mfma_f32_16x16x32_bf16 v[212:215], v[32:35], v[168:171], v[212:215]
    v_mfma_f32_16x16x32_bf16 v[216:219], v[36:39], v[168:171], v[216:219]
    v_mfma_f32_16x16x32_bf16 v[220:223], v[40:43], v[168:171], v[220:223]
    v_mfma_f32_16x16x32_bf16 v[224:227], v[44:47], v[168:171], v[224:227]
    v_mfma_f32_16x16x32_bf16 v[228:231], v[48:51], v[168:171], v[228:231]
    s_waitcnt lgkmcnt(0)
    v_mfma_f32_16x16x32_bf16 v[192:195], v[232:235], v[108:111], v[192:195]
    v_mfma_f32_16x16x32_bf16 v[196:199], v[236:239], v[108:111], v[196:199]
    v_mfma_f32_16x16x32_bf16 v[200:203], v[240:243], v[108:111], v[200:203]
    v_mfma_f32_16x16x32_bf16 v[204:207], v[244:247], v[108:111], v[204:207]
    v_mfma_f32_16x16x32_bf16 v[208:211], v[248:251], v[108:111], v[208:211]
    v_mfma_f32_16x16x32_bf16 v[212:215], v[232:235], v[172:175], v[212:215]
    v_mfma_f32_16x16x32_bf16 v[216:219], v[236:239], v[172:175], v[216:219]
    v_mfma_f32_16x16x32_bf16 v[220:223], v[240:243], v[172:175], v[220:223]
    v_mfma_f32_16x16x32_bf16 v[224:227], v[244:247], v[172:175], v[224:227]
    v_mfma_f32_16x16x32_bf16 v[228:231], v[248:251], v[172:175], v[228:231]
    s_nop 4
    ds_write_b128 v17, v[212:215] offset:0
    ds_write_b128 v17, v[216:219] offset:1024
    ds_write_b128 v17, v[220:223] offset:2048
    ds_write_b128 v17, v[224:227] offset:3072
    ds_write_b128 v17, v[228:231] offset:4096
    s_branch L_a_x
L_a_short:
    s_setprio 1
    s_cmp_eq_u32 s10, 1
    s_cbranch_scc1 L_a_g11
    s_cmp_eq_u32 s10, 2
    s_cbranch_scc1 L_a_g12
    s_cmp_eq_u32 s10, 3
    s_cbranch_scc1 L_a_g13
    s_add_u32 m0, s48, 0
    s_mov_b32 s11, 0
    buffer_load_dwordx4 v12, s[36:39], s11 offen sc1 lds
    s_add_u32 m0, s48, 1024
    s_mov_b32 s11, 0
    buffer_load_dwordx4 v13, s[36:39], s11 offen sc1 lds
    s_add_u32 m0, s48, 2048
    s_mov_b32 s11, 0
    buffer_load_dwordx4 v14, s[36:39], s11 offen sc1 lds
    s_add_u32 m0, s48, 3072
    s_mov_b32 s11, 0
    buffer_load_dwordx4 v15, s[36:39], s11 offen sc1 lds
    s_add_u32 m0, s48, 4096
    s_mov_b32 s11, 0
    buffer_load_dwordx4 v16, s[36:39], s11 offen sc1 lds
    s_add_u32 m0, s48, 10240
    s_mov_b32 s11, 43008
    buffer_load_dwordx4 v12, s[36:39], s11 offen sc1 lds
    s_add_u32 m0, s48, 11264
    s_mov_b32 s11, 43008
    buffer_load_dwordx4 v13, s[36:39], s11 offen sc1 lds
    s_add_u32 m0, s48, 12288
    s_mov_b32 s11, 43008
    buffer_load_dwordx4 v14, s[36:39], s11 offen sc1 lds
    s_add_u32 m0, s48, 13312
    s_mov_b32 s11, 43008
    buffer_load_dwordx4 v15, s[36:39], s11 offen sc1 lds
    s_add_u32 m0, s48, 14336
    s_mov_b32 s11, 43008
    buffer_load_dwordx4 v16, s[36:39], s11 offen sc1 lds
    s_waitcnt vmcnt(5)
    s_barrier
    ds_read_b128 v[32:35], v9 offset:0
    ds_read_b128 v[36:39], v9 offset:256
    ds_read_b128 v[40:43], v9 offset:512
    ds_read_b128 v[44:47], v9 offset:768
    ds_read_b128 v[48:51], v9 offset:1024
    ds_read_b128 v[128:131], v9 offset:5120
    ds_read_b128 v[132:135], v9 offset:5376
    ds_read_b128 v[136:139], v9 offset:5632
    ds_read_b128 v[140:143], v9 offset:5888
    ds_read_b128 v[144:147], v9 offset:6144
    s_waitcnt lgkmcnt(5)
    s_waitcnt vmcnt(0)
    s_barrier
    v_mfma_f32_16x16x32_bf16 v[192:195], v[32:35], v[64:67], 0
    ds_read_b128 v[148:151], v9 offset:10240
    s_add_u32 m0, s48, 20480
    s_mov_b32 s11, 86016
    buffer_load_dwordx4 v12, s[36:39], s11 offen sc1 lds
    v_mfma_f32_16x16x32_bf16 v[196:199], v[36:39], v[64:67], 0
    ds_read_b128 v[152:155], v9 offset:10496
    s_add_u32 m0, s48, 21504
    s_mov_b32 s11, 86016
    buffer_load_dwordx4 v13, s[36:39], s11 offen sc1 lds
    v_mfma_f32_16x16x32_bf16 v[200:203], v[40:43], v[64:67], 0
    ds_read_b128 v[156:159], v9 offset:10752
    s_add_u32 m0, s48, 22528
    s_mov_b32 s11, 86016
    buffer_load_dwordx4 v14, s[36:39], s11 offen sc1 lds
    v_mfma_f32_16x16x32_bf16 v[204:207], v[44:47], v[64:67], 0
    ds_read_b128 v[160:163], v9 offset:11008
    s_add_u32 m0, s48, 23552
    s_mov_b32 s11, 86016
    buffer_load_dwordx4 v15, s[36:39], s11 offen sc1 lds
    v_mfma_f32_16x16x32_bf16 v[208:211], v[48:51], v[64:67], 0
    ds_read_b128 v[164:167], v9 offset:11264
    s_add_u32 m0, s48, 24576
    s_mov_b32 s11, 86016
    buffer_load_dwordx4 v16, s[36:39], s11 offen sc1 lds
    s_waitcnt lgkmcnt(5)
    v_mfma_f32_16x16x32_bf16 v[192:195], v[128:131], v[68:71], v[192:195]
    ds_read_b128 v[32:35], v9 offset:15360
    s_add_u32 m0, s48, 30720
    s_mov_b32 s11, 129024
    buffer_load_dwordx4 v12, s[36:39], s11 offen sc1 lds
    v_mfma_f32_16x16x32_bf16 v[196:199], v[132:135], v[68:71], v[196:199]
    ds_read_b128 v[36:39], v9 offset:15616
    s_add_u32 m0, s48, 31744
    s_mov_b32 s11, 129024
    buffer_load_dwordx4 v13, s[36:39], s11 offen sc1 lds
    v_mfma_f32_16x16x32_bf16 v[200:203], v[136:139], v[68:71], v[200:203]
    ds_read_b128 v[40:43], v9 offset:15872
    s_add_u32 m0, s48, 32768
    s_mov_b32 s11, 129024
    buffer_load_dwordx4 v14, s[36:39], s11 offen sc1 lds
    v_mfma_f32_16x16x32_bf16 v[204:207], v[140:143], v[68:71], v[204:207]
    ds_read_b128 v[44:47], v9 offset:16128
    s_add_u32 m0, s48, 33792
    s_mov_b32 s11, 129024
    buffer_load_dwordx4 v15, s[36:39], s11 offen sc1 lds
    v_mfma_f32_16x16x32_bf16 v[208:211], v[144:147], v[68:71], v[208:211]
    ds_read_b128 v[48:51], v9 offset:16384
    s_add_u32 m0, s48, 34816
    s_mov_b32 s11, 129024
    buffer_load_dwordx4 v16, s[36:39], s11 offen sc1 lds
    s_waitcnt lgkmcnt(5)
    s_waitcnt vmcnt(5)
    s_barrier
    v_mfma_f32_16x16x32_bf16 v[192:195], v[148:151], v[72:75], v[192:195]
    ds_read_b128 v[128:131], v9 offset:20480
    s_add_u32 m0, s48, 40960
    s_mov_b32 s11, 172032
    buffer_load_dwordx4 v12, s[36:39], s11 offen sc1 lds
    v_mfma_f32_16x16x32_bf16 v[196:199], v[152:155], v[72:75], v[196:199]
    ds_read_b128 v[132:135], v9 offset:20736
    s_add_u32 m0, s48, 41984
    s_mov_b32 s11, 172032
    buffer_load_dwordx4 v13, s[36:39], s11 offen sc1 lds
    v_mfma_f32_16x16x32_bf16 v[200:203], v[156:159], v[72:75], v[200:203]
    ds_read_b128 v[136:139], v9 offset:20992
    s_add_u32 m0, s48, 43008
    s_mov_b32 s11, 172032
    buffer_load_dwordx4 v14, s[36:39], s11 offen sc1 lds
    v_mfma_f32_16x16x32_bf16 v[204:207], v[160:163], v[72:75], v[204:207]
    ds_read_b128 v[140:143], v9 offset:21248
    s_add_u32 m0, s48, 44032
    s_mov_b32 s11, 172032
    buffer_load_dwordx4 v15, s[36:39], s11 offen sc1 lds
    v_mfma_f32_16x16x32_bf16 v[208:211], v[164:167], v[72:75], v[208:211]
    ds_read_b128 v[144:147], v9 offset:21504
    s_add_u32 m0, s48, 45056
    s_mov_b32 s11, 172032
    buffer_load_dwordx4 v16, s[36:39], s11 offen sc1 lds
    s_waitcnt lgkmcnt(5)
    v_mfma_f32_16x16x32_bf16 v[192:195], v[32:35], v[76:79], v[192:195]
    ds_read_b128 v[148:151], v9 offset:25600
    s_add_u32 m0, s48, 51200
    s_mov_b32 s11, 215040
    buffer_load_dwordx4 v12, s[36:39], s11 offen sc1 lds
    v_mfma_f32_16x16x32_bf16 v[196:199], v[36:39], v[76:79], v[196:199]
    ds_read_b128 v[152:155], v9 offset:25856
    s_add_u32 m0, s48, 52224
    s_mov_b32 s11, 215040
    buffer_load_dwordx4 v13, s[36:39], s11 offen sc1 lds
    v_mfma_f32_16x16x32_bf16 v[200:203], v[40:43], v[76:79], v[200:203]
    ds_read_b128 v[156:159], v9 offset:26112
    s_add_u32 m0, s48, 53248
    s_mov_b32 s11, 215040
    buffer_load_dwordx4 v14, s[36:39], s11 offen sc1 lds
    v_mfma_f32_16x16x32_bf16 v[204:207], v[44:47], v[76:79], v[204:207]
    ds_read_b128 v[160:163], v9 offset:26368
    s_add_u32 m0, s48, 54272
    s_mov_b32 s11, 215040
    buffer_load_dwordx4 v15, s[36:39], s11 offen sc1 lds
    v_mfma_f32_16x16x32_bf16 v[208:211], v[48:51], v[76:79], v[208:211]
    ds_read_b128 v[164:167], v9 offset:26624
    s_add_u32 m0, s48, 55296
    s_mov_b32 s11, 215040
    buffer_load_dwordx4 v16, s[36:39], s11 offen sc1 lds
    s_waitcnt lgkmcnt(5)
    s_waitcnt vmcnt(10)
    s_barrier
    v_mfma_f32_16x16x32_bf16 v[192:195], v[128:131], v[80:83], v[192:195]
    ds_read_b128 v[32:35], v9 offset:30720
    s_add_u32 m0, s48, 61440
    s_mov_b32 s11, 258048
    buffer_load_dwordx4 v12, s[36:39], s11 offen sc1 lds
    v_mfma_f32_16x16x32_bf16 v[196:199], v[132:135], v[80:83], v[196:199]
    ds_read_b128 v[36:39], v9 offset:30976
    s_add_u32 m0, s48, 62464
    s_mov_b32 s11, 258048
    buffer_load_dwordx4 v13, s[36:39], s11 offen sc1 lds
    v_mfma_f32_16x16x32_bf16 v[200:203], v[136:139], v[80:83], v[200:203]
    ds_read_b128 v[40:43], v9 offset:31232
    s_add_u32 m0, s48, 63488
    s_mov_b32 s11, 258048
    buffer_load_dwordx4 v14, s[36:39], s11 offen sc1 lds
    v_mfma_f32_16x16x32_bf16 v[204:207], v[140:143], v[80:83], v[204:207]
    ds_read_b128 v[44:47], v9 offset:31488
    s_add_u32 m0, s48, 64512
    s_mov_b32 s11, 258048
    buffer_load_dwordx4 v15, s[36:39], s11 offen sc1 lds
    v_mfma_f32_16x16x32_bf16 v[208:211], v[144:147], v[80:83], v[208:211]
    ds_read_b128 v[48:51], v9 offset:31744
    s_add_u32 m0, s48, 65536
    s_mov_b32 s11, 258048
    buffer_load_dwordx4 v16, s[36:39], s11 offen sc1 lds
    s_waitcnt lgkmcnt(5)
    v_mfma_f32_16x16x32_bf16 v[192:195], v[148:151], v[84:87], v[192:195]
    ds_read_b128 v[128:131], v9 offset:35840
    s_add_u32 m0, s48, 71680
    s_mov_b32 s11, 301056
    buffer_load_dwordx4 v12, s[36:39], s11 offen sc1 lds
    v_mfma_f32_16x16x32_bf16 v[196:199], v[152:155], v[84:87], v[196:199]
    ds_read_b128 v[132:135], v9 offset:36096
    s_add_u32 m0, s48, 72704
    s_mov_b32 s11, 301056
    buffer_load_dwordx4 v13, s[36:39], s11 offen sc1 lds
    v_mfma_f32_16x16x32_bf16 v[200:203], v[156:159], v[84:87], v[200:203]
    ds_read_b128 v[136:139], v9 offset:36352
    s_add_u32 m0, s48, 73728
    s_mov_b32 s11, 301056
    buffer_load_dwordx4 v14, s[36:39], s11 offen sc1 lds
    v_mfma_f32_16x16x32_bf16 v[204:207], v[160:163], v[84:87], v[204:207]
    ds_read_b128 v[140:143], v9 offset:36608
    v_mfma_f32_16x16x32_bf16 v[208:211], v[164:167], v[84:87], v[208:211]
    ds_read_b128 v[144:147], v9 offset:36864
    s_waitcnt lgkmcnt(5)
    s_waitcnt vmcnt(8)
    s_barrier
    v_mfma_f32_16x16x32_bf16 v[192:195], v[32:35], v[88:91], v[192:195]
    ds_read_b128 v[148:151], v8 offset:0
    s_add_u32 m0, s48, 74752
    s_mov_b32 s11, 301056
    buffer_load_dwordx4 v15, s[36:39], s11 offen sc1 lds
    v_mfma_f32_16x16x32_bf16 v[196:199], v[36:39], v[88:91], v[196:199]
    ds_read_b128 v[152:155], v8 offset:256
    s_add_u32 m0, s48, 75776
    s_mov_b32 s11, 301056
    buffer_load_dwordx4 v16, s[36:39], s11 offen sc1 lds
    v_mfma_f32_16x16x32_bf16 v[200:203], v[40:43], v[88:91], v[200:203]
    ds_read_b128 v[156:159], v8 offset:512
    v_mfma_f32_16x16x32_bf16 v[204:207], v[44:47], v[88:91], v[204:207]
    ds_read_b128 v[160:163], v8 offset:768
    v_mfma_f32_16x16x32_bf16 v[208:211], v[48:51], v[88:91], v[208:211]
    ds_read_b128 v[164:167], v8 offset:1024
    s_waitcnt lgkmcnt(5)
    v_mfma_f32_16x16x32_bf16 v[192:195], v[128:131], v[92:95], v[192:195]
    ds_read_b128 v[32:35], v8 offset:5120
    v_mfma_f32_16x16x32_bf16 v[196:199], v[132:135], v[92:95], v[196:199]
    ds_read_b128 v[36:39], v8 offset:5376
    v_mfma_f32_16x16x32_bf16 v[200:203], v[136:139], v[92:95], v[200:203]
    ds_read_b128 v[40:43], v8 offset:5632
    v_mfma_f32_16x16x32_bf16 v[204:207], v[140:143], v[92:95], v[204:207]
    ds_read_b128 v[44:47], v8 offset:5888
    v_mfma_f32_16x16x32_bf16 v[208:211], v[144:147], v[92:95], v[208:211]
    ds_read_b128 v[48:51], v8 offset:6144
    s_waitcnt lgkmcnt(5)
    v_mfma_f32_16x16x32_bf16 v[192:195], v[148:151], v[96:99], v[192:195]
    ds_read_b128 v[128:131], v8 offset:10240
    v_mfma_f32_16x16x32_bf16 v[196:199], v[152:155], v[96:99], v[196:199]
    ds_read_b128 v[132:135], v8 offset:10496
    v_mfma_f32_16x16x32_bf16 v[200:203], v[156:159], v[96:99], v[200:203]
    ds_read_b128 v[136:139], v8 offset:10752
    v_mfma_f32_16x16x32_bf16 v[204:207], v[160:163], v[96:99], v[204:207]
    ds_read_b128 v[140:143], v8 offset:11008
    v_mfma_f32_16x16x32_bf16 v[208:211], v[164:167], v[96:99], v[208:211]
    ds_read_b128 v[144:147], v8 offset:11264
    s_waitcnt lgkmcnt(5)
    v_mfma_f32_16x16x32_bf16 v[192:195], v[32:35], v[100:103], v[192:195]
    ds_read_b128 v[148:151], v8 offset:15360
    v_mfma_f32_16x16x32_bf16 v[196:199], v[36:39], v[100:103], v[196:199]
    ds_read_b128 v[152:155], v8 offset:15616
    v_mfma_f32_16x16x32_bf16 v[200:203], v[40:43], v[100:103], v[200:203]
    ds_read_b128 v[156:159], v8 offset:15872
    v_mfma_f32_16x16x32_bf16 v[204:207], v[44:47], v[100:103], v[204:207]
    ds_read_b128 v[160:163], v8 offset:16128
    v_mfma_f32_16x16x32_bf16 v[208:211], v[48:51], v[100:103], v[208:211]
    ds_read_b128 v[164:167], v8 offset:16384
    s_waitcnt lgkmcnt(5)
    s_waitcnt vmcnt(0)
    s_barrier
    v_mfma_f32_16x16x32_bf16 v[192:195], v[128:131], v[104:107], v[192:195]
    ds_read_b128 v[32:35], v8 offset:20480
    v_mfma_f32_16x16x32_bf16 v[196:199], v[132:135], v[104:107], v[196:199]
    ds_read_b128 v[36:39], v8 offset:20736
    v_mfma_f32_16x16x32_bf16 v[200:203], v[136:139], v[104:107], v[200:203]
    ds_read_b128 v[40:43], v8 offset:20992
    v_mfma_f32_16x16x32_bf16 v[204:207], v[140:143], v[104:107], v[204:207]
    ds_read_b128 v[44:47], v8 offset:21248
    v_mfma_f32_16x16x32_bf16 v[208:211], v[144:147], v[104:107], v[208:211]
    ds_read_b128 v[48:51], v8 offset:21504
    s_waitcnt lgkmcnt(5)
    v_mfma_f32_16x16x32_bf16 v[192:195], v[148:151], v[108:111], v[192:195]
    ds_read_b128 v[128:131], v8 offset:25600
    v_mfma_f32_16x16x32_bf16 v[196:199], v[152:155], v[108:111], v[196:199]
    ds_read_b128 v[132:135], v8 offset:25856
    v_mfma_f32_16x16x32_bf16 v[200:203], v[156:159], v[108:111], v[200:203]
    ds_read_b128 v[136:139], v8 offset:26112
    v_mfma_f32_16x16x32_bf16 v[204:207], v[160:163], v[108:111], v[204:207]
    ds_read_b128 v[140:143], v8 offset:26368
    v_mfma_f32_16x16x32_bf16 v[208:211], v[164:167], v[108:111], v[208:211]
    ds_read_b128 v[144:147], v8 offset:26624
    s_waitcnt lgkmcnt(5)
    v_mfma_f32_16x16x32_bf16 v[192:195], v[32:35], v[112:115], v[192:195]
    ds_read_b128 v[148:151], v8 offset:30720
    v_mfma_f32_16x16x32_bf16 v[196:199], v[36:39], v[112:115], v[196:199]
    ds_read_b128 v[152:155], v8 offset:30976
    v_mfma_f32_16x16x32_bf16 v[200:203], v[40:43], v[112:115], v[200:203]
    ds_read_b128 v[156:159], v8 offset:31232
    v_mfma_f32_16x16x32_bf16 v[204:207], v[44:47], v[112:115], v[204:207]
    ds_read_b128 v[160:163], v8 offset:31488
    v_mfma_f32_16x16x32_bf16 v[208:211], v[48:51], v[112:115], v[208:211]
    ds_read_b128 v[164:167], v8 offset:31744
    s_cmp_lg_u32 s3, 4
    s_cbranch_scc1 L_a_v_53
    buffer_load_dwordx2 v[60:61], v10, s[36:39], 0 offen sc1
L_a_v_53:
    s_waitcnt lgkmcnt(5)
    v_mfma_f32_16x16x32_bf16 v[192:195], v[128:131], v[116:119], v[192:195]
    ds_read_b128 v[32:35], v8 offset:35840
    v_mfma_f32_16x16x32_bf16 v[196:199], v[132:135], v[116:119], v[196:199]
    ds_read_b128 v[36:39], v8 offset:36096
    v_mfma_f32_16x16x32_bf16 v[200:203], v[136:139], v[116:119], v[200:203]
    ds_read_b128 v[40:43], v8 offset:36352
    v_mfma_f32_16x16x32_bf16 v[204:207], v[140:143], v[116:119], v[204:207]
    ds_read_b128 v[44:47], v8 offset:36608
    v_mfma_f32_16x16x32_bf16 v[208:211], v[144:147], v[116:119], v[208:211]
    ds_read_b128 v[48:51], v8 offset:36864
    s_waitcnt lgkmcnt(5)
    v_mfma_f32_16x16x32_bf16 v[192:195], v[148:151], v[120:123], v[192:195]
    v_mfma_f32_16x16x32_bf16 v[196:199], v[152:155], v[120:123], v[196:199]
    v_mfma_f32_16x16x32_bf16 v[200:203], v[156:159], v[120:123], v[200:203]
    v_mfma_f32_16x16x32_bf16 v[204:207], v[160:163], v[120:123], v[204:207]
    v_mfma_f32_16x16x32_bf16 v[208:211], v[164:167], v[120:123], v[208:211]
    s_waitcnt lgkmcnt(0)
    v_mfma_f32_16x16x32_bf16 v[192:195], v[32:35], v[124:127], v[192:195]
    v_mfma_f32_16x16x32_bf16 v[196:199], v[36:39], v[124:127], v[196:199]
    v_mfma_f32_16x16x32_bf16 v[200:203], v[40:43], v[124:127], v[200:203]
    v_mfma_f32_16x16x32_bf16 v[204:207], v[44:47], v[124:127], v[204:207]
    v_mfma_f32_16x16x32_bf16 v[208:211], v[48:51], v[124:127], v[208:211]
    s_nop 4
    s_cmp_lg_u32 s3, 4
    s_cbranch_scc1 L_a_v_54
    s_waitcnt vmcnt(0)
    ds_write_b64 v62, v[60:61]
L_a_v_54:
    ds_write_b128 v17, v[192:195] offset:0
    ds_write_b128 v17, v[196:199] offset:1024
    ds_write_b128 v17, v[200:203] offset:2048
    ds_write_b128 v17, v[204:207] offset:3072
    ds_write_b128 v17, v[208:211] offset:4096
    s_branch L_a_x
L_a_g11:
    s_add_u32 m0, s48, 20480
    s_mov_b32 s11, 86016
    buffer_load_dwordx4 v12, s[36:39], s11 offen sc1 lds
    s_add_u32 m0, s48, 21504
    s_mov_b32 s11, 86016
    buffer_load_dwordx4 v13, s[36:39], s11 offen sc1 lds
    s_add_u32 m0, s48, 22528
    s_mov_b32 s11, 86016
    buffer_load_dwordx4 v14, s[36:39], s11 offen sc1 lds
    s_add_u32 m0, s48, 23552
    s_mov_b32 s11, 86016
    buffer_load_dwordx4 v15, s[36:39], s11 offen sc1 lds
    s_add_u32 m0, s48, 24576
    s_mov_b32 s11, 86016
    buffer_load_dwordx4 v16, s[36:39], s11 offen sc1 lds
    s_add_u32 m0, s48, 30720
    s_mov_b32 s11, 129024
    buffer_load_dwordx4 v12, s[36:39], s11 offen sc1 lds
    s_add_u32 m0, s48, 31744
    s_mov_b32 s11, 129024
    buffer_load_dwordx4 v13, s[36:39], s11 offen sc1 lds
    s_add_u32 m0, s48, 32768
    s_mov_b32 s11, 129024
    buffer_load_dwordx4 v14, s[36:39], s11 offen sc1 lds
    s_add_u32 m0, s48, 33792
    s_mov_b32 s11, 129024
    buffer_load_dwordx4 v15, s[36:39], s11 offen sc1 lds
    s_add_u32 m0, s48, 34816
    s_mov_b32 s11, 129024
    buffer_load_dwordx4 v16, s[36:39], s11 offen sc1 lds
    s_waitcnt vmcnt(5)
    s_barrier
    ds_read_b128 v[32:35], v9 offset:20480
    ds_read_b128 v[36:39], v9 offset:20736
    ds_read_b128 v[40:43], v9 offset:20992
    ds_read_b128 v[44:47], v9 offset:21248
    ds_read_b128 v[48:51], v9 offset:21504
    ds_read_b128 v[128:131], v9 offset:25600
    ds_read_b128 v[132:135], v9 offset:25856
    ds_read_b128 v[136:139], v9 offset:26112
    ds_read_b128 v[140:143], v9 offset:26368
    ds_read_b128 v[144:147], v9 offset:26624
    s_waitcnt lgkmcnt(5)
    s_waitcnt vmcnt(0)
    s_barrier
    v_mfma_f32_16x16x32_bf16 v[192:195], v[32:35], v[80:83], 0
    ds_read_b128 v[148:151], v9 offset:30720
    s_add_u32 m0, s48, 40960
    s_mov_b32 s11, 172032
    buffer_load_dwordx4 v12, s[36:39], s11 offen sc1 lds
    v_mfma_f32_16x16x32_bf16 v[196:199], v[36:39], v[80:83], 0
    ds_read_b128 v[152:155], v9 offset:30976
    s_add_u32 m0, s48, 41984
    s_mov_b32 s11, 172032
    buffer_load_dwordx4 v13, s[36:39], s11 offen sc1 lds
    v_mfma_f32_16x16x32_bf16 v[200:203], v[40:43], v[80:83], 0
    ds_read_b128 v[156:159], v9 offset:31232
    s_add_u32 m0, s48, 43008
    s_mov_b32 s11, 172032
    buffer_load_dwordx4 v14, s[36:39], s11 offen sc1 lds
    v_mfma_f32_16x16x32_bf16 v[204:207], v[44:47], v[80:83], 0
    ds_read_b128 v[160:163], v9 offset:31488
    s_add_u32 m0, s48, 44032
    s_mov_b32 s11, 172032
    buffer_load_dwordx4 v15, s[36:39], s11 offen sc1 lds
    v_mfma_f32_16x16x32_bf16 v[208:211], v[48:51], v[80:83], 0
    ds_read_b128 v[164:167], v9 offset:31744
    s_add_u32 m0, s48, 45056
    s_mov_b32 s11, 172032
    buffer_load_dwordx4 v16, s[36:39], s11 offen sc1 lds
    s_waitcnt lgkmcnt(5)
    v_mfma_f32_16x16x32_bf16 v[192:195], v[128:131], v[84:87], v[192:195]
    ds_read_b128 v[32:35], v9 offset:35840
    s_add_u32 m0, s48, 51200
    s_mov_b32 s11, 215040
    buffer_load_dwordx4 v12, s[36:39], s11 offen sc1 lds
    v_mfma_f32_16x16x32_bf16 v[196:199], v[132:135], v[84:87], v[196:199]
    ds_read_b128 v[36:39], v9 offset:36096
    s_add_u32 m0, s48, 52224
    s_mov_b32 s11, 215040
    buffer_load_dwordx4 v13, s[36:39], s11 offen sc1 lds
    v_mfma_f32_16x16x32_bf16 v[200:203], v[136:139], v[84:87], v[200:203]
    ds_read_b128 v[40:43], v9 offset:36352
    s_add_u32 m0, s48, 53248
    s_mov_b32 s11, 215040
    buffer_load_dwordx4 v14, s[36:39], s11 offen sc1 lds
    v_mfma_f32_16x16x32_bf16 v[204:207], v[140:143], v[84:87], v[204:207]
    ds_read_b128 v[44:47], v9 offset:36608
    s_add_u32 m0, s48, 54272
    s_mov_b32 s11, 215040
    buffer_load_dwordx4 v15, s[36:39], s11 offen sc1 lds
    v_mfma_f32_16x16x32_bf16 v[208:211], v[144:147], v[84:87], v[208:211]
    ds_read_b128 v[48:51], v9 offset:36864
    s_add_u32 m0, s48, 55296
    s_mov_b32 s11, 215040
    buffer_load_dwordx4 v16, s[36:39], s11 offen sc1 lds
    s_waitcnt lgkmcnt(5)
    s_waitcnt vmcnt(5)
    s_barrier
    v_mfma_f32_16x16x32_bf16 v[192:195], v[148:151], v[88:91], v[192:195]
    ds_read_b128 v[128:131], v8 offset:0
    s_add_u32 m0, s48, 61440
    s_mov_b32 s11, 258048
    buffer_load_dwordx4 v12, s[36:39], s11 offen sc1 lds
    v_mfma_f32_16x16x32_bf16 v[196:199], v[152:155], v[88:91], v[196:199]
    ds_read_b128 v[132:135], v8 offset:256
    s_add_u32 m0, s48, 62464
    s_mov_b32 s11, 258048
    buffer_load_dwordx4 v13, s[36:39], s11 offen sc1 lds
    v_mfma_f32_16x16x32_bf16 v[200:203], v[156:159], v[88:91], v[200:203]
    ds_read_b128 v[136:139], v8 offset:512
    s_add_u32 m0, s48, 63488
    s_mov_b32 s11, 258048
    buffer_load_dwordx4 v14, s[36:39], s11 offen sc1 lds
    v_mfma_f32_16x16x32_bf16 v[204:207], v[160:163], v[88:91], v[204:207]
    ds_read_b128 v[140:143], v8 offset:768
    s_add_u32 m0, s48, 64512
    s_mov_b32 s11, 258048
    buffer_load_dwordx4 v15, s[36:39], s11 offen sc1 lds
    v_mfma_f32_16x16x32_bf16 v[208:211], v[164:167], v[88:91], v[208:211]
    ds_read_b128 v[144:147], v8 offset:1024
    s_add_u32 m0, s48, 65536
    s_mov_b32 s11, 258048
    buffer_load_dwordx4 v16, s[36:39], s11 offen sc1 lds
    s_waitcnt lgkmcnt(5)
    v_mfma_f32_16x16x32_bf16 v[192:195], v[32:35], v[92:95], v[192:195]
    ds_read_b128 v[148:151], v8 offset:5120
    s_add_u32 m0, s48, 71680
    s_mov_b32 s11, 301056
    buffer_load_dwordx4 v12, s[36:39], s11 offen sc1 lds
    v_mfma_f32_16x16x32_bf16 v[196:199], v[36:39], v[92:95], v[196:199]
    ds_read_b128 v[152:155], v8 offset:5376
    s_add_u32 m0, s48, 72704
    s_mov_b32 s11, 301056
    buffer_load_dwordx4 v13, s[36:39], s11 offen sc1 lds
    v_mfma_f32_16x16x32_bf16 v[200:203], v[40:43], v[92:95], v[200:203]
    ds_read_b128 v[156:159], v8 offset:5632
    s_add_u32 m0, s48, 73728
    s_mov_b32 s11, 301056
    buffer_load_dwordx4 v14, s[36:39], s11 offen sc1 lds
    v_mfma_f32_16x16x32_bf16 v[204:207], v[44:47], v[92:95], v[204:207]
    ds_read_b128 v[160:163], v8 offset:5888
    s_add_u32 m0, s48, 74752
    s_mov_b32 s11, 301056
    buffer_load_dwordx4 v15, s[36:39], s11 offen sc1 lds
    v_mfma_f32_16x16x32_bf16 v[208:211], v[48:51], v[92:95], v[208:211]
    ds_read_b128 v[164:167], v8 offset:6144
    s_add_u32 m0, s48, 75776
    s_mov_b32 s11, 301056
    buffer_load_dwordx4 v16, s[36:39], s11 offen sc1 lds
    s_waitcnt lgkmcnt(5)
    s_waitcnt vmcnt(10)
    s_barrier
    v_mfma_f32_16x16x32_bf16 v[192:195], v[128:131], v[96:99], v[192:195]
    ds_read_b128 v[32:35], v8 offset:10240
    s_add_u32 m0, s48, 0
    s_mov_b32 s11, 0
    buffer_load_dwordx4 v12, s[36:39], s11 offen sc1 lds
    v_mfma_f32_16x16x32_bf16 v[196:199], v[132:135], v[96:99], v[196:199]
    ds_read_b128 v[36:39], v8 offset:10496
    s_add_u32 m0, s48, 1024
    s_mov_b32 s11, 0
    buffer_load_dwordx4 v13, s[36:39], s11 offen sc1 lds
    v_mfma_f32_16x16x32_bf16 v[200:203], v[136:139], v[96:99], v[200:203]
    ds_read_b128 v[40:43], v8 offset:10752
    s_add_u32 m0, s48, 2048
    s_mov_b32 s11, 0
    buffer_load_dwordx4 v14, s[36:39], s11 offen sc1 lds
    v_mfma_f32_16x16x32_bf16 v[204:207], v[140:143], v[96:99], v[204:207]
    ds_read_b128 v[44:47], v8 offset:11008
    s_add_u32 m0, s48, 3072
    s_mov_b32 s11, 0
    buffer_load_dwordx4 v15, s[36:39], s11 offen sc1 lds
    v_mfma_f32_16x16x32_bf16 v[208:211], v[144:147], v[96:99], v[208:211]
    ds_read_b128 v[48:51], v8 offset:11264
    s_add_u32 m0, s48, 4096
    s_mov_b32 s11, 0
    buffer_load_dwordx4 v16, s[36:39], s11 offen sc1 lds
    s_waitcnt lgkmcnt(5)
    v_mfma_f32_16x16x32_bf16 v[192:195], v[148:151], v[100:103], v[192:195]
    ds_read_b128 v[128:131], v8 offset:15360
    s_add_u32 m0, s48, 10240
    s_mov_b32 s11, 43008
    buffer_load_dwordx4 v12, s[36:39], s11 offen sc1 lds
    v_mfma_f32_16x16x32_bf16 v[196:199], v[152:155], v[100:103], v[196:199]
    ds_read_b128 v[132:135], v8 offset:15616
    s_add_u32 m0, s48, 11264
    s_mov_b32 s11, 43008
    buffer_load_dwordx4 v13, s[36:39], s11 offen sc1 lds
    v_mfma_f32_16x16x32_bf16 v[200:203], v[156:159], v[100:103], v[200:203]
    ds_read_b128 v[136:139], v8 offset:15872
    s_add_u32 m0, s48, 12288
    s_mov_b32 s11, 43008
    buffer_load_dwordx4 v14, s[36:39], s11 offen sc1 lds
    v_mfma_f32_16x16x32_bf16 v[204:207], v[160:163], v[100:103], v[204:207]
    ds_read_b128 v[140:143], v8 offset:16128
    v_mfma_f32_16x16x32_bf16 v[208:211], v[164:167], v[100:103], v[208:211]
    ds_read_b128 v[144:147], v8 offset:16384
    s_waitcnt lgkmcnt(5)
    s_waitcnt vmcnt(8)
    s_barrier
    v_mfma_f32_16x16x32_bf16 v[192:195], v[32:35], v[104:107], v[192:195]
    ds_read_b128 v[148:151], v8 offset:20480
    s_add_u32 m0, s48, 13312
    s_mov_b32 s11, 43008
    buffer_load_dwordx4 v15, s[36:39], s11 offen sc1 lds
    v_mfma_f32_16x16x32_bf16 v[196:199], v[36:39], v[104:107], v[196:199]
    ds_read_b128 v[152:155], v8 offset:20736
    s_add_u32 m0, s48, 14336
    s_mov_b32 s11, 43008
    buffer_load_dwordx4 v16, s[36:39], s11 offen sc1 lds
    v_mfma_f32_16x16x32_bf16 v[200:203], v[40:43], v[104:107], v[200:203]
    ds_read_b128 v[156:159], v8 offset:20992
    v_mfma_f32_16x16x32_bf16 v[204:207], v[44:47], v[104:107], v[204:207]
    ds_read_b128 v[160:163], v8 offset:21248
    v_mfma_f32_16x16x32_bf16 v[208:211], v[48:51], v[104:107], v[208:211]
    ds_read_b128 v[164:167], v8 offset:21504
    s_waitcnt lgkmcnt(5)
    v_mfma_f32_16x16x32_bf16 v[192:195], v[128:131], v[108:111], v[192:195]
    ds_read_b128 v[32:35], v8 offset:25600
    v_mfma_f32_16x16x32_bf16 v[196:199], v[132:135], v[108:111], v[196:199]
    ds_read_b128 v[36:39], v8 offset:25856
    v_mfma_f32_16x16x32_bf16 v[200:203], v[136:139], v[108:111], v[200:203]
    ds_read_b128 v[40:43], v8 offset:26112
    v_mfma_f32_16x16x32_bf16 v[204:207], v[140:143], v[108:111], v[204:207]
    ds_read_b128 v[44:47], v8 offset:26368
    v_mfma_f32_16x16x32_bf16 v[208:211], v[144:147], v[108:111], v[208:211]
    ds_read_b128 v[48:51], v8 offset:26624
    s_waitcnt lgkmcnt(5)
    v_mfma_f32_16x16x32_bf16 v[192:195], v[148:151], v[112:115], v[192:195]
    ds_read_b128 v[128:131], v8 offset:30720
    v_mfma_f32_16x16x32_bf16 v[196:199], v[152:155], v[112:115], v[196:199]
    ds_read_b128 v[132:135], v8 offset:30976
    v_mfma_f32_16x16x32_bf16 v[200:203], v[156:159], v[112:115], v[200:203]
    ds_read_b128 v[136:139], v8 offset:31232
    v_mfma_f32_16x16x32_bf16 v[204:207], v[160:163], v[112:115], v[204:207]
    ds_read_b128 v[140:143], v8 offset:31488
    v_mfma_f32_16x16x32_bf16 v[208:211], v[164:167], v[112:115], v[208:211]
    ds_read_b128 v[144:147], v8 offset:31744
    s_waitcnt lgkmcnt(5)
    v_mfma_f32_16x16x32_bf16 v[192:195], v[32:35], v[116:119], v[192:195]
    ds_read_b128 v[148:151], v8 offset:35840
    v_mfma_f32_16x16x32_bf16 v[196:199], v[36:39], v[116:119], v[196:199]
    ds_read_b128 v[152:155], v8 offset:36096
    v_mfma_f32_16x16x32_bf16 v[200:203], v[40:43], v[116:119], v[200:203]
    ds_read_b128 v[156:159], v8 offset:36352
    v_mfma_f32_16x16x32_bf16 v[204:207], v[44:47], v[116:119], v[204:207]
    ds_read_b128 v[160:163], v8 offset:36608
    v_mfma_f32_16x16x32_bf16 v[208:211], v[48:51], v[116:119], v[208:211]
    ds_read_b128 v[164:167], v8 offset:36864
    s_waitcnt lgkmcnt(5)
    s_waitcnt vmcnt(0)
    s_barrier
    v_mfma_f32_16x16x32_bf16 v[192:195], v[128:131], v[120:123], v[192:195]
    ds_read_b128 v[32:35], v9 offset:0
    v_mfma_f32_16x16x32_bf16 v[196:199], v[132:135], v[120:123], v[196:199]
    ds_read_b128 v[36:39], v9 offset:256
    v_mfma_f32_16x16x32_bf16 v[200:203], v[136:139], v[120:123], v[200:203]
    ds_read_b128 v[40:43], v9 offset:512
    v_mfma_f32_16x16x32_bf16 v[204:207], v[140:143], v[120:123], v[204:207]
    ds_read_b128 v[44:47], v9 offset:768
    v_mfma_f32_16x16x32_bf16 v[208:211], v[144:147], v[120:123], v[208:211]
    ds_read_b128 v[48:51], v9 offset:1024
    s_waitcnt lgkmcnt(5)
    v_mfma_f32_16x16x32_bf16 v[192:195], v[148:151], v[124:127], v[192:195]
    ds_read_b128 v[128:131], v9 offset:5120
    v_mfma_f32_16x16x32_bf16 v[196:199], v[152:155], v[124:127], v[196:199]
    ds_read_b128 v[132:135], v9 offset:5376
    v_mfma_f32_16x16x32_bf16 v[200:203], v[156:159], v[124:127], v[200:203]
    ds_read_b128 v[136:139], v9 offset:5632
    v_mfma_f32_16x16x32_bf16 v[204:207], v[160:163], v[124:127], v[204:207]
    ds_read_b128 v[140:143], v9 offset:5888
    v_mfma_f32_16x16x32_bf16 v[208:211], v[164:167], v[124:127], v[208:211]
    ds_read_b128 v[144:147], v9 offset:6144
    s_waitcnt lgkmcnt(5)
    v_mfma_f32_16x16x32_bf16 v[192:195], v[32:35], v[64:67], v[192:195]
    ds_read_b128 v[148:151], v9 offset:10240
    v_mfma_f32_16x16x32_bf16 v[196:199], v[36:39], v[64:67], v[196:199]
    ds_read_b128 v[152:155], v9 offset:10496
    v_mfma_f32_16x16x32_bf16 v[200:203], v[40:43], v[64:67], v[200:203]
    ds_read_b128 v[156:159], v9 offset:10752
    v_mfma_f32_16x16x32_bf16 v[204:207], v[44:47], v[64:67], v[204:207]
    ds_read_b128 v[160:163], v9 offset:11008
    v_mfma_f32_16x16x32_bf16 v[208:211], v[48:51], v[64:67], v[208:211]
    ds_read_b128 v[164:167], v9 offset:11264
    s_cmp_lg_u32 s3, 4
    s_cbranch_scc1 L_a_v_55
    buffer_load_dwordx2 v[60:61], v10, s[36:39], 0 offen sc1
L_a_v_55:
    s_waitcnt lgkmcnt(5)
    v_mfma_f32_16x16x32_bf16 v[192:195], v[128:131], v[68:71], v[192:195]
    ds_read_b128 v[32:35], v9 offset:15360
    v_mfma_f32_16x16x32_bf16 v[196:199], v[132:135], v[68:71], v[196:199]
    ds_read_b128 v[36:39], v9 offset:15616
    v_mfma_f32_16x16x32_bf16 v[200:203], v[136:139], v[68:71], v[200:203]
    ds_read_b128 v[40:43], v9 offset:15872
    v_mfma_f32_16x16x32_bf16 v[204:207], v[140:143], v[68:71], v[204:207]
    ds_read_b128 v[44:47], v9 offset:16128
    v_mfma_f32_16x16x32_bf16 v[208:211], v[144:147], v[68:71], v[208:211]
    ds_read_b128 v[48:51], v9 offset:16384
    s_waitcnt lgkmcnt(5)
    v_mfma_f32_16x16x32_bf16 v[192:195], v[148:151], v[72:75], v[192:195]
    v_mfma_f32_16x16x32_bf16 v[196:199], v[152:155], v[72:75], v[196:199]
    v_mfma_f32_16x16x32_bf16 v[200:203], v[156:159], v[72:75], v[200:203]
    v_mfma_f32_16x16x32_bf16 v[204:207], v[160:163], v[72:75], v[204:207]
    v_mfma_f32_16x16x32_bf16 v[208:211], v[164:167], v[72:75], v[208:211]
    s_waitcnt lgkmcnt(0)
    v_mfma_f32_16x16x32_bf16 v[192:195], v[32:35], v[76:79], v[192:195]
    v_mfma_f32_16x16x32_bf16 v[196:199], v[36:39], v[76:79], v[196:199]
    v_mfma_f32_16x16x32_bf16 v[200:203], v[40:43], v[76:79], v[200:203]
    v_mfma_f32_16x16x32_bf16 v[204:207], v[44:47], v[76:79], v[204:207]
    v_mfma_f32_16x16x32_bf16 v[208:211], v[48:51], v[76:79], v[208:211]
    s_nop 4
    s_cmp_lg_u32 s3, 4
    s_cbranch_scc1 L_a_v_56
    s_waitcnt vmcnt(0)
    ds_write_b64 v62, v[60:61]
L_a_v_56:
    ds_write_b128 v17, v[192:195] offset:0
    ds_write_b128 v17, v[196:199] offset:1024
    ds_write_b128 v17, v[200:203] offset:2048
    ds_write_b128 v17, v[204:207] offset:3072
    ds_write_b128 v17, v[208:211] offset:4096
    s_branch L_a_x
L_a_g12:
    s_add_u32 m0, s48, 40960
    s_mov_b32 s11, 172032
    buffer_load_dwordx4 v12, s[36:39], s11 offen sc1 lds
    s_add_u32 m0, s48, 41984
    s_mov_b32 s11, 172032
    buffer_load_dwordx4 v13, s[36:39], s11 offen sc1 lds
    s_add_u32 m0, s48, 43008
    s_mov_b32 s11, 172032
    buffer_load_dwordx4 v14, s[36:39], s11 offen sc1 lds
    s_add_u32 m0, s48, 44032
    s_mov_b32 s11, 172032
    buffer_load_dwordx4 v15, s[36:39], s11 offen sc1 lds
    s_add_u32 m0, s48, 45056
    s_mov_b32 s11, 172032
    buffer_load_dwordx4 v16, s[36:39], s11 offen sc1 lds
    s_add_u32 m0, s48, 51200
    s_mov_b32 s11, 215040
    buffer_load_dwordx4 v12, s[36:39], s11 offen sc1 lds
    s_add_u32 m0, s48, 52224
    s_mov_b32 s11, 215040
    buffer_load_dwordx4 v13, s[36:39], s11 offen sc1 lds
    s_add_u32 m0, s48, 53248
    s_mov_b32 s11, 215040
    buffer_load_dwordx4 v14, s[36:39], s11 offen sc1 lds
    s_add_u32 m0, s48, 54272
    s_mov_b32 s11, 215040
    buffer_load_dwordx4 v15, s[36:39], s11 offen sc1 lds
    s_add_u32 m0, s48, 55296
    s_mov_b32 s11, 215040
    buffer_load_dwordx4 v16, s[36:39], s11 offen sc1 lds
    s_waitcnt vmcnt(5)
    s_barrier
    ds_read_b128 v[32:35], v8 offset:0
    ds_read_b128 v[36:39], v8 offset:256
    ds_read_b128 v[40:43], v8 offset:512
    ds_read_b128 v[44:47], v8 offset:768
    ds_read_b128 v[48:51], v8 offset:1024
    ds_read_b128 v[128:131], v8 offset:5120
    ds_read_b128 v[132:135], v8 offset:5376
    ds_read_b128 v[136:139], v8 offset:5632
    ds_read_b128 v[140:143], v8 offset:5888
    ds_read_b128 v[144:147], v8 offset:6144
    s_waitcnt lgkmcnt(5)
    s_waitcnt vmcnt(0)
    s_barrier
    v_mfma_f32_16x16x32_bf16 v[192:195], v[32:35], v[96:99], 0
    ds_read_b128 v[148:151], v8 offset:10240
    s_add_u32 m0, s48, 61440
    s_mov_b32 s11, 258048
    buffer_load_dwordx4 v12, s[36:39], s11 offen sc1 lds
    v_mfma_f32_16x16x32_bf16 v[196:199], v[36:39], v[96:99], 0
    ds_read_b128 v[152:155], v8 offset:10496
    s_add_u32 m0, s48, 62464
    s_mov_b32 s11, 258048
    buffer_load_dwordx4 v13, s[36:39], s11 offen sc1 lds
    v_mfma_f32_16x16x32_bf16 v[200:203], v[40:43], v[96:99], 0
    ds_read_b128 v[156:159], v8 offset:10752
    s_add_u32 m0, s48, 63488
    s_mov_b32 s11, 258048
    buffer_load_dwordx4 v14, s[36:39], s11 offen sc1 lds
    v_mfma_f32_16x16x32_bf16 v[204:207], v[44:47], v[96:99], 0
    ds_read_b128 v[160:163], v8 offset:11008
    s_add_u32 m0, s48, 64512
    s_mov_b32 s11, 258048
    buffer_load_dwordx4 v15, s[36:39], s11 offen sc1 lds
    v_mfma_f32_16x16x32_bf16 v[208:211], v[48:51], v[96:99], 0
    ds_read_b128 v[164:167], v8 offset:11264
    s_add_u32 m0, s48, 65536
    s_mov_b32 s11, 258048
    buffer_load_dwordx4 v16, s[36:39], s11 offen sc1 lds
    s_waitcnt lgkmcnt(5)
    v_mfma_f32_16x16x32_bf16 v[192:195], v[128:131], v[100:103], v[192:195]
    ds_read_b128 v[32:35], v8 offset:15360
    s_add_u32 m0, s48, 71680
    s_mov_b32 s11, 301056
    buffer_load_dwordx4 v12, s[36:39], s11 offen sc1 lds
    v_mfma_f32_16x16x32_bf16 v[196:199], v[132:135], v[100:103], v[196:199]
    ds_read_b128 v[36:39], v8 offset:15616
    s_add_u32 m0, s48, 72704
    s_mov_b32 s11, 301056
    buffer_load_dwordx4 v13, s[36:39], s11 offen sc1 lds
    v_mfma_f32_16x16x32_bf16 v[200:203], v[136:139], v[100:103], v[200:203]
    ds_read_b128 v[40:43], v8 offset:15872
    s_add_u32 m0, s48, 73728
    s_mov_b32 s11, 301056
    buffer_load_dwordx4 v14, s[36:39], s11 offen sc1 lds
    v_mfma_f32_16x16x32_bf16 v[204:207], v[140:143], v[100:103], v[204:207]
    ds_read_b128 v[44:47], v8 offset:16128
    s_add_u32 m0, s48, 74752
    s_mov_b32 s11, 301056
    buffer_load_dwordx4 v15, s[36:39], s11 offen sc1 lds
    v_mfma_f32_16x16x32_bf16 v[208:211], v[144:147], v[100:103], v[208:211]
    ds_read_b128 v[48:51], v8 offset:16384
    s_add_u32 m0, s48, 75776
    s_mov_b32 s11, 301056
    buffer_load_dwordx4 v16, s[36:39], s11 offen sc1 lds
    s_waitcnt lgkmcnt(5)
    s_waitcnt vmcnt(5)
    s_barrier
    v_mfma_f32_16x16x32_bf16 v[192:195], v[148:151], v[104:107], v[192:195]
    ds_read_b128 v[128:131], v8 offset:20480
    s_add_u32 m0, s48, 0
    s_mov_b32 s11, 0
    buffer_load_dwordx4 v12, s[36:39], s11 offen sc1 lds
    v_mfma_f32_16x16x32_bf16 v[196:199], v[152:155], v[104:107], v[196:199]
    ds_read_b128 v[132:135], v8 offset:20736
    s_add_u32 m0, s48, 1024
    s_mov_b32 s11, 0
    buffer_load_dwordx4 v13, s[36:39], s11 offen sc1 lds
    v_mfma_f32_16x16x32_bf16 v[200:203], v[156:159], v[104:107], v[200:203]
    ds_read_b128 v[136:139], v8 offset:20992
    s_add_u32 m0, s48, 2048
    s_mov_b32 s11, 0
    buffer_load_dwordx4 v14, s[36:39], s11 offen sc1 lds
    v_mfma_f32_16x16x32_bf16 v[204:207], v[160:163], v[104:107], v[204:207]
    ds_read_b128 v[140:143], v8 offset:21248
    s_add_u32 m0, s48, 3072
    s_mov_b32 s11, 0
    buffer_load_dwordx4 v15, s[36:39], s11 offen sc1 lds
    v_mfma_f32_16x16x32_bf16 v[208:211], v[164:167], v[104:107], v[208:211]
    ds_read_b128 v[144:147], v8 offset:21504
    s_add_u32 m0, s48, 4096
    s_mov_b32 s11, 0
    buffer_load_dwordx4 v16, s[36:39], s11 offen sc1 lds
    s_waitcnt lgkmcnt(5)
    v_mfma_f32_16x16x32_bf16 v[192:195], v[32:35], v[108:111], v[192:195]
    ds_read_b128 v[148:151], v8 offset:25600
    s_add_u32 m0, s48, 10240
    s_mov_b32 s11, 43008
    buffer_load_dwordx4 v12, s[36:39], s11 offen sc1 lds
    v_mfma_f32_16x16x32_bf16 v[196:199], v[36:39], v[108:111], v[196:199]
    ds_read_b128 v[152:155], v8 offset:25856
    s_add_u32 m0, s48, 11264
    s_mov_b32 s11, 43008
    buffer_load_dwordx4 v13, s[36:39], s11 offen sc1 lds
    v_mfma_f32_16x16x32_bf16 v[200:203], v[40:43], v[108:111], v[200:203]
    ds_read_b128 v[156:159], v8 offset:26112
    s_add_u32 m0, s48, 12288
    s_mov_b32 s11, 43008
    buffer_load_dwordx4 v14, s[36:39], s11 offen sc1 lds
    v_mfma_f32_16x16x32_bf16 v[204:207], v[44:47], v[108:111], v[204:207]
    ds_read_b128 v[160:163], v8 offset:26368
    s_add_u32 m0, s48, 13312
    s_mov_b32 s11, 43008
    buffer_load_dwordx4 v15, s[36:39], s11 offen sc1 lds
    v_mfma_f32_16x16x32_bf16 v[208:211], v[48:51], v[108:111], v[208:211]
    ds_read_b128 v[164:167], v8 offset:26624
    s_add_u32 m0, s48, 14336
    s_mov_b32 s11, 43008
    buffer_load_dwordx4 v16, s[36:39], s11 offen sc1 lds
    s_waitcnt lgkmcnt(5)
    s_waitcnt vmcnt(10)
    s_barrier
    v_mfma_f32_16x16x32_bf16 v[192:195], v[128:131], v[112:115], v[192:195]
    ds_read_b128 v[32:35], v8 offset:30720
    s_add_u32 m0, s48, 20480
    s_mov_b32 s11, 86016
    buffer_load_dwordx4 v12, s[36:39], s11 offen sc1 lds
    v_mfma_f32_16x16x32_bf16 v[196:199], v[132:135], v[112:115], v[196:199]
    ds_read_b128 v[36:39], v8 offset:30976
    s_add_u32 m0, s48, 21504
    s_mov_b32 s11, 86016
    buffer_load_dwordx4 v13, s[36:39], s11 offen sc1 lds
    v_mfma_f32_16x16x32_bf16 v[200:203], v[136:139], v[112:115], v[200:203]
    ds_read_b128 v[40:43], v8 offset:31232
    s_add_u32 m0, s48, 22528
    s_mov_b32 s11, 86016
    buffer_load_dwordx4 v14, s[36:39], s11 offen sc1 lds
    v_mfma_f32_16x16x32_bf16 v[204:207], v[140:143], v[112:115], v[204:207]
    ds_read_b128 v[44:47], v8 offset:31488
    s_add_u32 m0, s48, 23552
    s_mov_b32 s11, 86016
    buffer_load_dwordx4 v15, s[36:39], s11 offen sc1 lds
    v_mfma_f32_16x16x32_bf16 v[208:211], v[144:147], v[112:115], v[208:211]
    ds_read_b128 v[48:51], v8 offset:31744
    s_add_u32 m0, s48, 24576
    s_mov_b32 s11, 86016
    buffer_load_dwordx4 v16, s[36:39], s11 offen sc1 lds
    s_waitcnt lgkmcnt(5)
    v_mfma_f32_16x16x32_bf16 v[192:195], v[148:151], v[116:119], v[192:195]
    ds_read_b128 v[128:131], v8 offset:35840
    s_add_u32 m0, s48, 30720
    s_mov_b32 s11, 129024
    buffer_load_dwordx4 v12, s[36:39], s11 offen sc1 lds
    v_mfma_f32_16x16x32_bf16 v[196:199], v[152:155], v[116:119], v[196:199]
    ds_read_b128 v[132:135], v8 offset:36096
    s_add_u32 m0, s48, 31744
    s_mov_b32 s11, 129024
    buffer_load_dwordx4 v13, s[36:39], s11 offen sc1 lds
    v_mfma_f32_16x16x32_bf16 v[200:203], v[156:159], v[116:119], v[200:203]
    ds_read_b128 v[136:139], v8 offset:36352
    s_add_u32 m0, s48, 32768
    s_mov_b32 s11, 129024
    buffer_load_dwordx4 v14, s[36:39], s11 offen sc1 lds
    v_mfma_f32_16x16x32_bf16 v[204:207], v[160:163], v[116:119], v[204:207]
    ds_read_b128 v[140:143], v8 offset:36608
    v_mfma_f32_16x16x32_bf16 v[208:211], v[164:167], v[116:119], v[208:211]
    ds_read_b128 v[144:147], v8 offset:36864
    s_waitcnt lgkmcnt(5)
    s_waitcnt vmcnt(8)
    s_barrier
    v_mfma_f32_16x16x32_bf16 v[192:195], v[32:35], v[120:123], v[192:195]
    ds_read_b128 v[148:151], v9 offset:0
    s_add_u32 m0, s48, 33792
    s_mov_b32 s11, 129024
    buffer_load_dwordx4 v15, s[36:39], s11 offen sc1 lds
    v_mfma_f32_16x16x32_bf16 v[196:199], v[36:39], v[120:123], v[196:199]
    ds_read_b128 v[152:155], v9 offset:256
    s_add_u32 m0, s48, 34816
    s_mov_b32 s11, 129024
    buffer_load_dwordx4 v16, s[36:39], s11 offen sc1 lds
    v_mfma_f32_16x16x32_bf16 v[200:203], v[40:43], v[120:123], v[200:203]
    ds_read_b128 v[156:159], v9 offset:512
    v_mfma_f32_16x16x32_bf16 v[204:207], v[44:47], v[120:123], v[204:207]
    ds_read_b128 v[160:163], v9 offset:768
    v_mfma_f32_16x16x32_bf16 v[208:211], v[48:51], v[120:123], v[208:211]
    ds_read_b128 v[164:167], v9 offset:1024
    s_waitcnt lgkmcnt(5)
    v_mfma_f32_16x16x32_bf16 v[192:195], v[128:131], v[124:127], v[192:195]
    ds_read_b128 v[32:35], v9 offset:5120
    v_mfma_f32_16x16x32_bf16 v[196:199], v[132:135], v[124:127], v[196:199]
    ds_read_b128 v[36:39], v9 offset:5376
    v_mfma_f32_16x16x32_bf16 v[200:203], v[136:139], v[124:127], v[200:203]
    ds_read_b128 v[40:43], v9 offset:5632
    v_mfma_f32_16x16x32_bf16 v[204:207], v[140:143], v[124:127], v[204:207]
    ds_read_b128 v[44:47], v9 offset:5888
    v_mfma_f32_16x16x32_bf16 v[208:211], v[144:147], v[124:127], v[208:211]
    ds_read_b128 v[48:51], v9 offset:6144
    s_waitcnt lgkmcnt(5)
    v_mfma_f32_16x16x32_bf16 v[192:195], v[148:151], v[64:67], v[192:195]
    ds_read_b128 v[128:131], v9 offset:10240
    v_mfma_f32_16x16x32_bf16 v[196:199], v[152:155], v[64:67], v[196:199]
    ds_read_b128 v[132:135], v9 offset:10496
    v_mfma_f32_16x16x32_bf16 v[200:203], v[156:159], v[64:67], v[200:203]
    ds_read_b128 v[136:139], v9 offset:10752
    v_mfma_f32_16x16x32_bf16 v[204:207], v[160:163], v[64:67], v[204:207]
    ds_read_b128 v[140:143], v9 offset:11008
    v_mfma_f32_16x16x32_bf16 v[208:211], v[164:167], v[64:67], v[208:211]
    ds_read_b128 v[144:147], v9 offset:11264
    s_waitcnt lgkmcnt(5)
    v_mfma_f32_16x16x32_bf16 v[192:195], v[32:35], v[68:71], v[192:195]
    ds_read_b128 v[148:151], v9 offset:15360
    v_mfma_f32_16x16x32_bf16 v[196:199], v[36:39], v[68:71], v[196:199]
    ds_read_b128 v[152:155], v9 offset:15616
    v_mfma_f32_16x16x32_bf16 v[200:203], v[40:43], v[68:71], v[200:203]
    ds_read_b128 v[156:159], v9 offset:15872
    v_mfma_f32_16x16x32_bf16 v[204:207], v[44:47], v[68:71], v[204:207]
    ds_read_b128 v[160:163], v9 offset:16128
    v_mfma_f32_16x16x32_bf16 v[208:211], v[48:51], v[68:71], v[208:211]
    ds_read_b128 v[164:167], v9 offset:16384
    s_waitcnt lgkmcnt(5)
    s_waitcnt vmcnt(0)
    s_barrier
    v_mfma_f32_16x16x32_bf16 v[192:195], v[128:131], v[72:75], v[192:195]
    ds_read_b128 v[32:35], v9 offset:20480
    v_mfma_f32_16x16x32_bf16 v[196:199], v[132:135], v[72:75], v[196:199]
    ds_read_b128 v[36:39], v9 offset:20736
    v_mfma_f32_16x16x32_bf16 v[200:203], v[136:139], v[72:75], v[200:203]
    ds_read_b128 v[40:43], v9 offset:20992
    v_mfma_f32_16x16x32_bf16 v[204:207], v[140:143], v[72:75], v[204:207]
    ds_read_b128 v[44:47], v9 offset:21248
    v_mfma_f32_16x16x32_bf16 v[208:211], v[144:147], v[72:75], v[208:211]
    ds_read_b128 v[48:51], v9 offset:21504
    s_waitcnt lgkmcnt(5)
    v_mfma_f32_16x16x32_bf16 v[192:195], v[148:151], v[76:79], v[192:195]
    ds_read_b128 v[128:131], v9 offset:25600
    v_mfma_f32_16x16x32_bf16 v[196:199], v[152:155], v[76:79], v[196:199]
    ds_read_b128 v[132:135], v9 offset:25856
    v_mfma_f32_16x16x32_bf16 v[200:203], v[156:159], v[76:79], v[200:203]
    ds_read_b128 v[136:139], v9 offset:26112
    v_mfma_f32_16x16x32_bf16 v[204:207], v[160:163], v[76:79], v[204:207]
    ds_read_b128 v[140:143], v9 offset:26368
    v_mfma_f32_16x16x32_bf16 v[208:211], v[164:167], v[76:79], v[208:211]
    ds_read_b128 v[144:147], v9 offset:26624
    s_waitcnt lgkmcnt(5)
    v_mfma_f32_16x16x32_bf16 v[192:195], v[32:35], v[80:83], v[192:195]
    ds_read_b128 v[148:151], v9 offset:30720
    v_mfma_f32_16x16x32_bf16 v[196:199], v[36:39], v[80:83], v[196:199]
    ds_read_b128 v[152:155], v9 offset:30976
    v_mfma_f32_16x16x32_bf16 v[200:203], v[40:43], v[80:83], v[200:203]
    ds_read_b128 v[156:159], v9 offset:31232
    v_mfma_f32_16x16x32_bf16 v[204:207], v[44:47], v[80:83], v[204:207]
    ds_read_b128 v[160:163], v9 offset:31488
    v_mfma_f32_16x16x32_bf16 v[208:211], v[48:51], v[80:83], v[208:211]
    ds_read_b128 v[164:167], v9 offset:31744
    s_cmp_lg_u32 s3, 4
    s_cbranch_scc1 L_a_v_57
    buffer_load_dwordx2 v[60:61], v10, s[36:39], 0 offen sc1
L_a_v_57:
    s_waitcnt lgkmcnt(5)
    v_mfma_f32_16x16x32_bf16 v[192:195], v[128:131], v[84:87], v[192:195]
    ds_read_b128 v[32:35], v9 offset:35840
    v_mfma_f32_16x16x32_bf16 v[196:199], v[132:135], v[84:87], v[196:199]
    ds_read_b128 v[36:39], v9 offset:36096
    v_mfma_f32_16x16x32_bf16 v[200:203], v[136:139], v[84:87], v[200:203]
    ds_read_b128 v[40:43], v9 offset:36352
    v_mfma_f32_16x16x32_bf16 v[204:207], v[140:143], v[84:87], v[204:207]
    ds_read_b128 v[44:47], v9 offset:36608
    v_mfma_f32_16x16x32_bf16 v[208:211], v[144:147], v[84:87], v[208:211]
    ds_read_b128 v[48:51], v9 offset:36864
    s_waitcnt lgkmcnt(5)
    v_mfma_f32_16x16x32_bf16 v[192:195], v[148:151], v[88:91], v[192:195]
    v_mfma_f32_16x16x32_bf16 v[196:199], v[152:155], v[88:91], v[196:199]
    v_mfma_f32_16x16x32_bf16 v[200:203], v[156:159], v[88:91], v[200:203]
    v_mfma_f32_16x16x32_bf16 v[204:207], v[160:163], v[88:91], v[204:207]
    v_mfma_f32_16x16x32_bf16 v[208:211], v[164:167], v[88:91], v[208:211]
    s_waitcnt lgkmcnt(0)
    v_mfma_f32_16x16x32_bf16 v[192:195], v[32:35], v[92:95], v[192:195]
    v_mfma_f32_16x16x32_bf16 v[196:199], v[36:39], v[92:95], v[196:199]
    v_mfma_f32_16x16x32_bf16 v[200:203], v[40:43], v[92:95], v[200:203]
    v_mfma_f32_16x16x32_bf16 v[204:207], v[44:47], v[92:95], v[204:207]
    v_mfma_f32_16x16x32_bf16 v[208:211], v[48:51], v[92:95], v[208:211]
    s_nop 4
    s_cmp_lg_u32 s3, 4
    s_cbranch_scc1 L_a_v_58
    s_waitcnt vmcnt(0)
    ds_write_b64 v62, v[60:61]
L_a_v_58:
    ds_write_b128 v17, v[192:195] offset:0
    ds_write_b128 v17, v[196:199] offset:1024
    ds_write_b128 v17, v[200:203] offset:2048
    ds_write_b128 v17, v[204:207] offset:3072
    ds_write_b128 v17, v[208:211] offset:4096
    s_branch L_a_x
L_a_g13:
    s_add_u32 m0, s48, 61440
    s_mov_b32 s11, 258048
    buffer_load_dwordx4 v12, s[36:39], s11 offen sc1 lds
    s_add_u32 m0, s48, 62464
    s_mov_b32 s11, 258048
    buffer_load_dwordx4 v13, s[36:39], s11 offen sc1 lds
    s_add_u32 m0, s48, 63488
    s_mov_b32 s11, 258048
    buffer_load_dwordx4 v14, s[36:39], s11 offen sc1 lds
    s_add_u32 m0, s48, 64512
    s_mov_b32 s11, 258048
    buffer_load_dwordx4 v15, s[36:39], s11 offen sc1 lds
    s_add_u32 m0, s48, 65536
    s_mov_b32 s11, 258048
    buffer_load_dwordx4 v16, s[36:39], s11 offen sc1 lds
    s_add_u32 m0, s48, 71680
    s_mov_b32 s11, 301056
    buffer_load_dwordx4 v12, s[36:39], s11 offen sc1 lds
    s_add_u32 m0, s48, 72704
    s_mov_b32 s11, 301056
    buffer_load_dwordx4 v13, s[36:39], s11 offen sc1 lds
    s_add_u32 m0, s48, 73728
    s_mov_b32 s11, 301056
    buffer_load_dwordx4 v14, s[36:39], s11 offen sc1 lds
    s_add_u32 m0, s48, 74752
    s_mov_b32 s11, 301056
    buffer_load_dwordx4 v15, s[36:39], s11 offen sc1 lds
    s_add_u32 m0, s48, 75776
    s_mov_b32 s11, 301056
    buffer_load_dwordx4 v16, s[36:39], s11 offen sc1 lds
    s_waitcnt vmcnt(5)
    s_barrier
    ds_read_b128 v[32:35], v8 offset:20480
    ds_read_b128 v[36:39], v8 offset:20736
    ds_read_b128 v[40:43], v8 offset:20992
    ds_read_b128 v[44:47], v8 offset:21248
    ds_read_b128 v[48:51], v8 offset:21504
    ds_read_b128 v[128:131], v8 offset:25600
    ds_read_b128 v[132:135], v8 offset:25856
    ds_read_b128 v[136:139], v8 offset:26112
    ds_read_b128 v[140:143], v8 offset:26368
    ds_read_b128 v[144:147], v8 offset:26624
    s_waitcnt lgkmcnt(5)
    s_waitcnt vmcnt(0)
    s_barrier
    v_mfma_f32_16x16x32_bf16 v[192:195], v[32:35], v[112:115], 0
    ds_read_b128 v[148:151], v8 offset:30720
    s_add_u32 m0, s48, 0
    s_mov_b32 s11, 0
    buffer_load_dwordx4 v12, s[36:39], s11 offen sc1 lds
    v_mfma_f32_16x16x32_bf16 v[196:199], v[36:39], v[112:115], 0
    ds_read_b128 v[152:155], v8 offset:30976
    s_add_u32 m0, s48, 1024
    s_mov_b32 s11, 0
    buffer_load_dwordx4 v13, s[36:39], s11 offen sc1 lds
    v_mfma_f32_16x16x32_bf16 v[200:203], v[40:43], v[112:115], 0
    ds_read_b128 v[156:159], v8 offset:31232
    s_add_u32 m0, s48, 2048
    s_mov_b32 s11, 0
    buffer_load_dwordx4 v14, s[36:39], s11 offen sc1 lds
    v_mfma_f32_16x16x32_bf16 v[204:207], v[44:47], v[112:115], 0
    ds_read_b128 v[160:163], v8 offset:31488
    s_add_u32 m0, s48, 3072
    s_mov_b32 s11, 0
    buffer_load_dwordx4 v15, s[36:39], s11 offen sc1 lds
    v_mfma_f32_16x16x32_bf16 v[208:211], v[48:51], v[112:115], 0
    ds_read_b128 v[164:167], v8 offset:31744
    s_add_u32 m0, s48, 4096
    s_mov_b32 s11, 0
    buffer_load_dwordx4 v16, s[36:39], s11 offen sc1 lds
    s_waitcnt lgkmcnt(5)
    v_mfma_f32_16x16x32_bf16 v[192:195], v[128:131], v[116:119], v[192:195]
    ds_read_b128 v[32:35], v8 offset:35840
    s_add_u32 m0, s48, 10240
    s_mov_b32 s11, 43008
    buffer_load_dwordx4 v12, s[36:39], s11 offen sc1 lds
    v_mfma_f32_16x16x32_bf16 v[196:199], v[132:135], v[116:119], v[196:199]
    ds_read_b128 v[36:39], v8 offset:36096
    s_add_u32 m0, s48, 11264
    s_mov_b32 s11, 43008
    buffer_load_dwordx4 v13, s[36:39], s11 offen sc1 lds
    v_mfma_f32_16x16x32_bf16 v[200:203], v[136:139], v[116:119], v[200:203]
    ds_read_b128 v[40:43], v8 offset:36352
    s_add_u32 m0, s48, 12288
    s_mov_b32 s11, 43008
    buffer_load_dwordx4 v14, s[36:39], s11 offen sc1 lds
    v_mfma_f32_16x16x32_bf16 v[204:207], v[140:143], v[116:119], v[204:207]
    ds_read_b128 v[44:47], v8 offset:36608
    s_add_u32 m0, s48, 13312
    s_mov_b32 s11, 43008
    buffer_load_dwordx4 v15, s[36:39], s11 offen sc1 lds
    v_mfma_f32_16x16x32_bf16 v[208:211], v[144:147], v[116:119], v[208:211]
    ds_read_b128 v[48:51], v8 offset:36864
    s_add_u32 m0, s48, 14336
    s_mov_b32 s11, 43008
    buffer_load_dwordx4 v16, s[36:39], s11 offen sc1 lds
    s_waitcnt lgkmcnt(5)
    s_waitcnt vmcnt(5)
    s_barrier
    v_mfma_f32_16x16x32_bf16 v[192:195], v[148:151], v[120:123], v[192:195]
    ds_read_b128 v[128:131], v9 offset:0
    s_add_u32 m0, s48, 20480
    s_mov_b32 s11, 86016
    buffer_load_dwordx4 v12, s[36:39], s11 offen sc1 lds
    v_mfma_f32_16x16x32_bf16 v[196:199], v[152:155], v[120:123], v[196:199]
    ds_read_b128 v[132:135], v9 offset:256
    s_add_u32 m0, s48, 21504
    s_mov_b32 s11, 86016
    buffer_load_dwordx4 v13, s[36:39], s11 offen sc1 lds
    v_mfma_f32_16x16x32_bf16 v[200:203], v[156:159], v[120:123], v[200:203]
    ds_read_b128 v[136:139], v9 offset:512
    s_add_u32 m0, s48, 22528
    s_mov_b32 s11, 86016
    buffer_load_dwordx4 v14, s[36:39], s11 offen sc1 lds
    v_mfma_f32_16x16x32_bf16 v[204:207], v[160:163], v[120:123], v[204:207]
    ds_read_b128 v[140:143], v9 offset:768
    s_add_u32 m0, s48, 23552
    s_mov_b32 s11, 86016
    buffer_load_dwordx4 v15, s[36:39], s11 offen sc1 lds
    v_mfma_f32_16x16x32_bf16 v[208:211], v[164:167], v[120:123], v[208:211]
    ds_read_b128 v[144:147], v9 offset:1024
    s_add_u32 m0, s48, 24576
    s_mov_b32 s11, 86016
    buffer_load_dwordx4 v16, s[36:39], s11 offen sc1 lds
    s_waitcnt lgkmcnt(5)
    v_mfma_f32_16x16x32_bf16 v[192:195], v[32:35], v[124:127], v[192:195]
    ds_read_b128 v[148:151], v9 offset:5120
    s_add_u32 m0, s48, 30720
    s_mov_b32 s11, 129024
    buffer_load_dwordx4 v12, s[36:39], s11 offen sc1 lds
    v_mfma_f32_16x16x32_bf16 v[196:199], v[36:39], v[124:127], v[196:199]
    ds_read_b128 v[152:155], v9 offset:5376
    s_add_u32 m0, s48, 31744
    s_mov_b32 s11, 129024
    buffer_load_dwordx4 v13, s[36:39], s11 offen sc1 lds
    v_mfma_f32_16x16x32_bf16 v[200:203], v[40:43], v[124:127], v[200:203]
    ds_read_b128 v[156:159], v9 offset:5632
    s_add_u32 m0, s48, 32768
    s_mov_b32 s11, 129024
    buffer_load_dwordx4 v14, s[36:39], s11 offen sc1 lds
    v_mfma_f32_16x16x32_bf16 v[204:207], v[44:47], v[124:127], v[204:207]
    ds_read_b128 v[160:163], v9 offset:5888
    s_add_u32 m0, s48, 33792
    s_mov_b32 s11, 129024
    buffer_load_dwordx4 v15, s[36:39], s11 offen sc1 lds
    v_mfma_f32_16x16x32_bf16 v[208:211], v[48:51], v[124:127], v[208:211]
    ds_read_b128 v[164:167], v9 offset:6144
    s_add_u32 m0, s48, 34816
    s_mov_b32 s11, 129024
    buffer_load_dwordx4 v16, s[36:39], s11 offen sc1 lds
    s_waitcnt lgkmcnt(5)
    s_waitcnt vmcnt(10)
    s_barrier
    v_mfma_f32_16x16x32_bf16 v[192:195], v[128:131], v[64:67], v[192:195]
    ds_read_b128 v[32:35], v9 offset:10240
    s_add_u32 m0, s48, 40960
    s_mov_b32 s11, 172032
    buffer_load_dwordx4 v12, s[36:39], s11 offen sc1 lds
    v_mfma_f32_16x16x32_bf16 v[196:199], v[132:135], v[64:67], v[196:199]
    ds_read_b128 v[36:39], v9 offset:10496
    s_add_u32 m0, s48, 41984
    s_mov_b32 s11, 172032
    buffer_load_dwordx4 v13, s[36:39], s11 offen sc1 lds
    v_mfma_f32_16x16x32_bf16 v[200:203], v[136:139], v[64:67], v[200:203]
    ds_read_b128 v[40:43], v9 offset:10752
    s_add_u32 m0, s48, 43008
    s_mov_b32 s11, 172032
    buffer_load_dwordx4 v14, s[36:39], s11 offen sc1 lds
    v_mfma_f32_16x16x32_bf16 v[204:207], v[140:143], v[64:67], v[204:207]
    ds_read_b128 v[44:47], v9 offset:11008
    s_add_u32 m0, s48, 44032
    s_mov_b32 s11, 172032
    buffer_load_dwordx4 v15, s[36:39], s11 offen sc1 lds
    v_mfma_f32_16x16x32_bf16 v[208:211], v[144:147], v[64:67], v[208:211]
    ds_read_b128 v[48:51], v9 offset:11264
    s_add_u32 m0, s48, 45056
    s_mov_b32 s11, 172032
    buffer_load_dwordx4 v16, s[36:39], s11 offen sc1 lds
    s_waitcnt lgkmcnt(5)
    v_mfma_f32_16x16x32_bf16 v[192:195], v[148:151], v[68:71], v[192:195]
    ds_read_b128 v[128:131], v9 offset:15360
    s_add_u32 m0, s48, 51200
    s_mov_b32 s11, 215040
    buffer_load_dwordx4 v12, s[36:39], s11 offen sc1 lds
    v_mfma_f32_16x16x32_bf16 v[196:199], v[152:155], v[68:71], v[196:199]
    ds_read_b128 v[132:135], v9 offset:15616
    s_add_u32 m0, s48, 52224
    s_mov_b32 s11, 215040
    buffer_load_dwordx4 v13, s[36:39], s11 offen sc1 lds
    v_mfma_f32_16x16x32_bf16 v[200:203], v[156:159], v[68:71], v[200:203]
    ds_read_b128 v[136:139], v9 offset:15872
    s_add_u32 m0, s48, 53248
    s_mov_b32 s11, 215040
    buffer_load_dwordx4 v14, s[36:39], s11 offen sc1 lds
    v_mfma_f32_16x16x32_bf16 v[204:207], v[160:163], v[68:71], v[204:207]
    ds_read_b128 v[140:143], v9 offset:16128
    v_mfma_f32_16x16x32_bf16 v[208:211], v[164:167], v[68:71], v[208:211]
    ds_read_b128 v[144:147], v9 offset:16384
    s_waitcnt lgkmcnt(5)
    s_waitcnt vmcnt(8)
    s_barrier
    v_mfma_f32_16x16x32_bf16 v[192:195], v[32:35], v[72:75], v[192:195]
    ds_read_b128 v[148:151], v9 offset:20480
    s_add_u32 m0, s48, 54272
    s_mov_b32 s11, 215040
    buffer_load_dwordx4 v15, s[36:39], s11 offen sc1 lds
    v_mfma_f32_16x16x32_bf16 v[196:199], v[36:39], v[72:75], v[196:199]
    ds_read_b128 v[152:155], v9 offset:20736
    s_add_u32 m0, s48, 55296
    s_mov_b32 s11, 215040
    buffer_load_dwordx4 v16, s[36:39], s11 offen sc1 lds
    v_mfma_f32_16x16x32_bf16 v[200:203], v[40:43], v[72:75], v[200:203]
    ds_read_b128 v[156:159], v9 offset:20992
    v_mfma_f32_16x16x32_bf16 v[204:207], v[44:47], v[72:75], v[204:207]
    ds_read_b128 v[160:163], v9 offset:21248
    v_mfma_f32_16x16x32_bf16 v[208:211], v[48:51], v[72:75], v[208:211]
    ds_read_b128 v[164:167], v9 offset:21504
    s_waitcnt lgkmcnt(5)
    v_mfma_f32_16x16x32_bf16 v[192:195], v[128:131], v[76:79], v[192:195]
    ds_read_b128 v[32:35], v9 offset:25600
    v_mfma_f32_16x16x32_bf16 v[196:199], v[132:135], v[76:79], v[196:199]
    ds_read_b128 v[36:39], v9 offset:25856
    v_mfma_f32_16x16x32_bf16 v[200:203], v[136:139], v[76:79], v[200:203]
    ds_read_b128 v[40:43], v9 offset:26112
    v_mfma_f32_16x16x32_bf16 v[204:207], v[140:143], v[76:79], v[204:207]
    ds_read_b128 v[44:47], v9 offset:26368
    v_mfma_f32_16x16x32_bf16 v[208:211], v[144:147], v[76:79], v[208:211]
    ds_read_b128 v[48:51], v9 offset:26624
    s_waitcnt lgkmcnt(5)
    v_mfma_f32_16x16x32_bf16 v[192:195], v[148:151], v[80:83], v[192:195]
    ds_read_b128 v[128:131], v9 offset:30720
    v_mfma_f32_16x16x32_bf16 v[196:199], v[152:155], v[80:83], v[196:199]
    ds_read_b128 v[132:135], v9 offset:30976
    v_mfma_f32_16x16x32_bf16 v[200:203], v[156:159], v[80:83], v[200:203]
    ds_read_b128 v[136:139], v9 offset:31232
    v_mfma_f32_16x16x32_bf16 v[204:207], v[160:163], v[80:83], v[204:207]
    ds_read_b128 v[140:143], v9 offset:31488
    v_mfma_f32_16x16x32_bf16 v[208:211], v[164:167], v[80:83], v[208:211]
    ds_read_b128 v[144:147], v9 offset:31744
    s_waitcnt lgkmcnt(5)
    v_mfma_f32_16x16x32_bf16 v[192:195], v[32:35], v[84:87], v[192:195]
    ds_read_b128 v[148:151], v9 offset:35840
    v_mfma_f32_16x16x32_bf16 v[196:199], v[36:39], v[84:87], v[196:199]
    ds_read_b128 v[152:155], v9 offset:36096
    v_mfma_f32_16x16x32_bf16 v[200:203], v[40:43], v[84:87], v[200:203]
    ds_read_b128 v[156:159], v9 offset:36352
    v_mfma_f32_16x16x32_bf16 v[204:207], v[44:47], v[84:87], v[204:207]
    ds_read_b128 v[160:163], v9 offset:36608
    v_mfma_f32_16x16x32_bf16 v[208:211], v[48:51], v[84:87], v[208:211]
    ds_read_b128 v[164:167], v9 offset:36864
    s_waitcnt lgkmcnt(5)
    s_waitcnt vmcnt(0)
    s_barrier
    v_mfma_f32_16x16x32_bf16 v[192:195], v[128:131], v[88:91], v[192:195]
    ds_read_b128 v[32:35], v8 offset:0
    v_mfma_f32_16x16x32_bf16 v[196:199], v[132:135], v[88:91], v[196:199]
    ds_read_b128 v[36:39], v8 offset:256
    v_mfma_f32_16x16x32_bf16 v[200:203], v[136:139], v[88:91], v[200:203]
    ds_read_b128 v[40:43], v8 offset:512
    v_mfma_f32_16x16x32_bf16 v[204:207], v[140:143], v[88:91], v[204:207]
    ds_read_b128 v[44:47], v8 offset:768
    v_mfma_f32_16x16x32_bf16 v[208:211], v[144:147], v[88:91], v[208:211]
    ds_read_b128 v[48:51], v8 offset:1024
    s_waitcnt lgkmcnt(5)
    v_mfma_f32_16x16x32_bf16 v[192:195], v[148:151], v[92:95], v[192:195]
    ds_read_b128 v[128:131], v8 offset:5120
    v_mfma_f32_16x16x32_bf16 v[196:199], v[152:155], v[92:95], v[196:199]
    ds_read_b128 v[132:135], v8 offset:5376
    v_mfma_f32_16x16x32_bf16 v[200:203], v[156:159], v[92:95], v[200:203]
    ds_read_b128 v[136:139], v8 offset:5632
    v_mfma_f32_16x16x32_bf16 v[204:207], v[160:163], v[92:95], v[204:207]
    ds_read_b128 v[140:143], v8 offset:5888
    v_mfma_f32_16x16x32_bf16 v[208:211], v[164:167], v[92:95], v[208:211]
    ds_read_b128 v[144:147], v8 offset:6144
    s_waitcnt lgkmcnt(5)
    v_mfma_f32_16x16x32_bf16 v[192:195], v[32:35], v[96:99], v[192:195]
    ds_read_b128 v[148:151], v8 offset:10240
    v_mfma_f32_16x16x32_bf16 v[196:199], v[36:39], v[96:99], v[196:199]
    ds_read_b128 v[152:155], v8 offset:10496
    v_mfma_f32_16x16x32_bf16 v[200:203], v[40:43], v[96:99], v[200:203]
    ds_read_b128 v[156:159], v8 offset:10752
    v_mfma_f32_16x16x32_bf16 v[204:207], v[44:47], v[96:99], v[204:207]
    ds_read_b128 v[160:163], v8 offset:11008
    v_mfma_f32_16x16x32_bf16 v[208:211], v[48:51], v[96:99], v[208:211]
    ds_read_b128 v[164:167], v8 offset:11264
    s_cmp_lg_u32 s3, 4
    s_cbranch_scc1 L_a_v_59
    buffer_load_dwordx2 v[60:61], v10, s[36:39], 0 offen sc1
L_a_v_59:
    s_waitcnt lgkmcnt(5)
    v_mfma_f32_16x16x32_bf16 v[192:195], v[128:131], v[100:103], v[192:195]
    ds_read_b128 v[32:35], v8 offset:15360
    v_mfma_f32_16x16x32_bf16 v[196:199], v[132:135], v[100:103], v[196:199]
    ds_read_b128 v[36:39], v8 offset:15616
    v_mfma_f32_16x16x32_bf16 v[200:203], v[136:139], v[100:103], v[200:203]
    ds_read_b128 v[40:43], v8 offset:15872
    v_mfma_f32_16x16x32_bf16 v[204:207], v[140:143], v[100:103], v[204:207]
    ds_read_b128 v[44:47], v8 offset:16128
    v_mfma_f32_16x16x32_bf16 v[208:211], v[144:147], v[100:103], v[208:211]
    ds_read_b128 v[48:51], v8 offset:16384
    s_waitcnt lgkmcnt(5)
    v_mfma_f32_16x16x32_bf16 v[192:195], v[148:151], v[104:107], v[192:195]
    v_mfma_f32_16x16x32_bf16 v[196:199], v[152:155], v[104:107], v[196:199]
    v_mfma_f32_16x16x32_bf16 v[200:203], v[156:159], v[104:107], v[200:203]
    v_mfma_f32_16x16x32_bf16 v[204:207], v[160:163], v[104:107], v[204:207]
    v_mfma_f32_16x16x32_bf16 v[208:211], v[164:167], v[104:107], v[208:211]
    s_waitcnt lgkmcnt(0)
    v_mfma_f32_16x16x32_bf16 v[192:195], v[32:35], v[108:111], v[192:195]
    v_mfma_f32_16x16x32_bf16 v[196:199], v[36:39], v[108:111], v[196:199]
    v_mfma_f32_16x16x32_bf16 v[200:203], v[40:43], v[108:111], v[200:203]
    v_mfma_f32_16x16x32_bf16 v[204:207], v[44:47], v[108:111], v[204:207]
    v_mfma_f32_16x16x32_bf16 v[208:211], v[48:51], v[108:111], v[208:211]
    s_nop 4
    s_cmp_lg_u32 s3, 4
    s_cbranch_scc1 L_a_v_60
    s_waitcnt vmcnt(0)
    ds_write_b64 v62, v[60:61]
L_a_v_60:
    ds_write_b128 v17, v[192:195] offset:0
    ds_write_b128 v17, v[196:199] offset:1024
    ds_write_b128 v17, v[200:203] offset:2048
    ds_write_b128 v17, v[204:207] offset:3072
    ds_write_b128 v17, v[208:211] offset:4096
L_a_x:
    s_waitcnt lgkmcnt(0)
    s_barrier
    ds_read_b128 v[232:235], v56 offset:0
    ds_read_b128 v[236:239], v56 offset:64
    ds_read_b128 v[240:243], v56 offset:128
    ds_read_b128 v[244:247], v56 offset:192
    ds_read_b128 v[248:251], v56 offset:256
    ds_read_b128 v[32:35], v18 offset:0
    ds_read_b128 v[36:39], v18 offset:1024
    ds_read_b128 v[40:43], v18 offset:2048
    ds_read_b128 v[44:47], v18 offset:3072
    ds_read_b128 v[48:51], v18 offset:4096
    s_cmp_eq_u32 s15, s12
    s_cbranch_scc1 L_a_vo
    s_waitcnt lgkmcnt(0)
    v_fma_f32 v32, v232, v11, v32
    v_fma_f32 v33, v233, v11, v33
    v_fma_f32 v34, v234, v11, v34
    v_fma_f32 v35, v235, v11, v35
    v_fma_f32 v36, v236, v11, v36
    v_fma_f32 v37, v237, v11, v37
    v_fma_f32 v38, v238, v11, v38
    v_fma_f32 v39, v239, v11, v39
    v_fma_f32 v40, v240, v11, v40
    v_fma_f32 v41, v241, v11, v41
    v_fma_f32 v42, v242, v11, v42
    v_fma_f32 v43, v243, v11, v43
    v_fma_f32 v44, v244, v11, v44
    v_fma_f32 v45, v245, v11, v45
    v_fma_f32 v46, v246, v11, v46
    v_fma_f32 v47, v247, v11, v47
    v_fma_f32 v48, v248, v11, v48
    v_fma_f32 v49, v249, v11, v49
    s_branch L_a_vd
L_a_vo:
    s_waitcnt lgkmcnt(5)
    v_fma_f32 v192, v232, v11, v192
    v_fma_f32 v193, v233, v11, v193
    v_fma_f32 v194, v234, v11, v194
    v_fma_f32 v195, v235, v11, v195
    v_fma_f32 v196, v236, v11, v196
    v_fma_f32 v197, v237, v11, v197
    v_fma_f32 v198, v238, v11, v198
    v_fma_f32 v199, v239, v11, v199
    v_fma_f32 v200, v240, v11, v200
    v_fma_f32 v201, v241, v11, v201
    v_fma_f32 v202, v242, v11, v202
    v_fma_f32 v203, v243, v11, v203
    v_fma_f32 v204, v244, v11, v204
    v_fma_f32 v205, v245, v11, v205
    v_fma_f32 v206, v246, v11, v206
    v_fma_f32 v207, v247, v11, v207
    v_fma_f32 v208, v248, v11, v208
    v_fma_f32 v209, v249, v11, v209
    s_waitcnt lgkmcnt(0)
L_a_vd:
    s_cmp_eq_u32 s15, 0
    s_cbranch_scc1 L_a_cp
    v_sub_f32 v64, v32, v192
    v_sub_f32 v65, v33, v193
    v_sub_f32 v66, v34, v194
    v_sub_f32 v67, v35, v195
    v_sub_f32 v68, v36, v196
    v_sub_f32 v69, v37, v197
    v_sub_f32 v70, v38, v198
    v_sub_f32 v71, v39, v199
    v_sub_f32 v72, v40, v200
    v_sub_f32 v73, v41, v201
    v_sub_f32 v74, v42, v202
    v_sub_f32 v75, v43, v203
    v_sub_f32 v76, v44, v204
    v_sub_f32 v77, v45, v205
    v_sub_f32 v78, v46, v206
    v_sub_f32 v79, v47, v207
    v_sub_f32 v80, v48, v208
    v_sub_f32 v81, v49, v209
    s_branch L_a_cq
L_a_cp:
    v_sub_f32 v64, v192, v32
    v_sub_f32 v65, v193, v33
    v_sub_f32 v66, v194, v34
    v_sub_f32 v67, v195, v35
    v_sub_f32 v68, v196, v36
    v_sub_f32 v69, v197, v37
    v_sub_f32 v70, v198, v38
    v_sub_f32 v71, v199, v39
    v_sub_f32 v72, v200, v40
    v_sub_f32 v73, v201, v41
    v_sub_f32 v74, v202, v42
    v_sub_f32 v75, v203, v43
    v_sub_f32 v76, v204, v44
    v_sub_f32 v77, v205, v45
    v_sub_f32 v78, v206, v46
    v_sub_f32 v79, v207, v47
    v_sub_f32 v80, v208, v48
    v_sub_f32 v81, v209, v49
L_a_cq:
    v_add_f32 v84, v192, v32
    v_add_f32 v85, v193, v33
    v_add_f32 v86, v194, v34
    v_add_f32 v87, v195, v35
    v_cvt_pk_bf16_f32 v106, v84, v85
    v_cvt_pk_bf16_f32 v104, v64, v65
    v_cvt_pk_bf16_f32 v107, v86, v87
    v_cvt_pk_bf16_f32 v105, v66, v67
    s_nop 1
    v_permlane16_swap_b32 v104, v106
    v_permlane16_swap_b32 v105, v107
    v_add_f32 v88, v196, v36
    v_add_f32 v89, v197, v37
    v_add_f32 v90, v198, v38
    v_add_f32 v91, v199, v39
    v_cvt_pk_bf16_f32 v114, v88, v89
    v_cvt_pk_bf16_f32 v112, v68, v69
    v_cvt_pk_bf16_f32 v115, v90, v91
    v_cvt_pk_bf16_f32 v113, v70, v71
    s_nop 1
    v_permlane16_swap_b32 v112, v114
    v_permlane16_swap_b32 v113, v115
    v_add_f32 v92, v200, v40
    v_add_f32 v93, v201, v41
    v_add_f32 v94, v202, v42
    v_add_f32 v95, v203, v43
    v_cvt_pk_bf16_f32 v122, v92, v93
    v_cvt_pk_bf16_f32 v120, v72, v73
    v_cvt_pk_bf16_f32 v123, v94, v95
    v_cvt_pk_bf16_f32 v121, v74, v75
    s_nop 1
    v_permlane16_swap_b32 v120, v122
    v_permlane16_swap_b32 v121, v123
    v_add_f32 v96, v204, v44
    v_add_f32 v97, v205, v45
    v_add_f32 v98, v206, v46
    v_add_f32 v99, v207, v47
    v_cvt_pk_bf16_f32 v130, v96, v97
    v_cvt_pk_bf16_f32 v128, v76, v77
    v_cvt_pk_bf16_f32 v131, v98, v99
    v_cvt_pk_bf16_f32 v129, v78, v79
    s_nop 1
    v_permlane16_swap_b32 v128, v130
    v_permlane16_swap_b32 v129, v131
    v_add_f32 v100, v208, v48
    v_add_f32 v101, v209, v49
    v_cvt_pk_bf16_f32 v138, v100, v101
    v_cvt_pk_bf16_f32 v136, v80, v81
    s_nop 1
    v_permlane16_swap_b32 v136, v138
    s_and_b32 s10, s3, 5
    s_cmp_eq_u32 s10, 5
    s_cbranch_scc1 L_a_nf
    ds_write_b128 v19, v[104:107] offset:0
    ds_write_b128 v19, v[112:115] offset:32
    ds_write_b128 v19, v[120:123] offset:64
    ds_write_b128 v19, v[128:131] offset:96
    s_cmp_eq_u32 s10, 4
    s_cbranch_scc1 L_a_fo
    v_mov_b32 v2, v104
    v_mov_b32 v3, v112
    v_bfi_b32 v109, v23, v107, v106
    v_bfi_b32 v110, v23, v106, v105
    v_permlane32_swap_b32 v2, v3
    v_bfi_b32 v111, v23, v105, v104
    v_bfi_b32 v108, v29, v2, v107
    v_bfi_b32 v108, v28, v3, v108
    v_mov_b32 v2, v112
    v_mov_b32 v3, v120
    v_bfi_b32 v117, v23, v115, v114
    v_bfi_b32 v118, v23, v114, v113
    v_permlane32_swap_b32 v2, v3
    v_bfi_b32 v119, v23, v113, v112
    v_bfi_b32 v116, v29, v2, v115
    v_bfi_b32 v116, v28, v3, v116
    s_waitcnt lgkmcnt(0)
    ds_read_b128 v[144:147], v21 offset:0
    ds_read_b128 v[148:151], v21 offset:1152
    ds_read_b128 v[152:155], v21 offset:2304
    ds_read_b128 v[156:159], v21 offset:3456
    v_mov_b32 v2, v120
    v_mov_b32 v3, v128
    v_bfi_b32 v125, v23, v123, v122
    v_bfi_b32 v126, v23, v122, v121
    v_permlane32_swap_b32 v2, v3
    v_bfi_b32 v127, v23, v121, v120
    v_bfi_b32 v124, v29, v2, v123
    v_bfi_b32 v124, v28, v3, v124
    v_mov_b32 v2, v128
    v_mov_b32 v3, v136
    v_bfi_b32 v133, v23, v131, v130
    v_bfi_b32 v134, v23, v130, v129
    v_permlane32_swap_b32 v2, v3
    v_bfi_b32 v135, v23, v129, v128
    v_bfi_b32 v132, v29, v2, v131
    v_bfi_b32 v132, v28, v3, v132
    ds_write_b128 v20, v[108:111] offset:96
    ds_write_b128 v20, v[116:119] offset:64
    ds_write_b128 v20, v[124:127] offset:32
    ds_write_b128 v20, v[132:135] offset:0
    s_waitcnt lgkmcnt(7)
    buffer_store_dwordx4 v[144:147], v24, s[32:35], s58 offen sc1
    s_waitcnt lgkmcnt(6)
    buffer_store_dwordx4 v[148:151], v25, s[32:35], s58 offen sc1
    s_waitcnt lgkmcnt(5)
    buffer_store_dwordx4 v[152:155], v26, s[32:35], s58 offen sc1
    s_waitcnt lgkmcnt(4)
    buffer_store_dwordx4 v[156:159], v27, s[32:35], s58 offen sc1
    s_branch L_a_rs
L_a_fo:
    s_waitcnt lgkmcnt(0)
    ds_read_b128 v[144:147], v21 offset:0
    ds_read_b128 v[148:151], v21 offset:1152
    ds_read_b128 v[152:155], v21 offset:2304
    ds_read_b128 v[156:159], v21 offset:3456
    s_waitcnt lgkmcnt(3)
    buffer_store_dwordx4 v[144:147], v24, s[32:35], s58 offen sc1
    s_waitcnt lgkmcnt(2)
    buffer_store_dwordx4 v[148:151], v25, s[32:35], s58 offen sc1
    s_waitcnt lgkmcnt(1)
    buffer_store_dwordx4 v[152:155], v26, s[32:35], s58 offen sc1
    s_waitcnt lgkmcnt(0)
    buffer_store_dwordx4 v[156:159], v27, s[32:35], s58 offen sc1
    s_branch L_a_done
L_a_nf:
    v_mov_b32 v2, v104
    v_mov_b32 v3, v112
    v_bfi_b32 v109, v23, v107, v106
    v_bfi_b32 v110, v23, v106, v105
    v_permlane32_swap_b32 v2, v3
    v_bfi_b32 v111, v23, v105, v104
    v_bfi_b32 v108, v29, v2, v107
    v_bfi_b32 v108, v28, v3, v108
    ds_write_b128 v20, v[108:111] offset:96
    v_mov_b32 v2, v112
    v_mov_b32 v3, v120
    v_bfi_b32 v117, v23, v115, v114
    v_bfi_b32 v118, v23, v114, v113
    v_permlane32_swap_b32 v2, v3
    v_bfi_b32 v119, v23, v113, v112
    v_bfi_b32 v116, v29, v2, v115
    v_bfi_b32 v116, v28, v3, v116
    ds_write_b128 v20, v[116:119] offset:64
    v_mov_b32 v2, v120
    v_mov_b32 v3, v128
    v_bfi_b32 v125, v23, v123, v122
    v_bfi_b32 v126, v23, v122, v121
    v_permlane32_swap_b32 v2, v3
    v_bfi_b32 v127, v23, v121, v120
    v_bfi_b32 v124, v29, v2, v123
    v_bfi_b32 v124, v28, v3, v124
    ds_write_b128 v20, v[124:127] offset:32
    v_mov_b32 v2, v128
    v_mov_b32 v3, v136
    v_bfi_b32 v133, v23, v131, v130
    v_bfi_b32 v134, v23, v130, v129
    v_permlane32_swap_b32 v2, v3
    v_bfi_b32 v135, v23, v129, v128
    v_bfi_b32 v132, v29, v2, v131
    v_bfi_b32 v132, v28, v3, v132
    ds_write_b128 v20, v[132:135] offset:0
L_a_rs:
    s_waitcnt lgkmcnt(0)
    ds_read_b128 v[160:163], v57 offset:0
    ds_read_b128 v[164:167], v57 offset:1152
    ds_read_b128 v[168:171], v57 offset:2304
    ds_read_b128 v[172:175], v57 offset:3456
    s_waitcnt lgkmcnt(3)
    buffer_store_dwordx4 v[160:163], v26, s[32:35], s59 offen sc1
    s_waitcnt lgkmcnt(2)
    buffer_store_dwordx4 v[164:167], v27, s[32:35], s59 offen sc1
    s_waitcnt lgkmcnt(1)
    buffer_store_dwordx4 v[168:171], v24, s[32:35], s59 offen sc1
    s_waitcnt lgkmcnt(0)
    buffer_store_dwordx4 v[172:175], v25, s[32:35], s59 offen sc1
L_a_done:
L_a_fin:
L_end:
    s_endpgm
.section .rodata,"a"
.p2align 6
.amdhsa_kernel concat_heads__spectral_fnet__sliding_local_dilated__prompt_kernel
  .amdhsa_next_free_vgpr 256
  .amdhsa_next_free_sgpr 102
  .amdhsa_accum_offset 256
  .amdhsa_group_segment_fixed_size 0
  .amdhsa_kernarg_size 88
  .amdhsa_user_sgpr_count 2
  .amdhsa_user_sgpr_kernarg_segment_ptr 1
  .amdhsa_system_sgpr_workgroup_id_x 1
.end_amdhsa_kernel
```
